```python
import torch

def _softmax(x, axis=-1):
    return torch.softmax(x, dim=axis)

def _gelu(x):
    return torch.nn.functional.gelu(x, approximate='tanh')

def _silu(x):
    return torch.nn.functional.silu(x)

def _sigmoid(x):
    return torch.sigmoid(x)

def _layernorm(x, axis=-1, eps=1e-05):
    m = x.mean(dim=axis, keepdim=True)
    v = x.var(dim=axis, keepdim=True, unbiased=False)
    return (x - m) / torch.sqrt(v + eps)

def _scatter_add(tgt, idx, src, axis=0):
    return tgt.clone().index_add_(axis, idx, src)

def _segment_sum(src, seg, n):
    out = torch.zeros((n,) + src.shape[1:], dtype=src.dtype)
    return out.index_add_(0, seg, src)

def _pad(x, pw):
    flat = tuple((v for pair in reversed(pw) for v in pair))
    return torch.nn.functional.pad(x, flat)
kernel_name = 'adaLN_cond__memory_aug_recurrent_mem_tr__glu_gated_reglu__prompt'

def setup_inputs():

    _w = lambda a: (lambda t: t.to(torch.bfloat16) if t.is_floating_point() else t)(torch.as_tensor(a))

    def _A_setup():
        B, S, Dm = (1, 2048, 576)
        H, Dh = (32, 128)
        M, seg = (8, 32)
        seg = min(seg, S)
        S = S // seg * seg
        return {'x': _w((lambda *s: torch.randn(*s, dtype=torch.bfloat16) * 0.05)(B, S, Dm)), 'mem0': _w((lambda *s: torch.randn(*s, dtype=torch.bfloat16) * 0.8)(B, M, Dm)), 'Wq': _w((lambda *s: torch.randn(*s, dtype=torch.bfloat16) * 0.8)(Dm, H, Dh) * Dm ** (-0.5)), 'Wk': _w((lambda *s: torch.randn(*s, dtype=torch.bfloat16) * 0.8)(Dm, H, Dh) * Dm ** (-0.5)), 'Wv': _w((lambda *s: torch.randn(*s, dtype=torch.bfloat16) * 0.8)(Dm, H, Dh) * Dm ** (-0.5)), 'Wo': _w((lambda *s: torch.randn(*s, dtype=torch.bfloat16) * 0.8)(H, Dh, Dm) * (H * Dh) ** (-0.5)), 'seg_len': seg}
    _A_in = _A_setup()

    def _B_setup():
        B, S, D, F = (1, 2048, 576, 4608)
        return {'x': _w((lambda *s: torch.randn(*s, dtype=torch.bfloat16) * 0.05)(B, S, D)), 'W_gate': _w((lambda *s: torch.randn(*s, dtype=torch.bfloat16) * 0.4)(D, F) * (2.0 / D) ** 0.5), 'W_up': _w((lambda *s: torch.randn(*s, dtype=torch.bfloat16) * 0.4)(D, F) * (2.0 / D) ** 0.5), 'W_down': _w((lambda *s: torch.randn(*s, dtype=torch.bfloat16) * 0.4)(F, D) * (1.0 / F) ** 0.5)}
    _B_in = _B_setup()
    return {'A_x': _A_in['x'], 'A_mem0': _A_in['mem0'], 'A_Wq': _A_in['Wq'], 'A_Wk': _A_in['Wk'], 'A_Wv': _A_in['Wv'], 'A_Wo': _A_in['Wo'], 'A_seg_len': _A_in['seg_len'], 'B_x': _B_in['x'], 'B_W_gate': _B_in['W_gate'], 'B_W_up': _B_in['W_up'], 'B_W_down': _B_in['W_down'], 'c': _w((lambda *s: torch.randn(*s, dtype=torch.bfloat16) * 0.1)(1, 576) * 8.0), 'w_mod': _w((lambda *s: torch.randn(*s, dtype=torch.bfloat16) * 0.1)(576, 6 * 576) * 576 ** (-0.5) * 8.0)}

def reference(A_x, A_mem0, A_Wq, A_Wk, A_Wv, A_Wo, A_seg_len, B_x, B_W_gate, B_W_up, B_W_down, c, w_mod):

    def _A_ref(x, mem0, Wq, Wk, Wv, Wo, seg_len):
        B, S, Dm = x.shape
        H, Dh = (Wq.shape[1], Wq.shape[2])
        M = mem0.shape[1]
        scale = Dh ** (-0.5)
        n_seg = S // seg_len
        L = M + seg_len
        idx = torch.arange(L)
        mask = (idx[:, None] < M) | (idx[:, None] >= idx[None, :])
        mem = mem0
        outs = []
        for s in range(n_seg):
            xs = x[:, s * seg_len:(s + 1) * seg_len, :].clone()
            h = torch.concatenate([mem, xs], axis=1)
            q = torch.einsum('btd,dhe->bhte', h, Wq)
            k = torch.einsum('btd,dhe->bhte', h, Wk)
            v = torch.einsum('btd,dhe->bhte', h, Wv)
            scores = torch.einsum('bhqe,bhke->bhqk', q, k) * scale
            scores = torch.where(mask[None, None], scores, -1000000000.0)
            p = _softmax(scores, axis=-1)
            o = torch.einsum('bhqk,bhke->bhqe', p, v)
            o = torch.einsum('bhte,hed->btd', o, Wo)
            mem = o[:, :M, :].clone()
            outs.append(o[:, M:, :])
        return torch.concatenate(outs, axis=1)

    def _B_ref(x, W_gate, W_up, W_down):
        gate = torch.einsum('bsd,df->bsf', x, W_gate)
        up = torch.einsum('bsd,df->bsf', x, W_up)
        gate = gate * (lambda x, dt: x.to(dt))(gate > 0, gate.dtype)
        h = gate * up
        return torch.einsum('bsf,fd->bsd', h, W_down)
    x = A_x
    mod = (_silu(c) @ w_mod).reshape(c.shape[0], 6, 1, -1)
    sa, ca, ga, sb, cb, gb = (mod[:, 0].clone(), mod[:, 1].clone(), mod[:, 2].clone(), mod[:, 3].clone(), mod[:, 4].clone(), mod[:, 5].clone())
    h = _layernorm(x, axis=-1) * (1 + ca) + sa
    x = x + ga * _A_ref(h, A_mem0, A_Wq, A_Wk, A_Wv, A_Wo, A_seg_len)
    h = _layernorm(x, axis=-1) * (1 + cb) + sb
    x = x + gb * _B_ref(h, B_W_gate, B_W_up, B_W_down)
    return x
```

```asm
; @launch kernel=zero_kernel grid=(580,1,1) block=(256,1,1) lds=0
; @launch kernel=mod_kernel grid=(27,1,1) block=(256,1,1) lds=2048
; @launch kernel=ln1_kernel grid=(512,1,1) block=(256,1,1) lds=0
; @launch kernel=qk_gemm_kernel grid=(1024,1,1) block=(256,1,1) lds=102400
; @launch kernel=v_gemm_kernel grid=(512,1,1) block=(256,1,1) lds=102400
; @launch kernel=chain_kernel grid=(32,1,1) block=(256,1,1) lds=163840
; @launch kernel=attn_kernel grid=(512,1,1) block=(256,1,1) lds=0
; @launch kernel=wo_gemm_kernel grid=(144,1,1) block=(256,1,1) lds=61440
; @launch kernel=ln2_kernel grid=(512,1,1) block=(256,1,1) lds=0
; @launch kernel=ffn1_kernel grid=(1152,1,1) block=(256,1,1) lds=102400
; @launch kernel=ffn2_kernel grid=(144,1,1) block=(256,1,1) lds=61440
.amdgcn_target "amdgcn-amd-amdhsa--gfx950"
.text
.p2align 8
.globl zero_kernel
.type zero_kernel,@function
zero_kernel:
    s_cmp_ge_u32 s2, 580
    s_cbranch_scc1 zero_kernel_end
    s_load_dwordx2 s[8:9], s[0:1], 120
    s_waitcnt lgkmcnt(0)

    s_add_u32 s12, s8, 16384
    s_addc_u32 s13, s9, 0
    s_mov_b32 s14, 2375680
    s_mov_b32 s15, 0x00020000
    s_lshl_b32 s3, s2, 12
    v_lshlrev_b32 v1, 4, v0
    v_add_u32 v1, s3, v1
    v_mov_b32 v4, 0
    v_mov_b32 v5, 0
    v_mov_b32 v6, 0
    v_mov_b32 v7, 0
    buffer_store_dwordx4 v[4:7], v1, s[12:15], 0 offen

zero_kernel_end:
    s_endpgm
.section .rodata,"a"
.p2align 6
.amdhsa_kernel zero_kernel
  .amdhsa_next_free_vgpr 8
  .amdhsa_next_free_sgpr 24
  .amdhsa_accum_offset 8
  .amdhsa_group_segment_fixed_size 0
  .amdhsa_kernarg_size 128
  .amdhsa_user_sgpr_count 2
  .amdhsa_user_sgpr_kernarg_segment_ptr 1
  .amdhsa_system_sgpr_workgroup_id_x 1
.end_amdhsa_kernel
.text
.p2align 8
.globl mod_kernel
.type mod_kernel,@function
mod_kernel:
    s_cmp_ge_u32 s2, 27
    s_cbranch_scc1 mod_kernel_end
    s_load_dwordx2 s[4:5], s[0:1], 88
    s_load_dwordx2 s[6:7], s[0:1], 96
    s_load_dwordx2 s[8:9], s[0:1], 120
    v_and_b32 v1, 63, v0
    v_lshrrev_b32 v2, 6, v0
    s_waitcnt lgkmcnt(0)

    s_mov_b32 s12, s4
    s_mov_b32 s13, s5
    s_mov_b32 s14, 1152
    s_mov_b32 s15, 0x00020000
    s_mov_b32 s16, s6
    s_mov_b32 s17, s7
    s_mov_b32 s18, 3981312
    s_mov_b32 s19, 0x00020000
    s_mov_b32 s20, s8
    s_mov_b32 s21, s9
    s_mov_b32 s22, 13824
    s_mov_b32 s23, 0x00020000
    v_mul_u32_u24 v3, 144, v2
    v_add_u32 v4, v3, v1
    v_lshlrev_b32 v4, 1, v4
    buffer_load_ushort v10, v4, s[12:15], 0 offen
    buffer_load_ushort v11, v4, s[12:15], 0 offen offset:128
    buffer_load_ushort v12, v4, s[12:15], 0 offen offset:256
    s_mov_b32 s24, 0xbfb8aa3b
    s_waitcnt vmcnt(0)

    v_lshlrev_b32 v10, 16, v10
    v_mul_f32 v13, s24, v10
    v_exp_f32 v13, v13
    s_nop 0
    v_add_f32 v13, 1.0, v13
    v_rcp_f32 v13, v13
    s_nop 0
    v_mul_f32 v13, v13, v10
    v_cvt_pk_bf16_f32 v13, v13, v13
    v_lshlrev_b32 v10, 16, v13

    v_lshlrev_b32 v11, 16, v11
    v_mul_f32 v13, s24, v11
    v_exp_f32 v13, v13
    s_nop 0
    v_add_f32 v13, 1.0, v13
    v_rcp_f32 v13, v13
    s_nop 0
    v_mul_f32 v13, v13, v11
    v_cvt_pk_bf16_f32 v13, v13, v13
    v_lshlrev_b32 v11, 16, v13

    v_lshlrev_b32 v12, 16, v12
    v_mul_f32 v13, s24, v12
    v_exp_f32 v13, v13
    s_nop 0
    v_add_f32 v13, 1.0, v13
    v_rcp_f32 v13, v13
    s_nop 0
    v_mul_f32 v13, v13, v12
    v_cvt_pk_bf16_f32 v13, v13, v13
    v_lshlrev_b32 v12, 16, v13

    s_lshl_b32 s3, s2, 8
    v_lshlrev_b32 v5, 2, v1
    v_add_u32 v5, s3, v5
    v_readfirstlane_b32 s25, v3
    v_mov_b32 v6, 0
    v_mov_b32 v7, 0
    s_nop 3
    s_mul_i32 s25, s25, 6912

    s_add_u32 s30, s25, 0
    s_add_u32 s31, s25, 6912
    s_add_u32 s32, s25, 13824
    s_add_u32 s33, s25, 20736
    s_add_u32 s34, s25, 27648
    s_add_u32 s35, s25, 34560
    s_add_u32 s36, s25, 41472
    s_add_u32 s37, s25, 48384
    s_add_u32 s38, s25, 55296
    s_add_u32 s39, s25, 62208
    s_add_u32 s40, s25, 69120
    s_add_u32 s41, s25, 76032
    s_add_u32 s42, s25, 82944
    s_add_u32 s43, s25, 89856
    s_add_u32 s44, s25, 96768
    s_add_u32 s45, s25, 103680
    s_nop 0
    buffer_load_dword v20, v5, s[16:19], s30 offen
    buffer_load_dword v21, v5, s[16:19], s31 offen
    buffer_load_dword v22, v5, s[16:19], s32 offen
    buffer_load_dword v23, v5, s[16:19], s33 offen
    buffer_load_dword v24, v5, s[16:19], s34 offen
    buffer_load_dword v25, v5, s[16:19], s35 offen
    buffer_load_dword v26, v5, s[16:19], s36 offen
    buffer_load_dword v27, v5, s[16:19], s37 offen
    buffer_load_dword v28, v5, s[16:19], s38 offen
    buffer_load_dword v29, v5, s[16:19], s39 offen
    buffer_load_dword v30, v5, s[16:19], s40 offen
    buffer_load_dword v31, v5, s[16:19], s41 offen
    buffer_load_dword v32, v5, s[16:19], s42 offen
    buffer_load_dword v33, v5, s[16:19], s43 offen
    buffer_load_dword v34, v5, s[16:19], s44 offen
    buffer_load_dword v35, v5, s[16:19], s45 offen
    v_readlane_b32 s50, v10, 0
    v_readlane_b32 s51, v10, 1
    v_readlane_b32 s52, v10, 2
    v_readlane_b32 s53, v10, 3
    v_readlane_b32 s54, v10, 4
    v_readlane_b32 s55, v10, 5
    v_readlane_b32 s56, v10, 6
    v_readlane_b32 s57, v10, 7
    v_readlane_b32 s58, v10, 8
    v_readlane_b32 s59, v10, 9
    v_readlane_b32 s60, v10, 10
    v_readlane_b32 s61, v10, 11
    v_readlane_b32 s62, v10, 12
    v_readlane_b32 s63, v10, 13
    v_readlane_b32 s64, v10, 14
    v_readlane_b32 s65, v10, 15
    s_waitcnt vmcnt(0)
    v_lshlrev_b32 v40, 16, v20
    v_and_b32 v41, 0xffff0000, v20
    v_fmac_f32 v6, s50, v40
    v_fmac_f32 v7, s50, v41

    v_lshlrev_b32 v40, 16, v21
    v_and_b32 v41, 0xffff0000, v21
    v_fmac_f32 v6, s51, v40
    v_fmac_f32 v7, s51, v41

    v_lshlrev_b32 v40, 16, v22
    v_and_b32 v41, 0xffff0000, v22
    v_fmac_f32 v6, s52, v40
    v_fmac_f32 v7, s52, v41

    v_lshlrev_b32 v40, 16, v23
    v_and_b32 v41, 0xffff0000, v23
    v_fmac_f32 v6, s53, v40
    v_fmac_f32 v7, s53, v41

    v_lshlrev_b32 v40, 16, v24
    v_and_b32 v41, 0xffff0000, v24
    v_fmac_f32 v6, s54, v40
    v_fmac_f32 v7, s54, v41

    v_lshlrev_b32 v40, 16, v25
    v_and_b32 v41, 0xffff0000, v25
    v_fmac_f32 v6, s55, v40
    v_fmac_f32 v7, s55, v41

    v_lshlrev_b32 v40, 16, v26
    v_and_b32 v41, 0xffff0000, v26
    v_fmac_f32 v6, s56, v40
    v_fmac_f32 v7, s56, v41

    v_lshlrev_b32 v40, 16, v27
    v_and_b32 v41, 0xffff0000, v27
    v_fmac_f32 v6, s57, v40
    v_fmac_f32 v7, s57, v41

    v_lshlrev_b32 v40, 16, v28
    v_and_b32 v41, 0xffff0000, v28
    v_fmac_f32 v6, s58, v40
    v_fmac_f32 v7, s58, v41

    v_lshlrev_b32 v40, 16, v29
    v_and_b32 v41, 0xffff0000, v29
    v_fmac_f32 v6, s59, v40
    v_fmac_f32 v7, s59, v41

    v_lshlrev_b32 v40, 16, v30
    v_and_b32 v41, 0xffff0000, v30
    v_fmac_f32 v6, s60, v40
    v_fmac_f32 v7, s60, v41

    v_lshlrev_b32 v40, 16, v31
    v_and_b32 v41, 0xffff0000, v31
    v_fmac_f32 v6, s61, v40
    v_fmac_f32 v7, s61, v41

    v_lshlrev_b32 v40, 16, v32
    v_and_b32 v41, 0xffff0000, v32
    v_fmac_f32 v6, s62, v40
    v_fmac_f32 v7, s62, v41

    v_lshlrev_b32 v40, 16, v33
    v_and_b32 v41, 0xffff0000, v33
    v_fmac_f32 v6, s63, v40
    v_fmac_f32 v7, s63, v41

    v_lshlrev_b32 v40, 16, v34
    v_and_b32 v41, 0xffff0000, v34
    v_fmac_f32 v6, s64, v40
    v_fmac_f32 v7, s64, v41

    v_lshlrev_b32 v40, 16, v35
    v_and_b32 v41, 0xffff0000, v35
    v_fmac_f32 v6, s65, v40
    v_fmac_f32 v7, s65, v41

    s_add_u32 s30, s25, 110592
    s_add_u32 s31, s25, 117504
    s_add_u32 s32, s25, 124416
    s_add_u32 s33, s25, 131328
    s_add_u32 s34, s25, 138240
    s_add_u32 s35, s25, 145152
    s_add_u32 s36, s25, 152064
    s_add_u32 s37, s25, 158976
    s_add_u32 s38, s25, 165888
    s_add_u32 s39, s25, 172800
    s_add_u32 s40, s25, 179712
    s_add_u32 s41, s25, 186624
    s_add_u32 s42, s25, 193536
    s_add_u32 s43, s25, 200448
    s_add_u32 s44, s25, 207360
    s_add_u32 s45, s25, 214272
    s_nop 0
    buffer_load_dword v20, v5, s[16:19], s30 offen
    buffer_load_dword v21, v5, s[16:19], s31 offen
    buffer_load_dword v22, v5, s[16:19], s32 offen
    buffer_load_dword v23, v5, s[16:19], s33 offen
    buffer_load_dword v24, v5, s[16:19], s34 offen
    buffer_load_dword v25, v5, s[16:19], s35 offen
    buffer_load_dword v26, v5, s[16:19], s36 offen
    buffer_load_dword v27, v5, s[16:19], s37 offen
    buffer_load_dword v28, v5, s[16:19], s38 offen
    buffer_load_dword v29, v5, s[16:19], s39 offen
    buffer_load_dword v30, v5, s[16:19], s40 offen
    buffer_load_dword v31, v5, s[16:19], s41 offen
    buffer_load_dword v32, v5, s[16:19], s42 offen
    buffer_load_dword v33, v5, s[16:19], s43 offen
    buffer_load_dword v34, v5, s[16:19], s44 offen
    buffer_load_dword v35, v5, s[16:19], s45 offen
    v_readlane_b32 s50, v10, 16
    v_readlane_b32 s51, v10, 17
    v_readlane_b32 s52, v10, 18
    v_readlane_b32 s53, v10, 19
    v_readlane_b32 s54, v10, 20
    v_readlane_b32 s55, v10, 21
    v_readlane_b32 s56, v10, 22
    v_readlane_b32 s57, v10, 23
    v_readlane_b32 s58, v10, 24
    v_readlane_b32 s59, v10, 25
    v_readlane_b32 s60, v10, 26
    v_readlane_b32 s61, v10, 27
    v_readlane_b32 s62, v10, 28
    v_readlane_b32 s63, v10, 29
    v_readlane_b32 s64, v10, 30
    v_readlane_b32 s65, v10, 31
    s_waitcnt vmcnt(0)
    v_lshlrev_b32 v40, 16, v20
    v_and_b32 v41, 0xffff0000, v20
    v_fmac_f32 v6, s50, v40
    v_fmac_f32 v7, s50, v41

    v_lshlrev_b32 v40, 16, v21
    v_and_b32 v41, 0xffff0000, v21
    v_fmac_f32 v6, s51, v40
    v_fmac_f32 v7, s51, v41

    v_lshlrev_b32 v40, 16, v22
    v_and_b32 v41, 0xffff0000, v22
    v_fmac_f32 v6, s52, v40
    v_fmac_f32 v7, s52, v41

    v_lshlrev_b32 v40, 16, v23
    v_and_b32 v41, 0xffff0000, v23
    v_fmac_f32 v6, s53, v40
    v_fmac_f32 v7, s53, v41

    v_lshlrev_b32 v40, 16, v24
    v_and_b32 v41, 0xffff0000, v24
    v_fmac_f32 v6, s54, v40
    v_fmac_f32 v7, s54, v41

    v_lshlrev_b32 v40, 16, v25
    v_and_b32 v41, 0xffff0000, v25
    v_fmac_f32 v6, s55, v40
    v_fmac_f32 v7, s55, v41

    v_lshlrev_b32 v40, 16, v26
    v_and_b32 v41, 0xffff0000, v26
    v_fmac_f32 v6, s56, v40
    v_fmac_f32 v7, s56, v41

    v_lshlrev_b32 v40, 16, v27
    v_and_b32 v41, 0xffff0000, v27
    v_fmac_f32 v6, s57, v40
    v_fmac_f32 v7, s57, v41

    v_lshlrev_b32 v40, 16, v28
    v_and_b32 v41, 0xffff0000, v28
    v_fmac_f32 v6, s58, v40
    v_fmac_f32 v7, s58, v41

    v_lshlrev_b32 v40, 16, v29
    v_and_b32 v41, 0xffff0000, v29
    v_fmac_f32 v6, s59, v40
    v_fmac_f32 v7, s59, v41

    v_lshlrev_b32 v40, 16, v30
    v_and_b32 v41, 0xffff0000, v30
    v_fmac_f32 v6, s60, v40
    v_fmac_f32 v7, s60, v41

    v_lshlrev_b32 v40, 16, v31
    v_and_b32 v41, 0xffff0000, v31
    v_fmac_f32 v6, s61, v40
    v_fmac_f32 v7, s61, v41

    v_lshlrev_b32 v40, 16, v32
    v_and_b32 v41, 0xffff0000, v32
    v_fmac_f32 v6, s62, v40
    v_fmac_f32 v7, s62, v41

    v_lshlrev_b32 v40, 16, v33
    v_and_b32 v41, 0xffff0000, v33
    v_fmac_f32 v6, s63, v40
    v_fmac_f32 v7, s63, v41

    v_lshlrev_b32 v40, 16, v34
    v_and_b32 v41, 0xffff0000, v34
    v_fmac_f32 v6, s64, v40
    v_fmac_f32 v7, s64, v41

    v_lshlrev_b32 v40, 16, v35
    v_and_b32 v41, 0xffff0000, v35
    v_fmac_f32 v6, s65, v40
    v_fmac_f32 v7, s65, v41

    s_add_u32 s30, s25, 221184
    s_add_u32 s31, s25, 228096
    s_add_u32 s32, s25, 235008
    s_add_u32 s33, s25, 241920
    s_add_u32 s34, s25, 248832
    s_add_u32 s35, s25, 255744
    s_add_u32 s36, s25, 262656
    s_add_u32 s37, s25, 269568
    s_add_u32 s38, s25, 276480
    s_add_u32 s39, s25, 283392
    s_add_u32 s40, s25, 290304
    s_add_u32 s41, s25, 297216
    s_add_u32 s42, s25, 304128
    s_add_u32 s43, s25, 311040
    s_add_u32 s44, s25, 317952
    s_add_u32 s45, s25, 324864
    s_nop 0
    buffer_load_dword v20, v5, s[16:19], s30 offen
    buffer_load_dword v21, v5, s[16:19], s31 offen
    buffer_load_dword v22, v5, s[16:19], s32 offen
    buffer_load_dword v23, v5, s[16:19], s33 offen
    buffer_load_dword v24, v5, s[16:19], s34 offen
    buffer_load_dword v25, v5, s[16:19], s35 offen
    buffer_load_dword v26, v5, s[16:19], s36 offen
    buffer_load_dword v27, v5, s[16:19], s37 offen
    buffer_load_dword v28, v5, s[16:19], s38 offen
    buffer_load_dword v29, v5, s[16:19], s39 offen
    buffer_load_dword v30, v5, s[16:19], s40 offen
    buffer_load_dword v31, v5, s[16:19], s41 offen
    buffer_load_dword v32, v5, s[16:19], s42 offen
    buffer_load_dword v33, v5, s[16:19], s43 offen
    buffer_load_dword v34, v5, s[16:19], s44 offen
    buffer_load_dword v35, v5, s[16:19], s45 offen
    v_readlane_b32 s50, v10, 32
    v_readlane_b32 s51, v10, 33
    v_readlane_b32 s52, v10, 34
    v_readlane_b32 s53, v10, 35
    v_readlane_b32 s54, v10, 36
    v_readlane_b32 s55, v10, 37
    v_readlane_b32 s56, v10, 38
    v_readlane_b32 s57, v10, 39
    v_readlane_b32 s58, v10, 40
    v_readlane_b32 s59, v10, 41
    v_readlane_b32 s60, v10, 42
    v_readlane_b32 s61, v10, 43
    v_readlane_b32 s62, v10, 44
    v_readlane_b32 s63, v10, 45
    v_readlane_b32 s64, v10, 46
    v_readlane_b32 s65, v10, 47
    s_waitcnt vmcnt(0)
    v_lshlrev_b32 v40, 16, v20
    v_and_b32 v41, 0xffff0000, v20
    v_fmac_f32 v6, s50, v40
    v_fmac_f32 v7, s50, v41

    v_lshlrev_b32 v40, 16, v21
    v_and_b32 v41, 0xffff0000, v21
    v_fmac_f32 v6, s51, v40
    v_fmac_f32 v7, s51, v41

    v_lshlrev_b32 v40, 16, v22
    v_and_b32 v41, 0xffff0000, v22
    v_fmac_f32 v6, s52, v40
    v_fmac_f32 v7, s52, v41

    v_lshlrev_b32 v40, 16, v23
    v_and_b32 v41, 0xffff0000, v23
    v_fmac_f32 v6, s53, v40
    v_fmac_f32 v7, s53, v41

    v_lshlrev_b32 v40, 16, v24
    v_and_b32 v41, 0xffff0000, v24
    v_fmac_f32 v6, s54, v40
    v_fmac_f32 v7, s54, v41

    v_lshlrev_b32 v40, 16, v25
    v_and_b32 v41, 0xffff0000, v25
    v_fmac_f32 v6, s55, v40
    v_fmac_f32 v7, s55, v41

    v_lshlrev_b32 v40, 16, v26
    v_and_b32 v41, 0xffff0000, v26
    v_fmac_f32 v6, s56, v40
    v_fmac_f32 v7, s56, v41

    v_lshlrev_b32 v40, 16, v27
    v_and_b32 v41, 0xffff0000, v27
    v_fmac_f32 v6, s57, v40
    v_fmac_f32 v7, s57, v41

    v_lshlrev_b32 v40, 16, v28
    v_and_b32 v41, 0xffff0000, v28
    v_fmac_f32 v6, s58, v40
    v_fmac_f32 v7, s58, v41

    v_lshlrev_b32 v40, 16, v29
    v_and_b32 v41, 0xffff0000, v29
    v_fmac_f32 v6, s59, v40
    v_fmac_f32 v7, s59, v41

    v_lshlrev_b32 v40, 16, v30
    v_and_b32 v41, 0xffff0000, v30
    v_fmac_f32 v6, s60, v40
    v_fmac_f32 v7, s60, v41

    v_lshlrev_b32 v40, 16, v31
    v_and_b32 v41, 0xffff0000, v31
    v_fmac_f32 v6, s61, v40
    v_fmac_f32 v7, s61, v41

    v_lshlrev_b32 v40, 16, v32
    v_and_b32 v41, 0xffff0000, v32
    v_fmac_f32 v6, s62, v40
    v_fmac_f32 v7, s62, v41

    v_lshlrev_b32 v40, 16, v33
    v_and_b32 v41, 0xffff0000, v33
    v_fmac_f32 v6, s63, v40
    v_fmac_f32 v7, s63, v41

    v_lshlrev_b32 v40, 16, v34
    v_and_b32 v41, 0xffff0000, v34
    v_fmac_f32 v6, s64, v40
    v_fmac_f32 v7, s64, v41

    v_lshlrev_b32 v40, 16, v35
    v_and_b32 v41, 0xffff0000, v35
    v_fmac_f32 v6, s65, v40
    v_fmac_f32 v7, s65, v41

    s_add_u32 s30, s25, 331776
    s_add_u32 s31, s25, 338688
    s_add_u32 s32, s25, 345600
    s_add_u32 s33, s25, 352512
    s_add_u32 s34, s25, 359424
    s_add_u32 s35, s25, 366336
    s_add_u32 s36, s25, 373248
    s_add_u32 s37, s25, 380160
    s_add_u32 s38, s25, 387072
    s_add_u32 s39, s25, 393984
    s_add_u32 s40, s25, 400896
    s_add_u32 s41, s25, 407808
    s_add_u32 s42, s25, 414720
    s_add_u32 s43, s25, 421632
    s_add_u32 s44, s25, 428544
    s_add_u32 s45, s25, 435456
    s_nop 0
    buffer_load_dword v20, v5, s[16:19], s30 offen
    buffer_load_dword v21, v5, s[16:19], s31 offen
    buffer_load_dword v22, v5, s[16:19], s32 offen
    buffer_load_dword v23, v5, s[16:19], s33 offen
    buffer_load_dword v24, v5, s[16:19], s34 offen
    buffer_load_dword v25, v5, s[16:19], s35 offen
    buffer_load_dword v26, v5, s[16:19], s36 offen
    buffer_load_dword v27, v5, s[16:19], s37 offen
    buffer_load_dword v28, v5, s[16:19], s38 offen
    buffer_load_dword v29, v5, s[16:19], s39 offen
    buffer_load_dword v30, v5, s[16:19], s40 offen
    buffer_load_dword v31, v5, s[16:19], s41 offen
    buffer_load_dword v32, v5, s[16:19], s42 offen
    buffer_load_dword v33, v5, s[16:19], s43 offen
    buffer_load_dword v34, v5, s[16:19], s44 offen
    buffer_load_dword v35, v5, s[16:19], s45 offen
    v_readlane_b32 s50, v10, 48
    v_readlane_b32 s51, v10, 49
    v_readlane_b32 s52, v10, 50
    v_readlane_b32 s53, v10, 51
    v_readlane_b32 s54, v10, 52
    v_readlane_b32 s55, v10, 53
    v_readlane_b32 s56, v10, 54
    v_readlane_b32 s57, v10, 55
    v_readlane_b32 s58, v10, 56
    v_readlane_b32 s59, v10, 57
    v_readlane_b32 s60, v10, 58
    v_readlane_b32 s61, v10, 59
    v_readlane_b32 s62, v10, 60
    v_readlane_b32 s63, v10, 61
    v_readlane_b32 s64, v10, 62
    v_readlane_b32 s65, v10, 63
    s_waitcnt vmcnt(0)
    v_lshlrev_b32 v40, 16, v20
    v_and_b32 v41, 0xffff0000, v20
    v_fmac_f32 v6, s50, v40
    v_fmac_f32 v7, s50, v41

    v_lshlrev_b32 v40, 16, v21
    v_and_b32 v41, 0xffff0000, v21
    v_fmac_f32 v6, s51, v40
    v_fmac_f32 v7, s51, v41

    v_lshlrev_b32 v40, 16, v22
    v_and_b32 v41, 0xffff0000, v22
    v_fmac_f32 v6, s52, v40
    v_fmac_f32 v7, s52, v41

    v_lshlrev_b32 v40, 16, v23
    v_and_b32 v41, 0xffff0000, v23
    v_fmac_f32 v6, s53, v40
    v_fmac_f32 v7, s53, v41

    v_lshlrev_b32 v40, 16, v24
    v_and_b32 v41, 0xffff0000, v24
    v_fmac_f32 v6, s54, v40
    v_fmac_f32 v7, s54, v41

    v_lshlrev_b32 v40, 16, v25
    v_and_b32 v41, 0xffff0000, v25
    v_fmac_f32 v6, s55, v40
    v_fmac_f32 v7, s55, v41

    v_lshlrev_b32 v40, 16, v26
    v_and_b32 v41, 0xffff0000, v26
    v_fmac_f32 v6, s56, v40
    v_fmac_f32 v7, s56, v41

    v_lshlrev_b32 v40, 16, v27
    v_and_b32 v41, 0xffff0000, v27
    v_fmac_f32 v6, s57, v40
    v_fmac_f32 v7, s57, v41

    v_lshlrev_b32 v40, 16, v28
    v_and_b32 v41, 0xffff0000, v28
    v_fmac_f32 v6, s58, v40
    v_fmac_f32 v7, s58, v41

    v_lshlrev_b32 v40, 16, v29
    v_and_b32 v41, 0xffff0000, v29
    v_fmac_f32 v6, s59, v40
    v_fmac_f32 v7, s59, v41

    v_lshlrev_b32 v40, 16, v30
    v_and_b32 v41, 0xffff0000, v30
    v_fmac_f32 v6, s60, v40
    v_fmac_f32 v7, s60, v41

    v_lshlrev_b32 v40, 16, v31
    v_and_b32 v41, 0xffff0000, v31
    v_fmac_f32 v6, s61, v40
    v_fmac_f32 v7, s61, v41

    v_lshlrev_b32 v40, 16, v32
    v_and_b32 v41, 0xffff0000, v32
    v_fmac_f32 v6, s62, v40
    v_fmac_f32 v7, s62, v41

    v_lshlrev_b32 v40, 16, v33
    v_and_b32 v41, 0xffff0000, v33
    v_fmac_f32 v6, s63, v40
    v_fmac_f32 v7, s63, v41

    v_lshlrev_b32 v40, 16, v34
    v_and_b32 v41, 0xffff0000, v34
    v_fmac_f32 v6, s64, v40
    v_fmac_f32 v7, s64, v41

    v_lshlrev_b32 v40, 16, v35
    v_and_b32 v41, 0xffff0000, v35
    v_fmac_f32 v6, s65, v40
    v_fmac_f32 v7, s65, v41

    s_add_u32 s30, s25, 442368
    s_add_u32 s31, s25, 449280
    s_add_u32 s32, s25, 456192
    s_add_u32 s33, s25, 463104
    s_add_u32 s34, s25, 470016
    s_add_u32 s35, s25, 476928
    s_add_u32 s36, s25, 483840
    s_add_u32 s37, s25, 490752
    s_add_u32 s38, s25, 497664
    s_add_u32 s39, s25, 504576
    s_add_u32 s40, s25, 511488
    s_add_u32 s41, s25, 518400
    s_add_u32 s42, s25, 525312
    s_add_u32 s43, s25, 532224
    s_add_u32 s44, s25, 539136
    s_add_u32 s45, s25, 546048
    s_nop 0
    buffer_load_dword v20, v5, s[16:19], s30 offen
    buffer_load_dword v21, v5, s[16:19], s31 offen
    buffer_load_dword v22, v5, s[16:19], s32 offen
    buffer_load_dword v23, v5, s[16:19], s33 offen
    buffer_load_dword v24, v5, s[16:19], s34 offen
    buffer_load_dword v25, v5, s[16:19], s35 offen
    buffer_load_dword v26, v5, s[16:19], s36 offen
    buffer_load_dword v27, v5, s[16:19], s37 offen
    buffer_load_dword v28, v5, s[16:19], s38 offen
    buffer_load_dword v29, v5, s[16:19], s39 offen
    buffer_load_dword v30, v5, s[16:19], s40 offen
    buffer_load_dword v31, v5, s[16:19], s41 offen
    buffer_load_dword v32, v5, s[16:19], s42 offen
    buffer_load_dword v33, v5, s[16:19], s43 offen
    buffer_load_dword v34, v5, s[16:19], s44 offen
    buffer_load_dword v35, v5, s[16:19], s45 offen
    v_readlane_b32 s50, v11, 0
    v_readlane_b32 s51, v11, 1
    v_readlane_b32 s52, v11, 2
    v_readlane_b32 s53, v11, 3
    v_readlane_b32 s54, v11, 4
    v_readlane_b32 s55, v11, 5
    v_readlane_b32 s56, v11, 6
    v_readlane_b32 s57, v11, 7
    v_readlane_b32 s58, v11, 8
    v_readlane_b32 s59, v11, 9
    v_readlane_b32 s60, v11, 10
    v_readlane_b32 s61, v11, 11
    v_readlane_b32 s62, v11, 12
    v_readlane_b32 s63, v11, 13
    v_readlane_b32 s64, v11, 14
    v_readlane_b32 s65, v11, 15
    s_waitcnt vmcnt(0)
    v_lshlrev_b32 v40, 16, v20
    v_and_b32 v41, 0xffff0000, v20
    v_fmac_f32 v6, s50, v40
    v_fmac_f32 v7, s50, v41

    v_lshlrev_b32 v40, 16, v21
    v_and_b32 v41, 0xffff0000, v21
    v_fmac_f32 v6, s51, v40
    v_fmac_f32 v7, s51, v41

    v_lshlrev_b32 v40, 16, v22
    v_and_b32 v41, 0xffff0000, v22
    v_fmac_f32 v6, s52, v40
    v_fmac_f32 v7, s52, v41

    v_lshlrev_b32 v40, 16, v23
    v_and_b32 v41, 0xffff0000, v23
    v_fmac_f32 v6, s53, v40
    v_fmac_f32 v7, s53, v41

    v_lshlrev_b32 v40, 16, v24
    v_and_b32 v41, 0xffff0000, v24
    v_fmac_f32 v6, s54, v40
    v_fmac_f32 v7, s54, v41

    v_lshlrev_b32 v40, 16, v25
    v_and_b32 v41, 0xffff0000, v25
    v_fmac_f32 v6, s55, v40
    v_fmac_f32 v7, s55, v41

    v_lshlrev_b32 v40, 16, v26
    v_and_b32 v41, 0xffff0000, v26
    v_fmac_f32 v6, s56, v40
    v_fmac_f32 v7, s56, v41

    v_lshlrev_b32 v40, 16, v27
    v_and_b32 v41, 0xffff0000, v27
    v_fmac_f32 v6, s57, v40
    v_fmac_f32 v7, s57, v41

    v_lshlrev_b32 v40, 16, v28
    v_and_b32 v41, 0xffff0000, v28
    v_fmac_f32 v6, s58, v40
    v_fmac_f32 v7, s58, v41

    v_lshlrev_b32 v40, 16, v29
    v_and_b32 v41, 0xffff0000, v29
    v_fmac_f32 v6, s59, v40
    v_fmac_f32 v7, s59, v41

    v_lshlrev_b32 v40, 16, v30
    v_and_b32 v41, 0xffff0000, v30
    v_fmac_f32 v6, s60, v40
    v_fmac_f32 v7, s60, v41

    v_lshlrev_b32 v40, 16, v31
    v_and_b32 v41, 0xffff0000, v31
    v_fmac_f32 v6, s61, v40
    v_fmac_f32 v7, s61, v41

    v_lshlrev_b32 v40, 16, v32
    v_and_b32 v41, 0xffff0000, v32
    v_fmac_f32 v6, s62, v40
    v_fmac_f32 v7, s62, v41

    v_lshlrev_b32 v40, 16, v33
    v_and_b32 v41, 0xffff0000, v33
    v_fmac_f32 v6, s63, v40
    v_fmac_f32 v7, s63, v41

    v_lshlrev_b32 v40, 16, v34
    v_and_b32 v41, 0xffff0000, v34
    v_fmac_f32 v6, s64, v40
    v_fmac_f32 v7, s64, v41

    v_lshlrev_b32 v40, 16, v35
    v_and_b32 v41, 0xffff0000, v35
    v_fmac_f32 v6, s65, v40
    v_fmac_f32 v7, s65, v41

    s_add_u32 s30, s25, 552960
    s_add_u32 s31, s25, 559872
    s_add_u32 s32, s25, 566784
    s_add_u32 s33, s25, 573696
    s_add_u32 s34, s25, 580608
    s_add_u32 s35, s25, 587520
    s_add_u32 s36, s25, 594432
    s_add_u32 s37, s25, 601344
    s_add_u32 s38, s25, 608256
    s_add_u32 s39, s25, 615168
    s_add_u32 s40, s25, 622080
    s_add_u32 s41, s25, 628992
    s_add_u32 s42, s25, 635904
    s_add_u32 s43, s25, 642816
    s_add_u32 s44, s25, 649728
    s_add_u32 s45, s25, 656640
    s_nop 0
    buffer_load_dword v20, v5, s[16:19], s30 offen
    buffer_load_dword v21, v5, s[16:19], s31 offen
    buffer_load_dword v22, v5, s[16:19], s32 offen
    buffer_load_dword v23, v5, s[16:19], s33 offen
    buffer_load_dword v24, v5, s[16:19], s34 offen
    buffer_load_dword v25, v5, s[16:19], s35 offen
    buffer_load_dword v26, v5, s[16:19], s36 offen
    buffer_load_dword v27, v5, s[16:19], s37 offen
    buffer_load_dword v28, v5, s[16:19], s38 offen
    buffer_load_dword v29, v5, s[16:19], s39 offen
    buffer_load_dword v30, v5, s[16:19], s40 offen
    buffer_load_dword v31, v5, s[16:19], s41 offen
    buffer_load_dword v32, v5, s[16:19], s42 offen
    buffer_load_dword v33, v5, s[16:19], s43 offen
    buffer_load_dword v34, v5, s[16:19], s44 offen
    buffer_load_dword v35, v5, s[16:19], s45 offen
    v_readlane_b32 s50, v11, 16
    v_readlane_b32 s51, v11, 17
    v_readlane_b32 s52, v11, 18
    v_readlane_b32 s53, v11, 19
    v_readlane_b32 s54, v11, 20
    v_readlane_b32 s55, v11, 21
    v_readlane_b32 s56, v11, 22
    v_readlane_b32 s57, v11, 23
    v_readlane_b32 s58, v11, 24
    v_readlane_b32 s59, v11, 25
    v_readlane_b32 s60, v11, 26
    v_readlane_b32 s61, v11, 27
    v_readlane_b32 s62, v11, 28
    v_readlane_b32 s63, v11, 29
    v_readlane_b32 s64, v11, 30
    v_readlane_b32 s65, v11, 31
    s_waitcnt vmcnt(0)
    v_lshlrev_b32 v40, 16, v20
    v_and_b32 v41, 0xffff0000, v20
    v_fmac_f32 v6, s50, v40
    v_fmac_f32 v7, s50, v41

    v_lshlrev_b32 v40, 16, v21
    v_and_b32 v41, 0xffff0000, v21
    v_fmac_f32 v6, s51, v40
    v_fmac_f32 v7, s51, v41

    v_lshlrev_b32 v40, 16, v22
    v_and_b32 v41, 0xffff0000, v22
    v_fmac_f32 v6, s52, v40
    v_fmac_f32 v7, s52, v41

    v_lshlrev_b32 v40, 16, v23
    v_and_b32 v41, 0xffff0000, v23
    v_fmac_f32 v6, s53, v40
    v_fmac_f32 v7, s53, v41

    v_lshlrev_b32 v40, 16, v24
    v_and_b32 v41, 0xffff0000, v24
    v_fmac_f32 v6, s54, v40
    v_fmac_f32 v7, s54, v41

    v_lshlrev_b32 v40, 16, v25
    v_and_b32 v41, 0xffff0000, v25
    v_fmac_f32 v6, s55, v40
    v_fmac_f32 v7, s55, v41

    v_lshlrev_b32 v40, 16, v26
    v_and_b32 v41, 0xffff0000, v26
    v_fmac_f32 v6, s56, v40
    v_fmac_f32 v7, s56, v41

    v_lshlrev_b32 v40, 16, v27
    v_and_b32 v41, 0xffff0000, v27
    v_fmac_f32 v6, s57, v40
    v_fmac_f32 v7, s57, v41

    v_lshlrev_b32 v40, 16, v28
    v_and_b32 v41, 0xffff0000, v28
    v_fmac_f32 v6, s58, v40
    v_fmac_f32 v7, s58, v41

    v_lshlrev_b32 v40, 16, v29
    v_and_b32 v41, 0xffff0000, v29
    v_fmac_f32 v6, s59, v40
    v_fmac_f32 v7, s59, v41

    v_lshlrev_b32 v40, 16, v30
    v_and_b32 v41, 0xffff0000, v30
    v_fmac_f32 v6, s60, v40
    v_fmac_f32 v7, s60, v41

    v_lshlrev_b32 v40, 16, v31
    v_and_b32 v41, 0xffff0000, v31
    v_fmac_f32 v6, s61, v40
    v_fmac_f32 v7, s61, v41

    v_lshlrev_b32 v40, 16, v32
    v_and_b32 v41, 0xffff0000, v32
    v_fmac_f32 v6, s62, v40
    v_fmac_f32 v7, s62, v41

    v_lshlrev_b32 v40, 16, v33
    v_and_b32 v41, 0xffff0000, v33
    v_fmac_f32 v6, s63, v40
    v_fmac_f32 v7, s63, v41

    v_lshlrev_b32 v40, 16, v34
    v_and_b32 v41, 0xffff0000, v34
    v_fmac_f32 v6, s64, v40
    v_fmac_f32 v7, s64, v41

    v_lshlrev_b32 v40, 16, v35
    v_and_b32 v41, 0xffff0000, v35
    v_fmac_f32 v6, s65, v40
    v_fmac_f32 v7, s65, v41

    s_add_u32 s30, s25, 663552
    s_add_u32 s31, s25, 670464
    s_add_u32 s32, s25, 677376
    s_add_u32 s33, s25, 684288
    s_add_u32 s34, s25, 691200
    s_add_u32 s35, s25, 698112
    s_add_u32 s36, s25, 705024
    s_add_u32 s37, s25, 711936
    s_add_u32 s38, s25, 718848
    s_add_u32 s39, s25, 725760
    s_add_u32 s40, s25, 732672
    s_add_u32 s41, s25, 739584
    s_add_u32 s42, s25, 746496
    s_add_u32 s43, s25, 753408
    s_add_u32 s44, s25, 760320
    s_add_u32 s45, s25, 767232
    s_nop 0
    buffer_load_dword v20, v5, s[16:19], s30 offen
    buffer_load_dword v21, v5, s[16:19], s31 offen
    buffer_load_dword v22, v5, s[16:19], s32 offen
    buffer_load_dword v23, v5, s[16:19], s33 offen
    buffer_load_dword v24, v5, s[16:19], s34 offen
    buffer_load_dword v25, v5, s[16:19], s35 offen
    buffer_load_dword v26, v5, s[16:19], s36 offen
    buffer_load_dword v27, v5, s[16:19], s37 offen
    buffer_load_dword v28, v5, s[16:19], s38 offen
    buffer_load_dword v29, v5, s[16:19], s39 offen
    buffer_load_dword v30, v5, s[16:19], s40 offen
    buffer_load_dword v31, v5, s[16:19], s41 offen
    buffer_load_dword v32, v5, s[16:19], s42 offen
    buffer_load_dword v33, v5, s[16:19], s43 offen
    buffer_load_dword v34, v5, s[16:19], s44 offen
    buffer_load_dword v35, v5, s[16:19], s45 offen
    v_readlane_b32 s50, v11, 32
    v_readlane_b32 s51, v11, 33
    v_readlane_b32 s52, v11, 34
    v_readlane_b32 s53, v11, 35
    v_readlane_b32 s54, v11, 36
    v_readlane_b32 s55, v11, 37
    v_readlane_b32 s56, v11, 38
    v_readlane_b32 s57, v11, 39
    v_readlane_b32 s58, v11, 40
    v_readlane_b32 s59, v11, 41
    v_readlane_b32 s60, v11, 42
    v_readlane_b32 s61, v11, 43
    v_readlane_b32 s62, v11, 44
    v_readlane_b32 s63, v11, 45
    v_readlane_b32 s64, v11, 46
    v_readlane_b32 s65, v11, 47
    s_waitcnt vmcnt(0)
    v_lshlrev_b32 v40, 16, v20
    v_and_b32 v41, 0xffff0000, v20
    v_fmac_f32 v6, s50, v40
    v_fmac_f32 v7, s50, v41

    v_lshlrev_b32 v40, 16, v21
    v_and_b32 v41, 0xffff0000, v21
    v_fmac_f32 v6, s51, v40
    v_fmac_f32 v7, s51, v41

    v_lshlrev_b32 v40, 16, v22
    v_and_b32 v41, 0xffff0000, v22
    v_fmac_f32 v6, s52, v40
    v_fmac_f32 v7, s52, v41

    v_lshlrev_b32 v40, 16, v23
    v_and_b32 v41, 0xffff0000, v23
    v_fmac_f32 v6, s53, v40
    v_fmac_f32 v7, s53, v41

    v_lshlrev_b32 v40, 16, v24
    v_and_b32 v41, 0xffff0000, v24
    v_fmac_f32 v6, s54, v40
    v_fmac_f32 v7, s54, v41

    v_lshlrev_b32 v40, 16, v25
    v_and_b32 v41, 0xffff0000, v25
    v_fmac_f32 v6, s55, v40
    v_fmac_f32 v7, s55, v41

    v_lshlrev_b32 v40, 16, v26
    v_and_b32 v41, 0xffff0000, v26
    v_fmac_f32 v6, s56, v40
    v_fmac_f32 v7, s56, v41

    v_lshlrev_b32 v40, 16, v27
    v_and_b32 v41, 0xffff0000, v27
    v_fmac_f32 v6, s57, v40
    v_fmac_f32 v7, s57, v41

    v_lshlrev_b32 v40, 16, v28
    v_and_b32 v41, 0xffff0000, v28
    v_fmac_f32 v6, s58, v40
    v_fmac_f32 v7, s58, v41

    v_lshlrev_b32 v40, 16, v29
    v_and_b32 v41, 0xffff0000, v29
    v_fmac_f32 v6, s59, v40
    v_fmac_f32 v7, s59, v41

    v_lshlrev_b32 v40, 16, v30
    v_and_b32 v41, 0xffff0000, v30
    v_fmac_f32 v6, s60, v40
    v_fmac_f32 v7, s60, v41

    v_lshlrev_b32 v40, 16, v31
    v_and_b32 v41, 0xffff0000, v31
    v_fmac_f32 v6, s61, v40
    v_fmac_f32 v7, s61, v41

    v_lshlrev_b32 v40, 16, v32
    v_and_b32 v41, 0xffff0000, v32
    v_fmac_f32 v6, s62, v40
    v_fmac_f32 v7, s62, v41

    v_lshlrev_b32 v40, 16, v33
    v_and_b32 v41, 0xffff0000, v33
    v_fmac_f32 v6, s63, v40
    v_fmac_f32 v7, s63, v41

    v_lshlrev_b32 v40, 16, v34
    v_and_b32 v41, 0xffff0000, v34
    v_fmac_f32 v6, s64, v40
    v_fmac_f32 v7, s64, v41

    v_lshlrev_b32 v40, 16, v35
    v_and_b32 v41, 0xffff0000, v35
    v_fmac_f32 v6, s65, v40
    v_fmac_f32 v7, s65, v41

    s_add_u32 s30, s25, 774144
    s_add_u32 s31, s25, 781056
    s_add_u32 s32, s25, 787968
    s_add_u32 s33, s25, 794880
    s_add_u32 s34, s25, 801792
    s_add_u32 s35, s25, 808704
    s_add_u32 s36, s25, 815616
    s_add_u32 s37, s25, 822528
    s_add_u32 s38, s25, 829440
    s_add_u32 s39, s25, 836352
    s_add_u32 s40, s25, 843264
    s_add_u32 s41, s25, 850176
    s_add_u32 s42, s25, 857088
    s_add_u32 s43, s25, 864000
    s_add_u32 s44, s25, 870912
    s_add_u32 s45, s25, 877824
    s_nop 0
    buffer_load_dword v20, v5, s[16:19], s30 offen
    buffer_load_dword v21, v5, s[16:19], s31 offen
    buffer_load_dword v22, v5, s[16:19], s32 offen
    buffer_load_dword v23, v5, s[16:19], s33 offen
    buffer_load_dword v24, v5, s[16:19], s34 offen
    buffer_load_dword v25, v5, s[16:19], s35 offen
    buffer_load_dword v26, v5, s[16:19], s36 offen
    buffer_load_dword v27, v5, s[16:19], s37 offen
    buffer_load_dword v28, v5, s[16:19], s38 offen
    buffer_load_dword v29, v5, s[16:19], s39 offen
    buffer_load_dword v30, v5, s[16:19], s40 offen
    buffer_load_dword v31, v5, s[16:19], s41 offen
    buffer_load_dword v32, v5, s[16:19], s42 offen
    buffer_load_dword v33, v5, s[16:19], s43 offen
    buffer_load_dword v34, v5, s[16:19], s44 offen
    buffer_load_dword v35, v5, s[16:19], s45 offen
    v_readlane_b32 s50, v11, 48
    v_readlane_b32 s51, v11, 49
    v_readlane_b32 s52, v11, 50
    v_readlane_b32 s53, v11, 51
    v_readlane_b32 s54, v11, 52
    v_readlane_b32 s55, v11, 53
    v_readlane_b32 s56, v11, 54
    v_readlane_b32 s57, v11, 55
    v_readlane_b32 s58, v11, 56
    v_readlane_b32 s59, v11, 57
    v_readlane_b32 s60, v11, 58
    v_readlane_b32 s61, v11, 59
    v_readlane_b32 s62, v11, 60
    v_readlane_b32 s63, v11, 61
    v_readlane_b32 s64, v11, 62
    v_readlane_b32 s65, v11, 63
    s_waitcnt vmcnt(0)
    v_lshlrev_b32 v40, 16, v20
    v_and_b32 v41, 0xffff0000, v20
    v_fmac_f32 v6, s50, v40
    v_fmac_f32 v7, s50, v41

    v_lshlrev_b32 v40, 16, v21
    v_and_b32 v41, 0xffff0000, v21
    v_fmac_f32 v6, s51, v40
    v_fmac_f32 v7, s51, v41

    v_lshlrev_b32 v40, 16, v22
    v_and_b32 v41, 0xffff0000, v22
    v_fmac_f32 v6, s52, v40
    v_fmac_f32 v7, s52, v41

    v_lshlrev_b32 v40, 16, v23
    v_and_b32 v41, 0xffff0000, v23
    v_fmac_f32 v6, s53, v40
    v_fmac_f32 v7, s53, v41

    v_lshlrev_b32 v40, 16, v24
    v_and_b32 v41, 0xffff0000, v24
    v_fmac_f32 v6, s54, v40
    v_fmac_f32 v7, s54, v41

    v_lshlrev_b32 v40, 16, v25
    v_and_b32 v41, 0xffff0000, v25
    v_fmac_f32 v6, s55, v40
    v_fmac_f32 v7, s55, v41

    v_lshlrev_b32 v40, 16, v26
    v_and_b32 v41, 0xffff0000, v26
    v_fmac_f32 v6, s56, v40
    v_fmac_f32 v7, s56, v41

    v_lshlrev_b32 v40, 16, v27
    v_and_b32 v41, 0xffff0000, v27
    v_fmac_f32 v6, s57, v40
    v_fmac_f32 v7, s57, v41

    v_lshlrev_b32 v40, 16, v28
    v_and_b32 v41, 0xffff0000, v28
    v_fmac_f32 v6, s58, v40
    v_fmac_f32 v7, s58, v41

    v_lshlrev_b32 v40, 16, v29
    v_and_b32 v41, 0xffff0000, v29
    v_fmac_f32 v6, s59, v40
    v_fmac_f32 v7, s59, v41

    v_lshlrev_b32 v40, 16, v30
    v_and_b32 v41, 0xffff0000, v30
    v_fmac_f32 v6, s60, v40
    v_fmac_f32 v7, s60, v41

    v_lshlrev_b32 v40, 16, v31
    v_and_b32 v41, 0xffff0000, v31
    v_fmac_f32 v6, s61, v40
    v_fmac_f32 v7, s61, v41

    v_lshlrev_b32 v40, 16, v32
    v_and_b32 v41, 0xffff0000, v32
    v_fmac_f32 v6, s62, v40
    v_fmac_f32 v7, s62, v41

    v_lshlrev_b32 v40, 16, v33
    v_and_b32 v41, 0xffff0000, v33
    v_fmac_f32 v6, s63, v40
    v_fmac_f32 v7, s63, v41

    v_lshlrev_b32 v40, 16, v34
    v_and_b32 v41, 0xffff0000, v34
    v_fmac_f32 v6, s64, v40
    v_fmac_f32 v7, s64, v41

    v_lshlrev_b32 v40, 16, v35
    v_and_b32 v41, 0xffff0000, v35
    v_fmac_f32 v6, s65, v40
    v_fmac_f32 v7, s65, v41

    s_add_u32 s30, s25, 884736
    s_add_u32 s31, s25, 891648
    s_add_u32 s32, s25, 898560
    s_add_u32 s33, s25, 905472
    s_add_u32 s34, s25, 912384
    s_add_u32 s35, s25, 919296
    s_add_u32 s36, s25, 926208
    s_add_u32 s37, s25, 933120
    s_add_u32 s38, s25, 940032
    s_add_u32 s39, s25, 946944
    s_add_u32 s40, s25, 953856
    s_add_u32 s41, s25, 960768
    s_add_u32 s42, s25, 967680
    s_add_u32 s43, s25, 974592
    s_add_u32 s44, s25, 981504
    s_add_u32 s45, s25, 988416
    s_nop 0
    buffer_load_dword v20, v5, s[16:19], s30 offen
    buffer_load_dword v21, v5, s[16:19], s31 offen
    buffer_load_dword v22, v5, s[16:19], s32 offen
    buffer_load_dword v23, v5, s[16:19], s33 offen
    buffer_load_dword v24, v5, s[16:19], s34 offen
    buffer_load_dword v25, v5, s[16:19], s35 offen
    buffer_load_dword v26, v5, s[16:19], s36 offen
    buffer_load_dword v27, v5, s[16:19], s37 offen
    buffer_load_dword v28, v5, s[16:19], s38 offen
    buffer_load_dword v29, v5, s[16:19], s39 offen
    buffer_load_dword v30, v5, s[16:19], s40 offen
    buffer_load_dword v31, v5, s[16:19], s41 offen
    buffer_load_dword v32, v5, s[16:19], s42 offen
    buffer_load_dword v33, v5, s[16:19], s43 offen
    buffer_load_dword v34, v5, s[16:19], s44 offen
    buffer_load_dword v35, v5, s[16:19], s45 offen
    v_readlane_b32 s50, v12, 0
    v_readlane_b32 s51, v12, 1
    v_readlane_b32 s52, v12, 2
    v_readlane_b32 s53, v12, 3
    v_readlane_b32 s54, v12, 4
    v_readlane_b32 s55, v12, 5
    v_readlane_b32 s56, v12, 6
    v_readlane_b32 s57, v12, 7
    v_readlane_b32 s58, v12, 8
    v_readlane_b32 s59, v12, 9
    v_readlane_b32 s60, v12, 10
    v_readlane_b32 s61, v12, 11
    v_readlane_b32 s62, v12, 12
    v_readlane_b32 s63, v12, 13
    v_readlane_b32 s64, v12, 14
    v_readlane_b32 s65, v12, 15
    s_waitcnt vmcnt(0)
    v_lshlrev_b32 v40, 16, v20
    v_and_b32 v41, 0xffff0000, v20
    v_fmac_f32 v6, s50, v40
    v_fmac_f32 v7, s50, v41

    v_lshlrev_b32 v40, 16, v21
    v_and_b32 v41, 0xffff0000, v21
    v_fmac_f32 v6, s51, v40
    v_fmac_f32 v7, s51, v41

    v_lshlrev_b32 v40, 16, v22
    v_and_b32 v41, 0xffff0000, v22
    v_fmac_f32 v6, s52, v40
    v_fmac_f32 v7, s52, v41

    v_lshlrev_b32 v40, 16, v23
    v_and_b32 v41, 0xffff0000, v23
    v_fmac_f32 v6, s53, v40
    v_fmac_f32 v7, s53, v41

    v_lshlrev_b32 v40, 16, v24
    v_and_b32 v41, 0xffff0000, v24
    v_fmac_f32 v6, s54, v40
    v_fmac_f32 v7, s54, v41

    v_lshlrev_b32 v40, 16, v25
    v_and_b32 v41, 0xffff0000, v25
    v_fmac_f32 v6, s55, v40
    v_fmac_f32 v7, s55, v41

    v_lshlrev_b32 v40, 16, v26
    v_and_b32 v41, 0xffff0000, v26
    v_fmac_f32 v6, s56, v40
    v_fmac_f32 v7, s56, v41

    v_lshlrev_b32 v40, 16, v27
    v_and_b32 v41, 0xffff0000, v27
    v_fmac_f32 v6, s57, v40
    v_fmac_f32 v7, s57, v41

    v_lshlrev_b32 v40, 16, v28
    v_and_b32 v41, 0xffff0000, v28
    v_fmac_f32 v6, s58, v40
    v_fmac_f32 v7, s58, v41

    v_lshlrev_b32 v40, 16, v29
    v_and_b32 v41, 0xffff0000, v29
    v_fmac_f32 v6, s59, v40
    v_fmac_f32 v7, s59, v41

    v_lshlrev_b32 v40, 16, v30
    v_and_b32 v41, 0xffff0000, v30
    v_fmac_f32 v6, s60, v40
    v_fmac_f32 v7, s60, v41

    v_lshlrev_b32 v40, 16, v31
    v_and_b32 v41, 0xffff0000, v31
    v_fmac_f32 v6, s61, v40
    v_fmac_f32 v7, s61, v41

    v_lshlrev_b32 v40, 16, v32
    v_and_b32 v41, 0xffff0000, v32
    v_fmac_f32 v6, s62, v40
    v_fmac_f32 v7, s62, v41

    v_lshlrev_b32 v40, 16, v33
    v_and_b32 v41, 0xffff0000, v33
    v_fmac_f32 v6, s63, v40
    v_fmac_f32 v7, s63, v41

    v_lshlrev_b32 v40, 16, v34
    v_and_b32 v41, 0xffff0000, v34
    v_fmac_f32 v6, s64, v40
    v_fmac_f32 v7, s64, v41

    v_lshlrev_b32 v40, 16, v35
    v_and_b32 v41, 0xffff0000, v35
    v_fmac_f32 v6, s65, v40
    v_fmac_f32 v7, s65, v41

    v_lshlrev_b32 v8, 3, v0
    ds_write_b64 v8, v[6:7]
    s_waitcnt lgkmcnt(0)
    s_barrier
    v_cmp_gt_u32 vcc, 64, v0
    s_and_saveexec_b64 s[26:27], vcc
    s_cbranch_execz mod_kernel_end
    ds_read_b64 v[6:7], v8
    ds_read_b64 v[10:11], v8 offset:512
    ds_read_b64 v[12:13], v8 offset:1024
    ds_read_b64 v[14:15], v8 offset:1536
    s_waitcnt lgkmcnt(0)
    v_add_f32 v6, v6, v10
    v_add_f32 v7, v7, v11
    v_add_f32 v6, v6, v12
    v_add_f32 v7, v7, v13
    v_add_f32 v6, v6, v14
    v_add_f32 v7, v7, v15
    v_cvt_pk_bf16_f32 v6, v6, v7
    v_and_b32 v7, 0xffff0000, v6
    v_lshlrev_b32 v6, 16, v6
    s_lshl_b32 s3, s2, 9
    v_lshlrev_b32 v9, 3, v0
    v_add_u32 v9, s3, v9
    buffer_store_dwordx2 v[6:7], v9, s[20:23], 0 offen

mod_kernel_end:
    s_endpgm
.section .rodata,"a"
.p2align 6
.amdhsa_kernel mod_kernel
  .amdhsa_next_free_vgpr 48
  .amdhsa_next_free_sgpr 72
  .amdhsa_accum_offset 48
  .amdhsa_group_segment_fixed_size 0
  .amdhsa_kernarg_size 128
  .amdhsa_user_sgpr_count 2
  .amdhsa_user_sgpr_kernarg_segment_ptr 1
  .amdhsa_system_sgpr_workgroup_id_x 1
.end_amdhsa_kernel
.text
.p2align 8
.globl ln1_kernel
.type ln1_kernel,@function
ln1_kernel:
    s_cmp_ge_u32 s2, 512
    s_cbranch_scc1 ln1_kernel_end
    s_load_dwordx2 s[4:5], s[0:1], 0
    s_load_dwordx2 s[8:9], s[0:1], 120
    v_and_b32 v1, 63, v0
    v_lshrrev_b32 v2, 6, v0
    s_waitcnt lgkmcnt(0)

    s_mov_b32 s12, s4
    s_mov_b32 s13, s5
    s_mov_b32 s14, 2359296
    s_mov_b32 s15, 0x00020000
    s_mov_b32 s16, s8
    s_mov_b32 s17, s9
    s_mov_b32 s18, 13824
    s_mov_b32 s19, 0x00020000
    s_add_u32 s20, s8, 2392064
    s_addc_u32 s21, s9, 0
    s_mov_b32 s22, 2359296
    s_mov_b32 s23, 0x00020000
    s_lshl_b32 s3, s2, 2
    v_add_u32 v3, s3, v2
    v_mul_u32_u24 v3, 1152, v3
    v_lshlrev_b32 v4, 2, v1
    v_add_u32 v3, v3, v4
    v_lshlrev_b32 v5, 3, v1
    v_add_u32 v6, 2304, v5
    v_add_u32 v7, 0, v5
    v_mov_b32 v14, 0
    v_mov_b32 v24, 0
    v_mov_b32 v25, 0
    v_mov_b32 v34, 0
    v_mov_b32 v35, 0

    buffer_load_dword v10, v3, s[12:15], 0 offen offset:0
    buffer_load_dwordx2 v[20:21], v6, s[16:19], 0 offen offset:0
    buffer_load_dwordx2 v[30:31], v7, s[16:19], 0 offen offset:0
    buffer_load_dword v11, v3, s[12:15], 0 offen offset:256
    buffer_load_dwordx2 v[22:23], v6, s[16:19], 0 offen offset:512
    buffer_load_dwordx2 v[32:33], v7, s[16:19], 0 offen offset:512
    buffer_load_dword v12, v3, s[12:15], 0 offen offset:512
    buffer_load_dwordx2 v[24:25], v6, s[16:19], 0 offen offset:1024
    buffer_load_dwordx2 v[34:35], v7, s[16:19], 0 offen offset:1024
    buffer_load_dword v13, v3, s[12:15], 0 offen offset:768
    buffer_load_dwordx2 v[26:27], v6, s[16:19], 0 offen offset:1536
    buffer_load_dwordx2 v[36:37], v7, s[16:19], 0 offen offset:1536
    v_cmp_gt_u32 vcc, 32, v1
    s_and_saveexec_b64 s[26:27], vcc
    buffer_load_dword v14, v3, s[12:15], 0 offen offset:1024
    buffer_load_dwordx2 v[28:29], v6, s[16:19], 0 offen offset:2048
    buffer_load_dwordx2 v[38:39], v7, s[16:19], 0 offen offset:2048
    s_mov_b64 exec, s[26:27]
    s_waitcnt vmcnt(0)

    v_lshlrev_b32 v40, 16, v10
    v_and_b32 v41, 0xffff0000, v10
    v_lshlrev_b32 v42, 16, v11
    v_and_b32 v43, 0xffff0000, v11
    v_lshlrev_b32 v44, 16, v12
    v_and_b32 v45, 0xffff0000, v12
    v_lshlrev_b32 v46, 16, v13
    v_and_b32 v47, 0xffff0000, v13
    v_lshlrev_b32 v48, 16, v14
    v_and_b32 v49, 0xffff0000, v14
    v_add_f32 v50, v40, v41
    v_add_f32 v50, v50, v42
    v_add_f32 v50, v50, v43
    v_add_f32 v50, v50, v44
    v_add_f32 v50, v50, v45
    v_add_f32 v50, v50, v46
    v_add_f32 v50, v50, v47
    v_add_f32 v50, v50, v48
    v_add_f32 v50, v50, v49
    ds_swizzle_b32 v51, v50 offset:1055
    s_waitcnt lgkmcnt(0)
    v_add_f32 v50, v50, v51

    ds_swizzle_b32 v51, v50 offset:2079
    s_waitcnt lgkmcnt(0)
    v_add_f32 v50, v50, v51

    ds_swizzle_b32 v51, v50 offset:4127
    s_waitcnt lgkmcnt(0)
    v_add_f32 v50, v50, v51

    ds_swizzle_b32 v51, v50 offset:8223
    s_waitcnt lgkmcnt(0)
    v_add_f32 v50, v50, v51

    ds_swizzle_b32 v51, v50 offset:16415
    s_waitcnt lgkmcnt(0)
    v_add_f32 v50, v50, v51

    s_nop 0
    v_readlane_b32 s30, v50, 32
    s_nop 1
    v_add_f32 v50, s30, v50
    s_nop 0
    v_readlane_b32 s30, v50, 0
    s_nop 1

    v_mov_b32 v51, 0x3ae38e39
    v_mul_f32 v51, s30, v51

    v_mov_b32 v50, 0
    v_sub_f32 v52, v40, v51
    v_fmac_f32 v50, v52, v52

    v_sub_f32 v52, v41, v51
    v_fmac_f32 v50, v52, v52

    v_sub_f32 v52, v42, v51
    v_fmac_f32 v50, v52, v52

    v_sub_f32 v52, v43, v51
    v_fmac_f32 v50, v52, v52

    v_sub_f32 v52, v44, v51
    v_fmac_f32 v50, v52, v52

    v_sub_f32 v52, v45, v51
    v_fmac_f32 v50, v52, v52

    v_sub_f32 v52, v46, v51
    v_fmac_f32 v50, v52, v52

    v_sub_f32 v52, v47, v51
    v_fmac_f32 v50, v52, v52

    v_sub_f32 v52, v48, v51
    v_mul_f32 v52, v52, v52
    v_sub_f32 v53, v49, v51
    v_fmac_f32 v52, v53, v53
    v_cmp_gt_u32 vcc, 32, v1
    v_cndmask_b32 v52, 0, v52, vcc
    v_add_f32 v50, v50, v52

    ds_swizzle_b32 v52, v50 offset:1055
    s_waitcnt lgkmcnt(0)
    v_add_f32 v50, v50, v52

    ds_swizzle_b32 v52, v50 offset:2079
    s_waitcnt lgkmcnt(0)
    v_add_f32 v50, v50, v52

    ds_swizzle_b32 v52, v50 offset:4127
    s_waitcnt lgkmcnt(0)
    v_add_f32 v50, v50, v52

    ds_swizzle_b32 v52, v50 offset:8223
    s_waitcnt lgkmcnt(0)
    v_add_f32 v50, v50, v52

    ds_swizzle_b32 v52, v50 offset:16415
    s_waitcnt lgkmcnt(0)
    v_add_f32 v50, v50, v52

    s_nop 0
    v_readlane_b32 s31, v50, 32
    s_nop 1
    v_add_f32 v50, s31, v50
    s_nop 0
    v_readlane_b32 s31, v50, 0
    s_nop 1

    v_mov_b32 v52, 0x3ae38e39
    v_mul_f32 v52, s31, v52
    v_cvt_pk_bf16_f32 v52, v52, v51
    v_and_b32 v51, 0xffff0000, v52
    v_lshlrev_b32 v52, 16, v52
    v_add_f32 v52, 0x3727c5ac, v52
    v_cvt_pk_bf16_f32 v52, v52, v52
    v_lshlrev_b32 v52, 16, v52
    v_sqrt_f32 v52, v52
    s_nop 0
    v_cvt_pk_bf16_f32 v52, v52, v52
    v_lshlrev_b32 v52, 16, v52
    v_rcp_f32 v52, v52
    s_nop 0

    v_sub_f32 v40, v40, v51
    v_cvt_pk_bf16_f32 v40, v40, v40
    v_lshlrev_b32 v40, 16, v40
    v_mul_f32 v40, v40, v52
    v_cvt_pk_bf16_f32 v40, v40, v40
    v_lshlrev_b32 v40, 16, v40
    v_add_f32 v20, 1.0, v20
    v_cvt_pk_bf16_f32 v20, v20, v20
    v_lshlrev_b32 v20, 16, v20
    v_mul_f32 v40, v40, v20
    v_cvt_pk_bf16_f32 v40, v40, v40
    v_lshlrev_b32 v40, 16, v40
    v_add_f32 v40, v40, v30

    v_sub_f32 v41, v41, v51
    v_cvt_pk_bf16_f32 v41, v41, v41
    v_lshlrev_b32 v41, 16, v41
    v_mul_f32 v41, v41, v52
    v_cvt_pk_bf16_f32 v41, v41, v41
    v_lshlrev_b32 v41, 16, v41
    v_add_f32 v21, 1.0, v21
    v_cvt_pk_bf16_f32 v21, v21, v21
    v_lshlrev_b32 v21, 16, v21
    v_mul_f32 v41, v41, v21
    v_cvt_pk_bf16_f32 v41, v41, v41
    v_lshlrev_b32 v41, 16, v41
    v_add_f32 v41, v41, v31

    v_sub_f32 v42, v42, v51
    v_cvt_pk_bf16_f32 v42, v42, v42
    v_lshlrev_b32 v42, 16, v42
    v_mul_f32 v42, v42, v52
    v_cvt_pk_bf16_f32 v42, v42, v42
    v_lshlrev_b32 v42, 16, v42
    v_add_f32 v22, 1.0, v22
    v_cvt_pk_bf16_f32 v22, v22, v22
    v_lshlrev_b32 v22, 16, v22
    v_mul_f32 v42, v42, v22
    v_cvt_pk_bf16_f32 v42, v42, v42
    v_lshlrev_b32 v42, 16, v42
    v_add_f32 v42, v42, v32

    v_sub_f32 v43, v43, v51
    v_cvt_pk_bf16_f32 v43, v43, v43
    v_lshlrev_b32 v43, 16, v43
    v_mul_f32 v43, v43, v52
    v_cvt_pk_bf16_f32 v43, v43, v43
    v_lshlrev_b32 v43, 16, v43
    v_add_f32 v23, 1.0, v23
    v_cvt_pk_bf16_f32 v23, v23, v23
    v_lshlrev_b32 v23, 16, v23
    v_mul_f32 v43, v43, v23
    v_cvt_pk_bf16_f32 v43, v43, v43
    v_lshlrev_b32 v43, 16, v43
    v_add_f32 v43, v43, v33

    v_sub_f32 v44, v44, v51
    v_cvt_pk_bf16_f32 v44, v44, v44
    v_lshlrev_b32 v44, 16, v44
    v_mul_f32 v44, v44, v52
    v_cvt_pk_bf16_f32 v44, v44, v44
    v_lshlrev_b32 v44, 16, v44
    v_add_f32 v24, 1.0, v24
    v_cvt_pk_bf16_f32 v24, v24, v24
    v_lshlrev_b32 v24, 16, v24
    v_mul_f32 v44, v44, v24
    v_cvt_pk_bf16_f32 v44, v44, v44
    v_lshlrev_b32 v44, 16, v44
    v_add_f32 v44, v44, v34

    v_sub_f32 v45, v45, v51
    v_cvt_pk_bf16_f32 v45, v45, v45
    v_lshlrev_b32 v45, 16, v45
    v_mul_f32 v45, v45, v52
    v_cvt_pk_bf16_f32 v45, v45, v45
    v_lshlrev_b32 v45, 16, v45
    v_add_f32 v25, 1.0, v25
    v_cvt_pk_bf16_f32 v25, v25, v25
    v_lshlrev_b32 v25, 16, v25
    v_mul_f32 v45, v45, v25
    v_cvt_pk_bf16_f32 v45, v45, v45
    v_lshlrev_b32 v45, 16, v45
    v_add_f32 v45, v45, v35

    v_sub_f32 v46, v46, v51
    v_cvt_pk_bf16_f32 v46, v46, v46
    v_lshlrev_b32 v46, 16, v46
    v_mul_f32 v46, v46, v52
    v_cvt_pk_bf16_f32 v46, v46, v46
    v_lshlrev_b32 v46, 16, v46
    v_add_f32 v26, 1.0, v26
    v_cvt_pk_bf16_f32 v26, v26, v26
    v_lshlrev_b32 v26, 16, v26
    v_mul_f32 v46, v46, v26
    v_cvt_pk_bf16_f32 v46, v46, v46
    v_lshlrev_b32 v46, 16, v46
    v_add_f32 v46, v46, v36

    v_sub_f32 v47, v47, v51
    v_cvt_pk_bf16_f32 v47, v47, v47
    v_lshlrev_b32 v47, 16, v47
    v_mul_f32 v47, v47, v52
    v_cvt_pk_bf16_f32 v47, v47, v47
    v_lshlrev_b32 v47, 16, v47
    v_add_f32 v27, 1.0, v27
    v_cvt_pk_bf16_f32 v27, v27, v27
    v_lshlrev_b32 v27, 16, v27
    v_mul_f32 v47, v47, v27
    v_cvt_pk_bf16_f32 v47, v47, v47
    v_lshlrev_b32 v47, 16, v47
    v_add_f32 v47, v47, v37

    v_sub_f32 v48, v48, v51
    v_cvt_pk_bf16_f32 v48, v48, v48
    v_lshlrev_b32 v48, 16, v48
    v_mul_f32 v48, v48, v52
    v_cvt_pk_bf16_f32 v48, v48, v48
    v_lshlrev_b32 v48, 16, v48
    v_add_f32 v28, 1.0, v28
    v_cvt_pk_bf16_f32 v28, v28, v28
    v_lshlrev_b32 v28, 16, v28
    v_mul_f32 v48, v48, v28
    v_cvt_pk_bf16_f32 v48, v48, v48
    v_lshlrev_b32 v48, 16, v48
    v_add_f32 v48, v48, v38

    v_sub_f32 v49, v49, v51
    v_cvt_pk_bf16_f32 v49, v49, v49
    v_lshlrev_b32 v49, 16, v49
    v_mul_f32 v49, v49, v52
    v_cvt_pk_bf16_f32 v49, v49, v49
    v_lshlrev_b32 v49, 16, v49
    v_add_f32 v29, 1.0, v29
    v_cvt_pk_bf16_f32 v29, v29, v29
    v_lshlrev_b32 v29, 16, v29
    v_mul_f32 v49, v49, v29
    v_cvt_pk_bf16_f32 v49, v49, v49
    v_lshlrev_b32 v49, 16, v49
    v_add_f32 v49, v49, v39

    v_cvt_pk_bf16_f32 v10, v40, v41
    v_cvt_pk_bf16_f32 v11, v42, v43
    v_cvt_pk_bf16_f32 v12, v44, v45
    v_cvt_pk_bf16_f32 v13, v46, v47
    v_cvt_pk_bf16_f32 v14, v48, v49
    buffer_store_dword v10, v3, s[20:23], 0 offen offset:0
    buffer_store_dword v11, v3, s[20:23], 0 offen offset:256
    buffer_store_dword v12, v3, s[20:23], 0 offen offset:512
    buffer_store_dword v13, v3, s[20:23], 0 offen offset:768
    v_cmp_gt_u32 vcc, 32, v1
    s_and_saveexec_b64 s[26:27], vcc
    buffer_store_dword v14, v3, s[20:23], 0 offen offset:1024

ln1_kernel_end:
    s_endpgm
.section .rodata,"a"
.p2align 6
.amdhsa_kernel ln1_kernel
  .amdhsa_next_free_vgpr 64
  .amdhsa_next_free_sgpr 40
  .amdhsa_accum_offset 64
  .amdhsa_group_segment_fixed_size 0
  .amdhsa_kernarg_size 128
  .amdhsa_user_sgpr_count 2
  .amdhsa_user_sgpr_kernarg_segment_ptr 1
  .amdhsa_system_sgpr_workgroup_id_x 1
.end_amdhsa_kernel
.text
.p2align 8
.globl qk_gemm_kernel
.type qk_gemm_kernel,@function
qk_gemm_kernel:
    s_cmp_ge_u32 s2, 1024
    s_cbranch_scc1 qk_gemm_kernel_end
    s_load_dwordx2 s[4:5], s[0:1], 120
    s_load_dwordx2 s[8:9], s[0:1], 120
    s_and_b32 s22, s2, 15
    s_lshr_b32 s23, s2, 4

    s_load_dwordx2 s[10:11], s[0:1], 16
    s_load_dwordx2 s[6:7], s[0:1], 24
    s_waitcnt lgkmcnt(0)
    s_cmp_ge_u32 s23, 32
    s_cselect_b32 s10, s6, s10
    s_cselect_b32 s11, s7, s11
    s_and_b32 s24, s23, 31
    s_lshl_b32 s24, s24, 8
    s_lshr_b32 s29, s23, 5
    s_lshl_b32 s29, s29, 24

    s_waitcnt lgkmcnt(0)
    s_add_u32 s12, s4, 2392064
    s_addc_u32 s13, s5, 0
    s_mov_b32 s14, 2359296
    s_mov_b32 s15, 0x00020000
    s_mov_b32 s16, s10
    s_mov_b32 s17, s11
    s_mov_b32 s18, 4718592
    s_mov_b32 s19, 0x00020000
    v_and_b32 v1, 63, v0
    v_lshrrev_b32 v2, 6, v0
    v_and_b32 v3, 15, v0
    v_bfe_u32 v4, v0, 4, 2

    v_lshrrev_b32 v5, 3, v0
    v_and_b32 v6, 7, v0
    s_mul_i32 s25, s22, 147456
    v_mul_u32_u24 v7, 1152, v5
    v_lshl_add_u32 v7, v6, 4, v7
    v_add_u32 v7, s25, v7
    v_mul_u32_u24 v8, 144, v5
    v_lshl_add_u32 v8, v6, 4, v8

    v_lshrrev_b32 v9, 4, v0
    v_and_b32 v10, 15, v0
    v_mul_u32_u24 v11, 8192, v9
    v_lshl_add_u32 v11, v10, 4, v11
    v_add_u32 v11, s24, v11

    v_add_u32 v12, 0, v9
    v_and_b32 v13, 0xffffffe0, v12
    v_bfe_u32 v14, v12, 2, 1
    v_lshl_add_u32 v13, v14, 4, v13
    v_bfe_u32 v14, v12, 3, 2
    v_lshl_add_u32 v13, v14, 2, v13
    v_and_b32 v14, 3, v12
    v_add_u32 v13, v13, v14
    v_mul_u32_u24 v13, 288, v13
    v_lshl_add_u32 v13, v10, 4, v13
    v_add_u32 v16, 18432, v13

    v_add_u32 v12, 16, v9
    v_and_b32 v13, 0xffffffe0, v12
    v_bfe_u32 v14, v12, 2, 1
    v_lshl_add_u32 v13, v14, 4, v13
    v_bfe_u32 v14, v12, 3, 2
    v_lshl_add_u32 v13, v14, 2, v13
    v_and_b32 v14, 3, v12
    v_add_u32 v13, v13, v14
    v_mul_u32_u24 v13, 288, v13
    v_lshl_add_u32 v13, v10, 4, v13
    v_add_u32 v17, 18432, v13

    v_add_u32 v12, 32, v9
    v_and_b32 v13, 0xffffffe0, v12
    v_bfe_u32 v14, v12, 2, 1
    v_lshl_add_u32 v13, v14, 4, v13
    v_bfe_u32 v14, v12, 3, 2
    v_lshl_add_u32 v13, v14, 2, v13
    v_and_b32 v14, 3, v12
    v_add_u32 v13, v13, v14
    v_mul_u32_u24 v13, 288, v13
    v_lshl_add_u32 v13, v10, 4, v13
    v_add_u32 v18, 18432, v13

    v_add_u32 v12, 48, v9
    v_and_b32 v13, 0xffffffe0, v12
    v_bfe_u32 v14, v12, 2, 1
    v_lshl_add_u32 v13, v14, 4, v13
    v_bfe_u32 v14, v12, 3, 2
    v_lshl_add_u32 v13, v14, 2, v13
    v_and_b32 v14, 3, v12
    v_add_u32 v13, v13, v14
    v_mul_u32_u24 v13, 288, v13
    v_lshl_add_u32 v13, v10, 4, v13
    v_add_u32 v19, 18432, v13

    v_lshrrev_b32 v12, 1, v2
    v_and_b32 v13, 1, v2
    v_lshlrev_b32 v14, 6, v12
    v_add_u32 v14, v14, v3
    v_mul_u32_u24 v14, 144, v14
    v_lshl_add_u32 v20, v4, 4, v14

    v_bfe_u32 v14, v0, 2, 2
    v_and_b32 v15, 3, v0
    v_lshl_add_u32 v14, v4, 2, v14
    v_mul_u32_u24 v14, 288, v14
    v_mul_u32_u24 v21, 64, v13
    v_lshl_add_u32 v21, v15, 2, v21
    v_lshl_add_u32 v21, v21, 1, v14
    v_add_u32 v21, 18432, v21

    v_mov_b32 v64, 0
    v_mov_b32 v65, 0
    v_mov_b32 v66, 0
    v_mov_b32 v67, 0
    v_mov_b32 v68, 0
    v_mov_b32 v69, 0
    v_mov_b32 v70, 0
    v_mov_b32 v71, 0
    v_mov_b32 v72, 0
    v_mov_b32 v73, 0
    v_mov_b32 v74, 0
    v_mov_b32 v75, 0
    v_mov_b32 v76, 0
    v_mov_b32 v77, 0
    v_mov_b32 v78, 0
    v_mov_b32 v79, 0
    v_mov_b32 v80, 0
    v_mov_b32 v81, 0
    v_mov_b32 v82, 0
    v_mov_b32 v83, 0
    v_mov_b32 v84, 0
    v_mov_b32 v85, 0
    v_mov_b32 v86, 0
    v_mov_b32 v87, 0
    v_mov_b32 v88, 0
    v_mov_b32 v89, 0
    v_mov_b32 v90, 0
    v_mov_b32 v91, 0
    v_mov_b32 v92, 0
    v_mov_b32 v93, 0
    v_mov_b32 v94, 0
    v_mov_b32 v95, 0
    v_mov_b32 v96, 0
    v_mov_b32 v97, 0
    v_mov_b32 v98, 0
    v_mov_b32 v99, 0
    v_mov_b32 v100, 0
    v_mov_b32 v101, 0
    v_mov_b32 v102, 0
    v_mov_b32 v103, 0
    v_mov_b32 v104, 0
    v_mov_b32 v105, 0
    v_mov_b32 v106, 0
    v_mov_b32 v107, 0
    v_mov_b32 v108, 0
    v_mov_b32 v109, 0
    v_mov_b32 v110, 0
    v_mov_b32 v111, 0
    v_mov_b32 v112, 0
    v_mov_b32 v113, 0
    v_mov_b32 v114, 0
    v_mov_b32 v115, 0
    v_mov_b32 v116, 0
    v_mov_b32 v117, 0
    v_mov_b32 v118, 0
    v_mov_b32 v119, 0
    v_mov_b32 v120, 0
    v_mov_b32 v121, 0
    v_mov_b32 v122, 0
    v_mov_b32 v123, 0
    v_mov_b32 v124, 0
    v_mov_b32 v125, 0
    v_mov_b32 v126, 0
    v_mov_b32 v127, 0
    v_add_u32 v25, 36864, v7
    v_add_u32 v26, 73728, v7
    v_add_u32 v27, 110592, v7
    v_add_u32 v29, 131072, v11
    v_add_u32 v30, 262144, v11
    v_add_u32 v31, 393216, v11
    s_mov_b32 s26, 0
    s_mov_b32 s27, 0
    s_mov_b32 s28, 0
    buffer_load_dwordx4 v[32:35], v7, s[12:15], s26 offen offset:0
    buffer_load_dwordx4 v[36:39], v25, s[12:15], s26 offen
    buffer_load_dwordx4 v[40:43], v26, s[12:15], s26 offen
    buffer_load_dwordx4 v[44:47], v27, s[12:15], s26 offen
    buffer_load_dwordx4 v[48:51], v11, s[16:19], s27 offen
    buffer_load_dwordx4 v[52:55], v29, s[16:19], s27 offen
    buffer_load_dwordx4 v[56:59], v30, s[16:19], s27 offen
    buffer_load_dwordx4 v[60:63], v31, s[16:19], s27 offen
    s_waitcnt vmcnt(0)
    ds_write_b128 v8, v[32:35] offset:0
    ds_write_b128 v8, v[36:39] offset:4608
    ds_write_b128 v8, v[40:43] offset:9216
    ds_write_b128 v8, v[44:47] offset:13824
    ds_write_b128 v16, v[48:51]
    ds_write_b128 v17, v[52:55]
    ds_write_b128 v18, v[56:59]
    ds_write_b128 v19, v[60:63]
    s_waitcnt lgkmcnt(0)
    s_barrier
qk_gemm_kernel_loop1:
    s_add_u32 s26, s26, 128
    s_add_u32 s27, s27, 524288
    s_add_u32 s28, s28, 1

    buffer_load_dwordx4 v[32:35], v7, s[12:15], s26 offen offset:0
    buffer_load_dwordx4 v[36:39], v25, s[12:15], s26 offen
    buffer_load_dwordx4 v[40:43], v26, s[12:15], s26 offen
    buffer_load_dwordx4 v[44:47], v27, s[12:15], s26 offen
    buffer_load_dwordx4 v[48:51], v11, s[16:19], s27 offen
    buffer_load_dwordx4 v[52:55], v29, s[16:19], s27 offen
    buffer_load_dwordx4 v[56:59], v30, s[16:19], s27 offen
    buffer_load_dwordx4 v[60:63], v31, s[16:19], s27 offen
    ds_read_b128 v[128:131], v20 offset:0
    ds_read_b128 v[132:135], v20 offset:2304
    ds_read_b128 v[136:139], v20 offset:4608
    ds_read_b128 v[140:143], v20 offset:6912
    ds_read_b64_tr_b16 v[144:145], v21 offset:0
    ds_read_b64_tr_b16 v[146:147], v21 offset:4608
    ds_read_b64_tr_b16 v[148:149], v21 offset:32
    ds_read_b64_tr_b16 v[150:151], v21 offset:4640
    ds_read_b64_tr_b16 v[152:153], v21 offset:64
    ds_read_b64_tr_b16 v[154:155], v21 offset:4672
    ds_read_b64_tr_b16 v[156:157], v21 offset:96
    ds_read_b64_tr_b16 v[158:159], v21 offset:4704
    s_waitcnt lgkmcnt(0)
    v_mfma_f32_16x16x32_bf16 v[64:67], v[144:147], v[128:131], v[64:67]
    v_mfma_f32_16x16x32_bf16 v[68:71], v[148:151], v[128:131], v[68:71]
    v_mfma_f32_16x16x32_bf16 v[72:75], v[152:155], v[128:131], v[72:75]
    v_mfma_f32_16x16x32_bf16 v[76:79], v[156:159], v[128:131], v[76:79]
    v_mfma_f32_16x16x32_bf16 v[80:83], v[144:147], v[132:135], v[80:83]
    v_mfma_f32_16x16x32_bf16 v[84:87], v[148:151], v[132:135], v[84:87]
    v_mfma_f32_16x16x32_bf16 v[88:91], v[152:155], v[132:135], v[88:91]
    v_mfma_f32_16x16x32_bf16 v[92:95], v[156:159], v[132:135], v[92:95]
    v_mfma_f32_16x16x32_bf16 v[96:99], v[144:147], v[136:139], v[96:99]
    v_mfma_f32_16x16x32_bf16 v[100:103], v[148:151], v[136:139], v[100:103]
    v_mfma_f32_16x16x32_bf16 v[104:107], v[152:155], v[136:139], v[104:107]
    v_mfma_f32_16x16x32_bf16 v[108:111], v[156:159], v[136:139], v[108:111]
    v_mfma_f32_16x16x32_bf16 v[112:115], v[144:147], v[140:143], v[112:115]
    v_mfma_f32_16x16x32_bf16 v[116:119], v[148:151], v[140:143], v[116:119]
    v_mfma_f32_16x16x32_bf16 v[120:123], v[152:155], v[140:143], v[120:123]
    v_mfma_f32_16x16x32_bf16 v[124:127], v[156:159], v[140:143], v[124:127]
    ds_read_b128 v[128:131], v20 offset:64
    ds_read_b128 v[132:135], v20 offset:2368
    ds_read_b128 v[136:139], v20 offset:4672
    ds_read_b128 v[140:143], v20 offset:6976
    ds_read_b64_tr_b16 v[144:145], v21 offset:9216
    ds_read_b64_tr_b16 v[146:147], v21 offset:13824
    ds_read_b64_tr_b16 v[148:149], v21 offset:9248
    ds_read_b64_tr_b16 v[150:151], v21 offset:13856
    ds_read_b64_tr_b16 v[152:153], v21 offset:9280
    ds_read_b64_tr_b16 v[154:155], v21 offset:13888
    ds_read_b64_tr_b16 v[156:157], v21 offset:9312
    ds_read_b64_tr_b16 v[158:159], v21 offset:13920
    s_waitcnt lgkmcnt(0)
    v_mfma_f32_16x16x32_bf16 v[64:67], v[144:147], v[128:131], v[64:67]
    v_mfma_f32_16x16x32_bf16 v[68:71], v[148:151], v[128:131], v[68:71]
    v_mfma_f32_16x16x32_bf16 v[72:75], v[152:155], v[128:131], v[72:75]
    v_mfma_f32_16x16x32_bf16 v[76:79], v[156:159], v[128:131], v[76:79]
    v_mfma_f32_16x16x32_bf16 v[80:83], v[144:147], v[132:135], v[80:83]
    v_mfma_f32_16x16x32_bf16 v[84:87], v[148:151], v[132:135], v[84:87]
    v_mfma_f32_16x16x32_bf16 v[88:91], v[152:155], v[132:135], v[88:91]
    v_mfma_f32_16x16x32_bf16 v[92:95], v[156:159], v[132:135], v[92:95]
    v_mfma_f32_16x16x32_bf16 v[96:99], v[144:147], v[136:139], v[96:99]
    v_mfma_f32_16x16x32_bf16 v[100:103], v[148:151], v[136:139], v[100:103]
    v_mfma_f32_16x16x32_bf16 v[104:107], v[152:155], v[136:139], v[104:107]
    v_mfma_f32_16x16x32_bf16 v[108:111], v[156:159], v[136:139], v[108:111]
    v_mfma_f32_16x16x32_bf16 v[112:115], v[144:147], v[140:143], v[112:115]
    v_mfma_f32_16x16x32_bf16 v[116:119], v[148:151], v[140:143], v[116:119]
    v_mfma_f32_16x16x32_bf16 v[120:123], v[152:155], v[140:143], v[120:123]
    v_mfma_f32_16x16x32_bf16 v[124:127], v[156:159], v[140:143], v[124:127]
    v_xor_b32 v8, 65536, v8
    v_xor_b32 v20, 65536, v20
    v_xor_b32 v21, 65536, v21

    v_xor_b32 v16, 65536, v16
    v_xor_b32 v17, 65536, v17
    v_xor_b32 v18, 65536, v18
    v_xor_b32 v19, 65536, v19
    s_cmp_ge_u32 s28, 9
    s_cbranch_scc1 qk_gemm_kernel_skip2
    s_waitcnt vmcnt(0)

    ds_write_b128 v8, v[32:35] offset:0
    ds_write_b128 v8, v[36:39] offset:4608
    ds_write_b128 v8, v[40:43] offset:9216
    ds_write_b128 v8, v[44:47] offset:13824
    ds_write_b128 v16, v[48:51]
    ds_write_b128 v17, v[52:55]
    ds_write_b128 v18, v[56:59]
    ds_write_b128 v19, v[60:63]
    s_waitcnt lgkmcnt(0)
    s_barrier
    s_branch qk_gemm_kernel_loop1
qk_gemm_kernel_skip2:
    s_waitcnt vmcnt(0)
    s_nop 7
    s_nop 7
    s_add_u32 s32, s8, 4751360
    s_addc_u32 s33, s9, 0
    s_mov_b32 s34, 33554432
    s_mov_b32 s35, 0x00020000
    v_lshrrev_b32 v12, 1, v2
    v_and_b32 v13, 1, v2
    s_lshl_b32 s25, s22, 7
    v_lshl_add_u32 v14, v12, 6, v3
    v_add_u32 v14, s25, v14
    v_mul_u32_u24 v14, 8192, v14
    v_mul_u32_u24 v15, 64, v13
    v_lshl_add_u32 v15, v4, 2, v15
    v_lshl_add_u32 v14, v15, 1, v14
    v_add_u32 v14, s24, v14
    v_add_u32 v14, s29, v14

    v_cvt_pk_bf16_f32 v64, v64, v65
    v_cvt_pk_bf16_f32 v65, v66, v67

    v_cvt_pk_bf16_f32 v68, v68, v69
    v_cvt_pk_bf16_f32 v69, v70, v71

    v_cvt_pk_bf16_f32 v72, v72, v73
    v_cvt_pk_bf16_f32 v73, v74, v75

    v_cvt_pk_bf16_f32 v76, v76, v77
    v_cvt_pk_bf16_f32 v77, v78, v79

    buffer_store_dwordx2 v[64:65], v14, s[32:35], 0 offen offset:0
    buffer_store_dwordx2 v[68:69], v14, s[32:35], 0 offen offset:32
    buffer_store_dwordx2 v[72:73], v14, s[32:35], 0 offen offset:64
    buffer_store_dwordx2 v[76:77], v14, s[32:35], 0 offen offset:96
    v_add_u32 v14, 131072, v14
    v_cvt_pk_bf16_f32 v80, v80, v81
    v_cvt_pk_bf16_f32 v81, v82, v83

    v_cvt_pk_bf16_f32 v84, v84, v85
    v_cvt_pk_bf16_f32 v85, v86, v87

    v_cvt_pk_bf16_f32 v88, v88, v89
    v_cvt_pk_bf16_f32 v89, v90, v91

    v_cvt_pk_bf16_f32 v92, v92, v93
    v_cvt_pk_bf16_f32 v93, v94, v95

    buffer_store_dwordx2 v[80:81], v14, s[32:35], 0 offen offset:0
    buffer_store_dwordx2 v[84:85], v14, s[32:35], 0 offen offset:32
    buffer_store_dwordx2 v[88:89], v14, s[32:35], 0 offen offset:64
    buffer_store_dwordx2 v[92:93], v14, s[32:35], 0 offen offset:96
    v_add_u32 v14, 131072, v14
    v_cvt_pk_bf16_f32 v96, v96, v97
    v_cvt_pk_bf16_f32 v97, v98, v99

    v_cvt_pk_bf16_f32 v100, v100, v101
    v_cvt_pk_bf16_f32 v101, v102, v103

    v_cvt_pk_bf16_f32 v104, v104, v105
    v_cvt_pk_bf16_f32 v105, v106, v107

    v_cvt_pk_bf16_f32 v108, v108, v109
    v_cvt_pk_bf16_f32 v109, v110, v111

    buffer_store_dwordx2 v[96:97], v14, s[32:35], 0 offen offset:0
    buffer_store_dwordx2 v[100:101], v14, s[32:35], 0 offen offset:32
    buffer_store_dwordx2 v[104:105], v14, s[32:35], 0 offen offset:64
    buffer_store_dwordx2 v[108:109], v14, s[32:35], 0 offen offset:96
    v_add_u32 v14, 131072, v14
    v_cvt_pk_bf16_f32 v112, v112, v113
    v_cvt_pk_bf16_f32 v113, v114, v115

    v_cvt_pk_bf16_f32 v116, v116, v117
    v_cvt_pk_bf16_f32 v117, v118, v119

    v_cvt_pk_bf16_f32 v120, v120, v121
    v_cvt_pk_bf16_f32 v121, v122, v123

    v_cvt_pk_bf16_f32 v124, v124, v125
    v_cvt_pk_bf16_f32 v125, v126, v127

    buffer_store_dwordx2 v[112:113], v14, s[32:35], 0 offen offset:0
    buffer_store_dwordx2 v[116:117], v14, s[32:35], 0 offen offset:32
    buffer_store_dwordx2 v[120:121], v14, s[32:35], 0 offen offset:64
    buffer_store_dwordx2 v[124:125], v14, s[32:35], 0 offen offset:96
    v_add_u32 v14, 131072, v14
qk_gemm_kernel_end:
    s_endpgm
.section .rodata,"a"
.p2align 6
.amdhsa_kernel qk_gemm_kernel
  .amdhsa_next_free_vgpr 160
  .amdhsa_next_free_sgpr 48
  .amdhsa_accum_offset 160
  .amdhsa_group_segment_fixed_size 0
  .amdhsa_kernarg_size 128
  .amdhsa_user_sgpr_count 2
  .amdhsa_user_sgpr_kernarg_segment_ptr 1
  .amdhsa_system_sgpr_workgroup_id_x 1
.end_amdhsa_kernel
.text
.p2align 8
.globl v_gemm_kernel
.type v_gemm_kernel,@function
v_gemm_kernel:
    s_cmp_ge_u32 s2, 512
    s_cbranch_scc1 v_gemm_kernel_end
    s_load_dwordx2 s[4:5], s[0:1], 120
    s_load_dwordx2 s[8:9], s[0:1], 120
    s_and_b32 s22, s2, 15
    s_lshr_b32 s23, s2, 4

    s_load_dwordx2 s[10:11], s[0:1], 32
    s_lshl_b32 s24, s23, 8

    s_waitcnt lgkmcnt(0)
    s_add_u32 s12, s4, 2392064
    s_addc_u32 s13, s5, 0
    s_mov_b32 s14, 2359296
    s_mov_b32 s15, 0x00020000
    s_mov_b32 s16, s10
    s_mov_b32 s17, s11
    s_mov_b32 s18, 4718592
    s_mov_b32 s19, 0x00020000
    v_and_b32 v1, 63, v0
    v_lshrrev_b32 v2, 6, v0
    v_and_b32 v3, 15, v0
    v_bfe_u32 v4, v0, 4, 2

    v_lshrrev_b32 v5, 3, v0
    v_and_b32 v6, 7, v0
    s_mul_i32 s25, s22, 147456
    v_mul_u32_u24 v7, 1152, v5
    v_lshl_add_u32 v7, v6, 4, v7
    v_add_u32 v7, s25, v7
    v_mul_u32_u24 v8, 144, v5
    v_lshl_add_u32 v8, v6, 4, v8

    v_lshrrev_b32 v9, 4, v0
    v_and_b32 v10, 15, v0
    v_mul_u32_u24 v11, 8192, v9
    v_lshl_add_u32 v11, v10, 4, v11
    v_add_u32 v11, s24, v11

    v_add_u32 v12, 0, v9
    v_and_b32 v13, 0xffffffe0, v12
    v_bfe_u32 v14, v12, 2, 1
    v_lshl_add_u32 v13, v14, 4, v13
    v_bfe_u32 v14, v12, 3, 2
    v_lshl_add_u32 v13, v14, 2, v13
    v_and_b32 v14, 3, v12
    v_add_u32 v13, v13, v14
    v_mul_u32_u24 v13, 288, v13
    v_lshl_add_u32 v13, v10, 4, v13
    v_add_u32 v16, 18432, v13

    v_add_u32 v12, 16, v9
    v_and_b32 v13, 0xffffffe0, v12
    v_bfe_u32 v14, v12, 2, 1
    v_lshl_add_u32 v13, v14, 4, v13
    v_bfe_u32 v14, v12, 3, 2
    v_lshl_add_u32 v13, v14, 2, v13
    v_and_b32 v14, 3, v12
    v_add_u32 v13, v13, v14
    v_mul_u32_u24 v13, 288, v13
    v_lshl_add_u32 v13, v10, 4, v13
    v_add_u32 v17, 18432, v13

    v_add_u32 v12, 32, v9
    v_and_b32 v13, 0xffffffe0, v12
    v_bfe_u32 v14, v12, 2, 1
    v_lshl_add_u32 v13, v14, 4, v13
    v_bfe_u32 v14, v12, 3, 2
    v_lshl_add_u32 v13, v14, 2, v13
    v_and_b32 v14, 3, v12
    v_add_u32 v13, v13, v14
    v_mul_u32_u24 v13, 288, v13
    v_lshl_add_u32 v13, v10, 4, v13
    v_add_u32 v18, 18432, v13

    v_add_u32 v12, 48, v9
    v_and_b32 v13, 0xffffffe0, v12
    v_bfe_u32 v14, v12, 2, 1
    v_lshl_add_u32 v13, v14, 4, v13
    v_bfe_u32 v14, v12, 3, 2
    v_lshl_add_u32 v13, v14, 2, v13
    v_and_b32 v14, 3, v12
    v_add_u32 v13, v13, v14
    v_mul_u32_u24 v13, 288, v13
    v_lshl_add_u32 v13, v10, 4, v13
    v_add_u32 v19, 18432, v13

    v_lshrrev_b32 v12, 1, v2
    v_and_b32 v13, 1, v2
    v_lshlrev_b32 v14, 6, v12
    v_add_u32 v14, v14, v3
    v_mul_u32_u24 v14, 144, v14
    v_lshl_add_u32 v20, v4, 4, v14

    v_bfe_u32 v14, v0, 2, 2
    v_and_b32 v15, 3, v0
    v_lshl_add_u32 v14, v4, 2, v14
    v_mul_u32_u24 v14, 288, v14
    v_mul_u32_u24 v21, 64, v13
    v_lshl_add_u32 v21, v15, 2, v21
    v_lshl_add_u32 v21, v21, 1, v14
    v_add_u32 v21, 18432, v21

    v_mov_b32 v64, 0
    v_mov_b32 v65, 0
    v_mov_b32 v66, 0
    v_mov_b32 v67, 0
    v_mov_b32 v68, 0
    v_mov_b32 v69, 0
    v_mov_b32 v70, 0
    v_mov_b32 v71, 0
    v_mov_b32 v72, 0
    v_mov_b32 v73, 0
    v_mov_b32 v74, 0
    v_mov_b32 v75, 0
    v_mov_b32 v76, 0
    v_mov_b32 v77, 0
    v_mov_b32 v78, 0
    v_mov_b32 v79, 0
    v_mov_b32 v80, 0
    v_mov_b32 v81, 0
    v_mov_b32 v82, 0
    v_mov_b32 v83, 0
    v_mov_b32 v84, 0
    v_mov_b32 v85, 0
    v_mov_b32 v86, 0
    v_mov_b32 v87, 0
    v_mov_b32 v88, 0
    v_mov_b32 v89, 0
    v_mov_b32 v90, 0
    v_mov_b32 v91, 0
    v_mov_b32 v92, 0
    v_mov_b32 v93, 0
    v_mov_b32 v94, 0
    v_mov_b32 v95, 0
    v_mov_b32 v96, 0
    v_mov_b32 v97, 0
    v_mov_b32 v98, 0
    v_mov_b32 v99, 0
    v_mov_b32 v100, 0
    v_mov_b32 v101, 0
    v_mov_b32 v102, 0
    v_mov_b32 v103, 0
    v_mov_b32 v104, 0
    v_mov_b32 v105, 0
    v_mov_b32 v106, 0
    v_mov_b32 v107, 0
    v_mov_b32 v108, 0
    v_mov_b32 v109, 0
    v_mov_b32 v110, 0
    v_mov_b32 v111, 0
    v_mov_b32 v112, 0
    v_mov_b32 v113, 0
    v_mov_b32 v114, 0
    v_mov_b32 v115, 0
    v_mov_b32 v116, 0
    v_mov_b32 v117, 0
    v_mov_b32 v118, 0
    v_mov_b32 v119, 0
    v_mov_b32 v120, 0
    v_mov_b32 v121, 0
    v_mov_b32 v122, 0
    v_mov_b32 v123, 0
    v_mov_b32 v124, 0
    v_mov_b32 v125, 0
    v_mov_b32 v126, 0
    v_mov_b32 v127, 0
    v_add_u32 v25, 36864, v7
    v_add_u32 v26, 73728, v7
    v_add_u32 v27, 110592, v7
    v_add_u32 v29, 131072, v11
    v_add_u32 v30, 262144, v11
    v_add_u32 v31, 393216, v11
    s_mov_b32 s26, 0
    s_mov_b32 s27, 0
    s_mov_b32 s28, 0
    buffer_load_dwordx4 v[32:35], v7, s[12:15], s26 offen offset:0
    buffer_load_dwordx4 v[36:39], v25, s[12:15], s26 offen
    buffer_load_dwordx4 v[40:43], v26, s[12:15], s26 offen
    buffer_load_dwordx4 v[44:47], v27, s[12:15], s26 offen
    buffer_load_dwordx4 v[48:51], v11, s[16:19], s27 offen
    buffer_load_dwordx4 v[52:55], v29, s[16:19], s27 offen
    buffer_load_dwordx4 v[56:59], v30, s[16:19], s27 offen
    buffer_load_dwordx4 v[60:63], v31, s[16:19], s27 offen
    s_waitcnt vmcnt(0)
    ds_write_b128 v8, v[32:35] offset:0
    ds_write_b128 v8, v[36:39] offset:4608
    ds_write_b128 v8, v[40:43] offset:9216
    ds_write_b128 v8, v[44:47] offset:13824
    ds_write_b128 v16, v[48:51]
    ds_write_b128 v17, v[52:55]
    ds_write_b128 v18, v[56:59]
    ds_write_b128 v19, v[60:63]
    s_waitcnt lgkmcnt(0)
    s_barrier
v_gemm_kernel_loop1:
    s_add_u32 s26, s26, 128
    s_add_u32 s27, s27, 524288
    s_add_u32 s28, s28, 1

    buffer_load_dwordx4 v[32:35], v7, s[12:15], s26 offen offset:0
    buffer_load_dwordx4 v[36:39], v25, s[12:15], s26 offen
    buffer_load_dwordx4 v[40:43], v26, s[12:15], s26 offen
    buffer_load_dwordx4 v[44:47], v27, s[12:15], s26 offen
    buffer_load_dwordx4 v[48:51], v11, s[16:19], s27 offen
    buffer_load_dwordx4 v[52:55], v29, s[16:19], s27 offen
    buffer_load_dwordx4 v[56:59], v30, s[16:19], s27 offen
    buffer_load_dwordx4 v[60:63], v31, s[16:19], s27 offen
    ds_read_b128 v[128:131], v20 offset:0
    ds_read_b128 v[132:135], v20 offset:2304
    ds_read_b128 v[136:139], v20 offset:4608
    ds_read_b128 v[140:143], v20 offset:6912
    ds_read_b64_tr_b16 v[144:145], v21 offset:0
    ds_read_b64_tr_b16 v[146:147], v21 offset:4608
    ds_read_b64_tr_b16 v[148:149], v21 offset:32
    ds_read_b64_tr_b16 v[150:151], v21 offset:4640
    ds_read_b64_tr_b16 v[152:153], v21 offset:64
    ds_read_b64_tr_b16 v[154:155], v21 offset:4672
    ds_read_b64_tr_b16 v[156:157], v21 offset:96
    ds_read_b64_tr_b16 v[158:159], v21 offset:4704
    s_waitcnt lgkmcnt(0)
    v_mfma_f32_16x16x32_bf16 v[64:67], v[128:131], v[144:147], v[64:67]
    v_mfma_f32_16x16x32_bf16 v[68:71], v[128:131], v[148:151], v[68:71]
    v_mfma_f32_16x16x32_bf16 v[72:75], v[128:131], v[152:155], v[72:75]
    v_mfma_f32_16x16x32_bf16 v[76:79], v[128:131], v[156:159], v[76:79]
    v_mfma_f32_16x16x32_bf16 v[80:83], v[132:135], v[144:147], v[80:83]
    v_mfma_f32_16x16x32_bf16 v[84:87], v[132:135], v[148:151], v[84:87]
    v_mfma_f32_16x16x32_bf16 v[88:91], v[132:135], v[152:155], v[88:91]
    v_mfma_f32_16x16x32_bf16 v[92:95], v[132:135], v[156:159], v[92:95]
    v_mfma_f32_16x16x32_bf16 v[96:99], v[136:139], v[144:147], v[96:99]
    v_mfma_f32_16x16x32_bf16 v[100:103], v[136:139], v[148:151], v[100:103]
    v_mfma_f32_16x16x32_bf16 v[104:107], v[136:139], v[152:155], v[104:107]
    v_mfma_f32_16x16x32_bf16 v[108:111], v[136:139], v[156:159], v[108:111]
    v_mfma_f32_16x16x32_bf16 v[112:115], v[140:143], v[144:147], v[112:115]
    v_mfma_f32_16x16x32_bf16 v[116:119], v[140:143], v[148:151], v[116:119]
    v_mfma_f32_16x16x32_bf16 v[120:123], v[140:143], v[152:155], v[120:123]
    v_mfma_f32_16x16x32_bf16 v[124:127], v[140:143], v[156:159], v[124:127]
    ds_read_b128 v[128:131], v20 offset:64
    ds_read_b128 v[132:135], v20 offset:2368
    ds_read_b128 v[136:139], v20 offset:4672
    ds_read_b128 v[140:143], v20 offset:6976
    ds_read_b64_tr_b16 v[144:145], v21 offset:9216
    ds_read_b64_tr_b16 v[146:147], v21 offset:13824
    ds_read_b64_tr_b16 v[148:149], v21 offset:9248
    ds_read_b64_tr_b16 v[150:151], v21 offset:13856
    ds_read_b64_tr_b16 v[152:153], v21 offset:9280
    ds_read_b64_tr_b16 v[154:155], v21 offset:13888
    ds_read_b64_tr_b16 v[156:157], v21 offset:9312
    ds_read_b64_tr_b16 v[158:159], v21 offset:13920
    s_waitcnt lgkmcnt(0)
    v_mfma_f32_16x16x32_bf16 v[64:67], v[128:131], v[144:147], v[64:67]
    v_mfma_f32_16x16x32_bf16 v[68:71], v[128:131], v[148:151], v[68:71]
    v_mfma_f32_16x16x32_bf16 v[72:75], v[128:131], v[152:155], v[72:75]
    v_mfma_f32_16x16x32_bf16 v[76:79], v[128:131], v[156:159], v[76:79]
    v_mfma_f32_16x16x32_bf16 v[80:83], v[132:135], v[144:147], v[80:83]
    v_mfma_f32_16x16x32_bf16 v[84:87], v[132:135], v[148:151], v[84:87]
    v_mfma_f32_16x16x32_bf16 v[88:91], v[132:135], v[152:155], v[88:91]
    v_mfma_f32_16x16x32_bf16 v[92:95], v[132:135], v[156:159], v[92:95]
    v_mfma_f32_16x16x32_bf16 v[96:99], v[136:139], v[144:147], v[96:99]
    v_mfma_f32_16x16x32_bf16 v[100:103], v[136:139], v[148:151], v[100:103]
    v_mfma_f32_16x16x32_bf16 v[104:107], v[136:139], v[152:155], v[104:107]
    v_mfma_f32_16x16x32_bf16 v[108:111], v[136:139], v[156:159], v[108:111]
    v_mfma_f32_16x16x32_bf16 v[112:115], v[140:143], v[144:147], v[112:115]
    v_mfma_f32_16x16x32_bf16 v[116:119], v[140:143], v[148:151], v[116:119]
    v_mfma_f32_16x16x32_bf16 v[120:123], v[140:143], v[152:155], v[120:123]
    v_mfma_f32_16x16x32_bf16 v[124:127], v[140:143], v[156:159], v[124:127]
    v_xor_b32 v8, 65536, v8
    v_xor_b32 v20, 65536, v20
    v_xor_b32 v21, 65536, v21

    v_xor_b32 v16, 65536, v16
    v_xor_b32 v17, 65536, v17
    v_xor_b32 v18, 65536, v18
    v_xor_b32 v19, 65536, v19
    s_cmp_ge_u32 s28, 9
    s_cbranch_scc1 v_gemm_kernel_skip2
    s_waitcnt vmcnt(0)

    ds_write_b128 v8, v[32:35] offset:0
    ds_write_b128 v8, v[36:39] offset:4608
    ds_write_b128 v8, v[40:43] offset:9216
    ds_write_b128 v8, v[44:47] offset:13824
    ds_write_b128 v16, v[48:51]
    ds_write_b128 v17, v[52:55]
    ds_write_b128 v18, v[56:59]
    ds_write_b128 v19, v[60:63]
    s_waitcnt lgkmcnt(0)
    s_barrier
    s_branch v_gemm_kernel_loop1
v_gemm_kernel_skip2:
    s_waitcnt vmcnt(0)
    s_nop 7
    s_nop 7
    s_add_u32 s32, s8, 38305792
    s_addc_u32 s33, s9, 0
    s_mov_b32 s34, 16777216
    s_mov_b32 s35, 0x00020000
    v_lshrrev_b32 v12, 1, v2
    v_and_b32 v13, 1, v2
    s_lshl_b32 s25, s22, 2
    v_lshlrev_b32 v14, 1, v12
    v_add_u32 v14, s25, v14
    v_lshlrev_b32 v14, 18, v14
    v_mul_u32_u24 v15, 64, v13
    v_add_u32 v15, v15, v3
    s_lshr_b32 s25, s24, 1
    v_add_u32 v15, s25, v15
    v_lshl_add_u32 v14, v15, 6, v14
    v_lshl_add_u32 v14, v4, 3, v14

    v_cvt_pk_bf16_f32 v64, v64, v65
    v_cvt_pk_bf16_f32 v65, v66, v67

    v_cvt_pk_bf16_f32 v68, v68, v69
    v_cvt_pk_bf16_f32 v69, v70, v71

    v_cvt_pk_bf16_f32 v72, v72, v73
    v_cvt_pk_bf16_f32 v73, v74, v75

    v_cvt_pk_bf16_f32 v76, v76, v77
    v_cvt_pk_bf16_f32 v77, v78, v79

    v_add_u32 v16, 0, v14
    buffer_store_dwordx2 v[64:65], v16, s[32:35], 0 offen
    v_add_u32 v16, 1024, v14
    buffer_store_dwordx2 v[68:69], v16, s[32:35], 0 offen
    v_add_u32 v16, 2048, v14
    buffer_store_dwordx2 v[72:73], v16, s[32:35], 0 offen
    v_add_u32 v16, 3072, v14
    buffer_store_dwordx2 v[76:77], v16, s[32:35], 0 offen
    v_cvt_pk_bf16_f32 v80, v80, v81
    v_cvt_pk_bf16_f32 v81, v82, v83

    v_cvt_pk_bf16_f32 v84, v84, v85
    v_cvt_pk_bf16_f32 v85, v86, v87

    v_cvt_pk_bf16_f32 v88, v88, v89
    v_cvt_pk_bf16_f32 v89, v90, v91

    v_cvt_pk_bf16_f32 v92, v92, v93
    v_cvt_pk_bf16_f32 v93, v94, v95

    v_add_u32 v16, 32, v14
    buffer_store_dwordx2 v[80:81], v16, s[32:35], 0 offen
    v_add_u32 v16, 1056, v14
    buffer_store_dwordx2 v[84:85], v16, s[32:35], 0 offen
    v_add_u32 v16, 2080, v14
    buffer_store_dwordx2 v[88:89], v16, s[32:35], 0 offen
    v_add_u32 v16, 3104, v14
    buffer_store_dwordx2 v[92:93], v16, s[32:35], 0 offen
    v_cvt_pk_bf16_f32 v96, v96, v97
    v_cvt_pk_bf16_f32 v97, v98, v99

    v_cvt_pk_bf16_f32 v100, v100, v101
    v_cvt_pk_bf16_f32 v101, v102, v103

    v_cvt_pk_bf16_f32 v104, v104, v105
    v_cvt_pk_bf16_f32 v105, v106, v107

    v_cvt_pk_bf16_f32 v108, v108, v109
    v_cvt_pk_bf16_f32 v109, v110, v111

    v_add_u32 v16, 262144, v14
    buffer_store_dwordx2 v[96:97], v16, s[32:35], 0 offen
    v_add_u32 v16, 263168, v14
    buffer_store_dwordx2 v[100:101], v16, s[32:35], 0 offen
    v_add_u32 v16, 264192, v14
    buffer_store_dwordx2 v[104:105], v16, s[32:35], 0 offen
    v_add_u32 v16, 265216, v14
    buffer_store_dwordx2 v[108:109], v16, s[32:35], 0 offen
    v_cvt_pk_bf16_f32 v112, v112, v113
    v_cvt_pk_bf16_f32 v113, v114, v115

    v_cvt_pk_bf16_f32 v116, v116, v117
    v_cvt_pk_bf16_f32 v117, v118, v119

    v_cvt_pk_bf16_f32 v120, v120, v121
    v_cvt_pk_bf16_f32 v121, v122, v123

    v_cvt_pk_bf16_f32 v124, v124, v125
    v_cvt_pk_bf16_f32 v125, v126, v127

    v_add_u32 v16, 262176, v14
    buffer_store_dwordx2 v[112:113], v16, s[32:35], 0 offen
    v_add_u32 v16, 263200, v14
    buffer_store_dwordx2 v[116:117], v16, s[32:35], 0 offen
    v_add_u32 v16, 264224, v14
    buffer_store_dwordx2 v[120:121], v16, s[32:35], 0 offen
    v_add_u32 v16, 265248, v14
    buffer_store_dwordx2 v[124:125], v16, s[32:35], 0 offen
v_gemm_kernel_end:
    s_endpgm
.section .rodata,"a"
.p2align 6
.amdhsa_kernel v_gemm_kernel
  .amdhsa_next_free_vgpr 160
  .amdhsa_next_free_sgpr 48
  .amdhsa_accum_offset 160
  .amdhsa_group_segment_fixed_size 0
  .amdhsa_kernarg_size 128
  .amdhsa_user_sgpr_count 2
  .amdhsa_user_sgpr_kernarg_segment_ptr 1
  .amdhsa_system_sgpr_workgroup_id_x 1
.end_amdhsa_kernel
.text
.p2align 8
.globl chain_kernel
.type chain_kernel,@function
chain_kernel:
    s_cmp_ge_u32 s2, 32
    s_cbranch_scc1 chain_kernel_end
    s_load_dwordx2 s[4:5], s[0:1], 120
    s_load_dwordx2 s[6:7], s[0:1], 8
    s_load_dwordx4 s[36:39], s[0:1], 16
    s_load_dwordx4 s[40:43], s[0:1], 32
    v_and_b32 v1, 15, v0
    v_bfe_u32 v2, v0, 4, 2
    v_lshrrev_b32 v3, 6, v0
    v_and_b32 v4, 63, v0
    s_nop 0
    v_readfirstlane_b32 s21, v3
    s_waitcnt lgkmcnt(0)

    s_mov_b32 s8, s4
    s_mov_b32 s9, s5
    s_mov_b32 s10, 103841792
    s_mov_b32 s11, 0x00020000
    s_mov_b32 s12, s6
    s_mov_b32 s13, s7
    s_mov_b32 s14, 9216
    s_mov_b32 s15, 0x00020000
    v_lshrrev_b32 v5, 4, v0
    s_lshl_b32 s22, s2, 8
    v_mul_u32_u24 v6, 8192, v5
    v_lshl_add_u32 v6, v1, 4, v6
    v_add_u32 v6, s22, v6

    v_bfe_u32 v7, v0, 2, 2
    v_lshl_add_u32 v7, v2, 2, v7
    v_mul_u32_u24 v7, 288, v7
    v_and_b32 v8, 3, v0
    v_lshlrev_b32 v8, 3, v8
    v_lshl_add_u32 v8, v3, 6, v8
    v_add_u32 v7, v7, v8

    s_mov_b32 s16, s36
    s_mov_b32 s17, s37
    s_mov_b32 s18, 4718592
    s_mov_b32 s19, 0x00020000
    s_mov_b32 s23, 0
    buffer_load_dwordx4 v[16:19], v6, s[16:19], s23 offen
    s_mov_b32 s23, 131072
    buffer_load_dwordx4 v[20:23], v6, s[16:19], s23 offen
    s_mov_b32 s23, 262144
    buffer_load_dwordx4 v[24:27], v6, s[16:19], s23 offen
    s_mov_b32 s23, 393216
    buffer_load_dwordx4 v[28:31], v6, s[16:19], s23 offen
    s_mov_b32 s23, 524288
    buffer_load_dwordx4 v[32:35], v6, s[16:19], s23 offen
    s_mov_b32 s23, 655360
    buffer_load_dwordx4 v[36:39], v6, s[16:19], s23 offen
    s_waitcnt vmcnt(0)
    v_add_u32 v9, 0, v5
    v_and_b32 v10, 0xffffffe0, v9
    v_bfe_u32 v11, v9, 2, 1
    v_lshl_add_u32 v10, v11, 4, v10
    v_bfe_u32 v11, v9, 3, 2
    v_lshl_add_u32 v10, v11, 2, v10
    v_and_b32 v11, 3, v9
    v_add_u32 v10, v10, v11
    v_mul_u32_u24 v10, 288, v10
    v_lshl_add_u32 v10, v1, 4, v10
    ds_write_b128 v10, v[16:19]

    v_add_u32 v9, 16, v5
    v_and_b32 v10, 0xffffffe0, v9
    v_bfe_u32 v11, v9, 2, 1
    v_lshl_add_u32 v10, v11, 4, v10
    v_bfe_u32 v11, v9, 3, 2
    v_lshl_add_u32 v10, v11, 2, v10
    v_and_b32 v11, 3, v9
    v_add_u32 v10, v10, v11
    v_mul_u32_u24 v10, 288, v10
    v_lshl_add_u32 v10, v1, 4, v10
    ds_write_b128 v10, v[20:23]

    v_add_u32 v9, 32, v5
    v_and_b32 v10, 0xffffffe0, v9
    v_bfe_u32 v11, v9, 2, 1
    v_lshl_add_u32 v10, v11, 4, v10
    v_bfe_u32 v11, v9, 3, 2
    v_lshl_add_u32 v10, v11, 2, v10
    v_and_b32 v11, 3, v9
    v_add_u32 v10, v10, v11
    v_mul_u32_u24 v10, 288, v10
    v_lshl_add_u32 v10, v1, 4, v10
    ds_write_b128 v10, v[24:27]

    v_add_u32 v9, 48, v5
    v_and_b32 v10, 0xffffffe0, v9
    v_bfe_u32 v11, v9, 2, 1
    v_lshl_add_u32 v10, v11, 4, v10
    v_bfe_u32 v11, v9, 3, 2
    v_lshl_add_u32 v10, v11, 2, v10
    v_and_b32 v11, 3, v9
    v_add_u32 v10, v10, v11
    v_mul_u32_u24 v10, 288, v10
    v_lshl_add_u32 v10, v1, 4, v10
    ds_write_b128 v10, v[28:31]

    v_add_u32 v9, 64, v5
    v_and_b32 v10, 0xffffffe0, v9
    v_bfe_u32 v11, v9, 2, 1
    v_lshl_add_u32 v10, v11, 4, v10
    v_bfe_u32 v11, v9, 3, 2
    v_lshl_add_u32 v10, v11, 2, v10
    v_and_b32 v11, 3, v9
    v_add_u32 v10, v10, v11
    v_mul_u32_u24 v10, 288, v10
    v_lshl_add_u32 v10, v1, 4, v10
    ds_write_b128 v10, v[32:35]

    v_add_u32 v9, 80, v5
    v_and_b32 v10, 0xffffffe0, v9
    v_bfe_u32 v11, v9, 2, 1
    v_lshl_add_u32 v10, v11, 4, v10
    v_bfe_u32 v11, v9, 3, 2
    v_lshl_add_u32 v10, v11, 2, v10
    v_and_b32 v11, 3, v9
    v_add_u32 v10, v10, v11
    v_mul_u32_u24 v10, 288, v10
    v_lshl_add_u32 v10, v1, 4, v10
    ds_write_b128 v10, v[36:39]

    s_mov_b32 s23, 786432
    buffer_load_dwordx4 v[16:19], v6, s[16:19], s23 offen
    s_mov_b32 s23, 917504
    buffer_load_dwordx4 v[20:23], v6, s[16:19], s23 offen
    s_mov_b32 s23, 1048576
    buffer_load_dwordx4 v[24:27], v6, s[16:19], s23 offen
    s_mov_b32 s23, 1179648
    buffer_load_dwordx4 v[28:31], v6, s[16:19], s23 offen
    s_mov_b32 s23, 1310720
    buffer_load_dwordx4 v[32:35], v6, s[16:19], s23 offen
    s_mov_b32 s23, 1441792
    buffer_load_dwordx4 v[36:39], v6, s[16:19], s23 offen
    s_waitcnt vmcnt(0)
    v_add_u32 v9, 96, v5
    v_and_b32 v10, 0xffffffe0, v9
    v_bfe_u32 v11, v9, 2, 1
    v_lshl_add_u32 v10, v11, 4, v10
    v_bfe_u32 v11, v9, 3, 2
    v_lshl_add_u32 v10, v11, 2, v10
    v_and_b32 v11, 3, v9
    v_add_u32 v10, v10, v11
    v_mul_u32_u24 v10, 288, v10
    v_lshl_add_u32 v10, v1, 4, v10
    ds_write_b128 v10, v[16:19]

    v_add_u32 v9, 112, v5
    v_and_b32 v10, 0xffffffe0, v9
    v_bfe_u32 v11, v9, 2, 1
    v_lshl_add_u32 v10, v11, 4, v10
    v_bfe_u32 v11, v9, 3, 2
    v_lshl_add_u32 v10, v11, 2, v10
    v_and_b32 v11, 3, v9
    v_add_u32 v10, v10, v11
    v_mul_u32_u24 v10, 288, v10
    v_lshl_add_u32 v10, v1, 4, v10
    ds_write_b128 v10, v[20:23]

    v_add_u32 v9, 128, v5
    v_and_b32 v10, 0xffffffe0, v9
    v_bfe_u32 v11, v9, 2, 1
    v_lshl_add_u32 v10, v11, 4, v10
    v_bfe_u32 v11, v9, 3, 2
    v_lshl_add_u32 v10, v11, 2, v10
    v_and_b32 v11, 3, v9
    v_add_u32 v10, v10, v11
    v_mul_u32_u24 v10, 288, v10
    v_lshl_add_u32 v10, v1, 4, v10
    ds_write_b128 v10, v[24:27]

    v_add_u32 v9, 144, v5
    v_and_b32 v10, 0xffffffe0, v9
    v_bfe_u32 v11, v9, 2, 1
    v_lshl_add_u32 v10, v11, 4, v10
    v_bfe_u32 v11, v9, 3, 2
    v_lshl_add_u32 v10, v11, 2, v10
    v_and_b32 v11, 3, v9
    v_add_u32 v10, v10, v11
    v_mul_u32_u24 v10, 288, v10
    v_lshl_add_u32 v10, v1, 4, v10
    ds_write_b128 v10, v[28:31]

    v_add_u32 v9, 160, v5
    v_and_b32 v10, 0xffffffe0, v9
    v_bfe_u32 v11, v9, 2, 1
    v_lshl_add_u32 v10, v11, 4, v10
    v_bfe_u32 v11, v9, 3, 2
    v_lshl_add_u32 v10, v11, 2, v10
    v_and_b32 v11, 3, v9
    v_add_u32 v10, v10, v11
    v_mul_u32_u24 v10, 288, v10
    v_lshl_add_u32 v10, v1, 4, v10
    ds_write_b128 v10, v[32:35]

    v_add_u32 v9, 176, v5
    v_and_b32 v10, 0xffffffe0, v9
    v_bfe_u32 v11, v9, 2, 1
    v_lshl_add_u32 v10, v11, 4, v10
    v_bfe_u32 v11, v9, 3, 2
    v_lshl_add_u32 v10, v11, 2, v10
    v_and_b32 v11, 3, v9
    v_add_u32 v10, v10, v11
    v_mul_u32_u24 v10, 288, v10
    v_lshl_add_u32 v10, v1, 4, v10
    ds_write_b128 v10, v[36:39]

    s_mov_b32 s23, 1572864
    buffer_load_dwordx4 v[16:19], v6, s[16:19], s23 offen
    s_mov_b32 s23, 1703936
    buffer_load_dwordx4 v[20:23], v6, s[16:19], s23 offen
    s_mov_b32 s23, 1835008
    buffer_load_dwordx4 v[24:27], v6, s[16:19], s23 offen
    s_mov_b32 s23, 1966080
    buffer_load_dwordx4 v[28:31], v6, s[16:19], s23 offen
    s_mov_b32 s23, 2097152
    buffer_load_dwordx4 v[32:35], v6, s[16:19], s23 offen
    s_mov_b32 s23, 2228224
    buffer_load_dwordx4 v[36:39], v6, s[16:19], s23 offen
    s_waitcnt vmcnt(0)
    v_add_u32 v9, 192, v5
    v_and_b32 v10, 0xffffffe0, v9
    v_bfe_u32 v11, v9, 2, 1
    v_lshl_add_u32 v10, v11, 4, v10
    v_bfe_u32 v11, v9, 3, 2
    v_lshl_add_u32 v10, v11, 2, v10
    v_and_b32 v11, 3, v9
    v_add_u32 v10, v10, v11
    v_mul_u32_u24 v10, 288, v10
    v_lshl_add_u32 v10, v1, 4, v10
    ds_write_b128 v10, v[16:19]

    v_add_u32 v9, 208, v5
    v_and_b32 v10, 0xffffffe0, v9
    v_bfe_u32 v11, v9, 2, 1
    v_lshl_add_u32 v10, v11, 4, v10
    v_bfe_u32 v11, v9, 3, 2
    v_lshl_add_u32 v10, v11, 2, v10
    v_and_b32 v11, 3, v9
    v_add_u32 v10, v10, v11
    v_mul_u32_u24 v10, 288, v10
    v_lshl_add_u32 v10, v1, 4, v10
    ds_write_b128 v10, v[20:23]

    v_add_u32 v9, 224, v5
    v_and_b32 v10, 0xffffffe0, v9
    v_bfe_u32 v11, v9, 2, 1
    v_lshl_add_u32 v10, v11, 4, v10
    v_bfe_u32 v11, v9, 3, 2
    v_lshl_add_u32 v10, v11, 2, v10
    v_and_b32 v11, 3, v9
    v_add_u32 v10, v10, v11
    v_mul_u32_u24 v10, 288, v10
    v_lshl_add_u32 v10, v1, 4, v10
    ds_write_b128 v10, v[24:27]

    v_add_u32 v9, 240, v5
    v_and_b32 v10, 0xffffffe0, v9
    v_bfe_u32 v11, v9, 2, 1
    v_lshl_add_u32 v10, v11, 4, v10
    v_bfe_u32 v11, v9, 3, 2
    v_lshl_add_u32 v10, v11, 2, v10
    v_and_b32 v11, 3, v9
    v_add_u32 v10, v10, v11
    v_mul_u32_u24 v10, 288, v10
    v_lshl_add_u32 v10, v1, 4, v10
    ds_write_b128 v10, v[28:31]

    v_add_u32 v9, 256, v5
    v_and_b32 v10, 0xffffffe0, v9
    v_bfe_u32 v11, v9, 2, 1
    v_lshl_add_u32 v10, v11, 4, v10
    v_bfe_u32 v11, v9, 3, 2
    v_lshl_add_u32 v10, v11, 2, v10
    v_and_b32 v11, 3, v9
    v_add_u32 v10, v10, v11
    v_mul_u32_u24 v10, 288, v10
    v_lshl_add_u32 v10, v1, 4, v10
    ds_write_b128 v10, v[32:35]

    v_add_u32 v9, 272, v5
    v_and_b32 v10, 0xffffffe0, v9
    v_bfe_u32 v11, v9, 2, 1
    v_lshl_add_u32 v10, v11, 4, v10
    v_bfe_u32 v11, v9, 3, 2
    v_lshl_add_u32 v10, v11, 2, v10
    v_and_b32 v11, 3, v9
    v_add_u32 v10, v10, v11
    v_mul_u32_u24 v10, 288, v10
    v_lshl_add_u32 v10, v1, 4, v10
    ds_write_b128 v10, v[36:39]

    s_waitcnt lgkmcnt(0)
    s_barrier
    v_add_u32 v8, 46080, v7
    ds_read_b64_tr_b16 a[0:1], v7 offset:0
    ds_read_b64_tr_b16 a[2:3], v7 offset:4608
    ds_read_b64_tr_b16 a[4:5], v7 offset:32
    ds_read_b64_tr_b16 a[6:7], v7 offset:4640
    ds_read_b64_tr_b16 a[8:9], v7 offset:9216
    ds_read_b64_tr_b16 a[10:11], v7 offset:13824
    ds_read_b64_tr_b16 a[12:13], v7 offset:9248
    ds_read_b64_tr_b16 a[14:15], v7 offset:13856
    ds_read_b64_tr_b16 a[16:17], v7 offset:18432
    ds_read_b64_tr_b16 a[18:19], v7 offset:23040
    ds_read_b64_tr_b16 a[20:21], v7 offset:18464
    ds_read_b64_tr_b16 a[22:23], v7 offset:23072
    ds_read_b64_tr_b16 a[24:25], v7 offset:27648
    ds_read_b64_tr_b16 a[26:27], v7 offset:32256
    ds_read_b64_tr_b16 a[28:29], v7 offset:27680
    ds_read_b64_tr_b16 a[30:31], v7 offset:32288
    ds_read_b64_tr_b16 a[32:33], v7 offset:36864
    ds_read_b64_tr_b16 a[34:35], v7 offset:41472
    ds_read_b64_tr_b16 a[36:37], v7 offset:36896
    ds_read_b64_tr_b16 a[38:39], v7 offset:41504
    ds_read_b64_tr_b16 a[40:41], v8 offset:0
    ds_read_b64_tr_b16 a[42:43], v8 offset:4608
    ds_read_b64_tr_b16 a[44:45], v8 offset:32
    ds_read_b64_tr_b16 a[46:47], v8 offset:4640
    ds_read_b64_tr_b16 a[48:49], v8 offset:9216
    ds_read_b64_tr_b16 a[50:51], v8 offset:13824
    ds_read_b64_tr_b16 a[52:53], v8 offset:9248
    ds_read_b64_tr_b16 a[54:55], v8 offset:13856
    ds_read_b64_tr_b16 a[56:57], v8 offset:18432
    ds_read_b64_tr_b16 a[58:59], v8 offset:23040
    ds_read_b64_tr_b16 a[60:61], v8 offset:18464
    ds_read_b64_tr_b16 a[62:63], v8 offset:23072
    ds_read_b64_tr_b16 a[64:65], v8 offset:27648
    ds_read_b64_tr_b16 a[66:67], v8 offset:32256
    ds_read_b64_tr_b16 a[68:69], v8 offset:27680
    ds_read_b64_tr_b16 a[70:71], v8 offset:32288
    s_waitcnt lgkmcnt(0)
    s_barrier
    s_mov_b32 s23, 2359296
    buffer_load_dwordx4 v[16:19], v6, s[16:19], s23 offen
    s_mov_b32 s23, 2490368
    buffer_load_dwordx4 v[20:23], v6, s[16:19], s23 offen
    s_mov_b32 s23, 2621440
    buffer_load_dwordx4 v[24:27], v6, s[16:19], s23 offen
    s_mov_b32 s23, 2752512
    buffer_load_dwordx4 v[28:31], v6, s[16:19], s23 offen
    s_mov_b32 s23, 2883584
    buffer_load_dwordx4 v[32:35], v6, s[16:19], s23 offen
    s_mov_b32 s23, 3014656
    buffer_load_dwordx4 v[36:39], v6, s[16:19], s23 offen
    s_waitcnt vmcnt(0)
    v_add_u32 v9, 0, v5
    v_and_b32 v10, 0xffffffe0, v9
    v_bfe_u32 v11, v9, 2, 1
    v_lshl_add_u32 v10, v11, 4, v10
    v_bfe_u32 v11, v9, 3, 2
    v_lshl_add_u32 v10, v11, 2, v10
    v_and_b32 v11, 3, v9
    v_add_u32 v10, v10, v11
    v_mul_u32_u24 v10, 288, v10
    v_lshl_add_u32 v10, v1, 4, v10
    ds_write_b128 v10, v[16:19]

    v_add_u32 v9, 16, v5
    v_and_b32 v10, 0xffffffe0, v9
    v_bfe_u32 v11, v9, 2, 1
    v_lshl_add_u32 v10, v11, 4, v10
    v_bfe_u32 v11, v9, 3, 2
    v_lshl_add_u32 v10, v11, 2, v10
    v_and_b32 v11, 3, v9
    v_add_u32 v10, v10, v11
    v_mul_u32_u24 v10, 288, v10
    v_lshl_add_u32 v10, v1, 4, v10
    ds_write_b128 v10, v[20:23]

    v_add_u32 v9, 32, v5
    v_and_b32 v10, 0xffffffe0, v9
    v_bfe_u32 v11, v9, 2, 1
    v_lshl_add_u32 v10, v11, 4, v10
    v_bfe_u32 v11, v9, 3, 2
    v_lshl_add_u32 v10, v11, 2, v10
    v_and_b32 v11, 3, v9
    v_add_u32 v10, v10, v11
    v_mul_u32_u24 v10, 288, v10
    v_lshl_add_u32 v10, v1, 4, v10
    ds_write_b128 v10, v[24:27]

    v_add_u32 v9, 48, v5
    v_and_b32 v10, 0xffffffe0, v9
    v_bfe_u32 v11, v9, 2, 1
    v_lshl_add_u32 v10, v11, 4, v10
    v_bfe_u32 v11, v9, 3, 2
    v_lshl_add_u32 v10, v11, 2, v10
    v_and_b32 v11, 3, v9
    v_add_u32 v10, v10, v11
    v_mul_u32_u24 v10, 288, v10
    v_lshl_add_u32 v10, v1, 4, v10
    ds_write_b128 v10, v[28:31]

    v_add_u32 v9, 64, v5
    v_and_b32 v10, 0xffffffe0, v9
    v_bfe_u32 v11, v9, 2, 1
    v_lshl_add_u32 v10, v11, 4, v10
    v_bfe_u32 v11, v9, 3, 2
    v_lshl_add_u32 v10, v11, 2, v10
    v_and_b32 v11, 3, v9
    v_add_u32 v10, v10, v11
    v_mul_u32_u24 v10, 288, v10
    v_lshl_add_u32 v10, v1, 4, v10
    ds_write_b128 v10, v[32:35]

    v_add_u32 v9, 80, v5
    v_and_b32 v10, 0xffffffe0, v9
    v_bfe_u32 v11, v9, 2, 1
    v_lshl_add_u32 v10, v11, 4, v10
    v_bfe_u32 v11, v9, 3, 2
    v_lshl_add_u32 v10, v11, 2, v10
    v_and_b32 v11, 3, v9
    v_add_u32 v10, v10, v11
    v_mul_u32_u24 v10, 288, v10
    v_lshl_add_u32 v10, v1, 4, v10
    ds_write_b128 v10, v[36:39]

    s_mov_b32 s23, 3145728
    buffer_load_dwordx4 v[16:19], v6, s[16:19], s23 offen
    s_mov_b32 s23, 3276800
    buffer_load_dwordx4 v[20:23], v6, s[16:19], s23 offen
    s_mov_b32 s23, 3407872
    buffer_load_dwordx4 v[24:27], v6, s[16:19], s23 offen
    s_mov_b32 s23, 3538944
    buffer_load_dwordx4 v[28:31], v6, s[16:19], s23 offen
    s_mov_b32 s23, 3670016
    buffer_load_dwordx4 v[32:35], v6, s[16:19], s23 offen
    s_mov_b32 s23, 3801088
    buffer_load_dwordx4 v[36:39], v6, s[16:19], s23 offen
    s_waitcnt vmcnt(0)
    v_add_u32 v9, 96, v5
    v_and_b32 v10, 0xffffffe0, v9
    v_bfe_u32 v11, v9, 2, 1
    v_lshl_add_u32 v10, v11, 4, v10
    v_bfe_u32 v11, v9, 3, 2
    v_lshl_add_u32 v10, v11, 2, v10
    v_and_b32 v11, 3, v9
    v_add_u32 v10, v10, v11
    v_mul_u32_u24 v10, 288, v10
    v_lshl_add_u32 v10, v1, 4, v10
    ds_write_b128 v10, v[16:19]

    v_add_u32 v9, 112, v5
    v_and_b32 v10, 0xffffffe0, v9
    v_bfe_u32 v11, v9, 2, 1
    v_lshl_add_u32 v10, v11, 4, v10
    v_bfe_u32 v11, v9, 3, 2
    v_lshl_add_u32 v10, v11, 2, v10
    v_and_b32 v11, 3, v9
    v_add_u32 v10, v10, v11
    v_mul_u32_u24 v10, 288, v10
    v_lshl_add_u32 v10, v1, 4, v10
    ds_write_b128 v10, v[20:23]

    v_add_u32 v9, 128, v5
    v_and_b32 v10, 0xffffffe0, v9
    v_bfe_u32 v11, v9, 2, 1
    v_lshl_add_u32 v10, v11, 4, v10
    v_bfe_u32 v11, v9, 3, 2
    v_lshl_add_u32 v10, v11, 2, v10
    v_and_b32 v11, 3, v9
    v_add_u32 v10, v10, v11
    v_mul_u32_u24 v10, 288, v10
    v_lshl_add_u32 v10, v1, 4, v10
    ds_write_b128 v10, v[24:27]

    v_add_u32 v9, 144, v5
    v_and_b32 v10, 0xffffffe0, v9
    v_bfe_u32 v11, v9, 2, 1
    v_lshl_add_u32 v10, v11, 4, v10
    v_bfe_u32 v11, v9, 3, 2
    v_lshl_add_u32 v10, v11, 2, v10
    v_and_b32 v11, 3, v9
    v_add_u32 v10, v10, v11
    v_mul_u32_u24 v10, 288, v10
    v_lshl_add_u32 v10, v1, 4, v10
    ds_write_b128 v10, v[28:31]

    v_add_u32 v9, 160, v5
    v_and_b32 v10, 0xffffffe0, v9
    v_bfe_u32 v11, v9, 2, 1
    v_lshl_add_u32 v10, v11, 4, v10
    v_bfe_u32 v11, v9, 3, 2
    v_lshl_add_u32 v10, v11, 2, v10
    v_and_b32 v11, 3, v9
    v_add_u32 v10, v10, v11
    v_mul_u32_u24 v10, 288, v10
    v_lshl_add_u32 v10, v1, 4, v10
    ds_write_b128 v10, v[32:35]

    v_add_u32 v9, 176, v5
    v_and_b32 v10, 0xffffffe0, v9
    v_bfe_u32 v11, v9, 2, 1
    v_lshl_add_u32 v10, v11, 4, v10
    v_bfe_u32 v11, v9, 3, 2
    v_lshl_add_u32 v10, v11, 2, v10
    v_and_b32 v11, 3, v9
    v_add_u32 v10, v10, v11
    v_mul_u32_u24 v10, 288, v10
    v_lshl_add_u32 v10, v1, 4, v10
    ds_write_b128 v10, v[36:39]

    s_mov_b32 s23, 3932160
    buffer_load_dwordx4 v[16:19], v6, s[16:19], s23 offen
    s_mov_b32 s23, 4063232
    buffer_load_dwordx4 v[20:23], v6, s[16:19], s23 offen
    s_mov_b32 s23, 4194304
    buffer_load_dwordx4 v[24:27], v6, s[16:19], s23 offen
    s_mov_b32 s23, 4325376
    buffer_load_dwordx4 v[28:31], v6, s[16:19], s23 offen
    s_mov_b32 s23, 4456448
    buffer_load_dwordx4 v[32:35], v6, s[16:19], s23 offen
    s_mov_b32 s23, 4587520
    buffer_load_dwordx4 v[36:39], v6, s[16:19], s23 offen
    s_waitcnt vmcnt(0)
    v_add_u32 v9, 192, v5
    v_and_b32 v10, 0xffffffe0, v9
    v_bfe_u32 v11, v9, 2, 1
    v_lshl_add_u32 v10, v11, 4, v10
    v_bfe_u32 v11, v9, 3, 2
    v_lshl_add_u32 v10, v11, 2, v10
    v_and_b32 v11, 3, v9
    v_add_u32 v10, v10, v11
    v_mul_u32_u24 v10, 288, v10
    v_lshl_add_u32 v10, v1, 4, v10
    ds_write_b128 v10, v[16:19]

    v_add_u32 v9, 208, v5
    v_and_b32 v10, 0xffffffe0, v9
    v_bfe_u32 v11, v9, 2, 1
    v_lshl_add_u32 v10, v11, 4, v10
    v_bfe_u32 v11, v9, 3, 2
    v_lshl_add_u32 v10, v11, 2, v10
    v_and_b32 v11, 3, v9
    v_add_u32 v10, v10, v11
    v_mul_u32_u24 v10, 288, v10
    v_lshl_add_u32 v10, v1, 4, v10
    ds_write_b128 v10, v[20:23]

    v_add_u32 v9, 224, v5
    v_and_b32 v10, 0xffffffe0, v9
    v_bfe_u32 v11, v9, 2, 1
    v_lshl_add_u32 v10, v11, 4, v10
    v_bfe_u32 v11, v9, 3, 2
    v_lshl_add_u32 v10, v11, 2, v10
    v_and_b32 v11, 3, v9
    v_add_u32 v10, v10, v11
    v_mul_u32_u24 v10, 288, v10
    v_lshl_add_u32 v10, v1, 4, v10
    ds_write_b128 v10, v[24:27]

    v_add_u32 v9, 240, v5
    v_and_b32 v10, 0xffffffe0, v9
    v_bfe_u32 v11, v9, 2, 1
    v_lshl_add_u32 v10, v11, 4, v10
    v_bfe_u32 v11, v9, 3, 2
    v_lshl_add_u32 v10, v11, 2, v10
    v_and_b32 v11, 3, v9
    v_add_u32 v10, v10, v11
    v_mul_u32_u24 v10, 288, v10
    v_lshl_add_u32 v10, v1, 4, v10
    ds_write_b128 v10, v[28:31]

    v_add_u32 v9, 256, v5
    v_and_b32 v10, 0xffffffe0, v9
    v_bfe_u32 v11, v9, 2, 1
    v_lshl_add_u32 v10, v11, 4, v10
    v_bfe_u32 v11, v9, 3, 2
    v_lshl_add_u32 v10, v11, 2, v10
    v_and_b32 v11, 3, v9
    v_add_u32 v10, v10, v11
    v_mul_u32_u24 v10, 288, v10
    v_lshl_add_u32 v10, v1, 4, v10
    ds_write_b128 v10, v[32:35]

    v_add_u32 v9, 272, v5
    v_and_b32 v10, 0xffffffe0, v9
    v_bfe_u32 v11, v9, 2, 1
    v_lshl_add_u32 v10, v11, 4, v10
    v_bfe_u32 v11, v9, 3, 2
    v_lshl_add_u32 v10, v11, 2, v10
    v_and_b32 v11, 3, v9
    v_add_u32 v10, v10, v11
    v_mul_u32_u24 v10, 288, v10
    v_lshl_add_u32 v10, v1, 4, v10
    ds_write_b128 v10, v[36:39]

    s_waitcnt lgkmcnt(0)
    s_barrier
    v_add_u32 v8, 46080, v7
    ds_read_b64_tr_b16 a[72:73], v7 offset:0
    ds_read_b64_tr_b16 a[74:75], v7 offset:4608
    ds_read_b64_tr_b16 a[76:77], v7 offset:32
    ds_read_b64_tr_b16 a[78:79], v7 offset:4640
    ds_read_b64_tr_b16 a[80:81], v7 offset:9216
    ds_read_b64_tr_b16 a[82:83], v7 offset:13824
    ds_read_b64_tr_b16 a[84:85], v7 offset:9248
    ds_read_b64_tr_b16 a[86:87], v7 offset:13856
    ds_read_b64_tr_b16 a[88:89], v7 offset:18432
    ds_read_b64_tr_b16 a[90:91], v7 offset:23040
    ds_read_b64_tr_b16 a[92:93], v7 offset:18464
    ds_read_b64_tr_b16 a[94:95], v7 offset:23072
    ds_read_b64_tr_b16 a[96:97], v7 offset:27648
    ds_read_b64_tr_b16 a[98:99], v7 offset:32256
    ds_read_b64_tr_b16 a[100:101], v7 offset:27680
    ds_read_b64_tr_b16 a[102:103], v7 offset:32288
    ds_read_b64_tr_b16 a[104:105], v7 offset:36864
    ds_read_b64_tr_b16 a[106:107], v7 offset:41472
    ds_read_b64_tr_b16 a[108:109], v7 offset:36896
    ds_read_b64_tr_b16 a[110:111], v7 offset:41504
    ds_read_b64_tr_b16 a[112:113], v8 offset:0
    ds_read_b64_tr_b16 a[114:115], v8 offset:4608
    ds_read_b64_tr_b16 a[116:117], v8 offset:32
    ds_read_b64_tr_b16 a[118:119], v8 offset:4640
    ds_read_b64_tr_b16 a[120:121], v8 offset:9216
    ds_read_b64_tr_b16 a[122:123], v8 offset:13824
    ds_read_b64_tr_b16 a[124:125], v8 offset:9248
    ds_read_b64_tr_b16 a[126:127], v8 offset:13856
    ds_read_b64_tr_b16 a[128:129], v8 offset:18432
    ds_read_b64_tr_b16 a[130:131], v8 offset:23040
    ds_read_b64_tr_b16 a[132:133], v8 offset:18464
    ds_read_b64_tr_b16 a[134:135], v8 offset:23072
    ds_read_b64_tr_b16 a[136:137], v8 offset:27648
    ds_read_b64_tr_b16 a[138:139], v8 offset:32256
    ds_read_b64_tr_b16 a[140:141], v8 offset:27680
    ds_read_b64_tr_b16 a[142:143], v8 offset:32288
    s_waitcnt lgkmcnt(0)
    s_barrier
    s_mov_b32 s16, s38
    s_mov_b32 s17, s39
    s_mov_b32 s18, 4718592
    s_mov_b32 s19, 0x00020000
    s_mov_b32 s23, 0
    buffer_load_dwordx4 v[16:19], v6, s[16:19], s23 offen
    s_mov_b32 s23, 131072
    buffer_load_dwordx4 v[20:23], v6, s[16:19], s23 offen
    s_mov_b32 s23, 262144
    buffer_load_dwordx4 v[24:27], v6, s[16:19], s23 offen
    s_mov_b32 s23, 393216
    buffer_load_dwordx4 v[28:31], v6, s[16:19], s23 offen
    s_mov_b32 s23, 524288
    buffer_load_dwordx4 v[32:35], v6, s[16:19], s23 offen
    s_mov_b32 s23, 655360
    buffer_load_dwordx4 v[36:39], v6, s[16:19], s23 offen
    s_waitcnt vmcnt(0)
    v_add_u32 v9, 0, v5
    v_and_b32 v10, 0xffffffe0, v9
    v_bfe_u32 v11, v9, 2, 1
    v_lshl_add_u32 v10, v11, 4, v10
    v_bfe_u32 v11, v9, 3, 2
    v_lshl_add_u32 v10, v11, 2, v10
    v_and_b32 v11, 3, v9
    v_add_u32 v10, v10, v11
    v_mul_u32_u24 v10, 288, v10
    v_lshl_add_u32 v10, v1, 4, v10
    ds_write_b128 v10, v[16:19]

    v_add_u32 v9, 16, v5
    v_and_b32 v10, 0xffffffe0, v9
    v_bfe_u32 v11, v9, 2, 1
    v_lshl_add_u32 v10, v11, 4, v10
    v_bfe_u32 v11, v9, 3, 2
    v_lshl_add_u32 v10, v11, 2, v10
    v_and_b32 v11, 3, v9
    v_add_u32 v10, v10, v11
    v_mul_u32_u24 v10, 288, v10
    v_lshl_add_u32 v10, v1, 4, v10
    ds_write_b128 v10, v[20:23]

    v_add_u32 v9, 32, v5
    v_and_b32 v10, 0xffffffe0, v9
    v_bfe_u32 v11, v9, 2, 1
    v_lshl_add_u32 v10, v11, 4, v10
    v_bfe_u32 v11, v9, 3, 2
    v_lshl_add_u32 v10, v11, 2, v10
    v_and_b32 v11, 3, v9
    v_add_u32 v10, v10, v11
    v_mul_u32_u24 v10, 288, v10
    v_lshl_add_u32 v10, v1, 4, v10
    ds_write_b128 v10, v[24:27]

    v_add_u32 v9, 48, v5
    v_and_b32 v10, 0xffffffe0, v9
    v_bfe_u32 v11, v9, 2, 1
    v_lshl_add_u32 v10, v11, 4, v10
    v_bfe_u32 v11, v9, 3, 2
    v_lshl_add_u32 v10, v11, 2, v10
    v_and_b32 v11, 3, v9
    v_add_u32 v10, v10, v11
    v_mul_u32_u24 v10, 288, v10
    v_lshl_add_u32 v10, v1, 4, v10
    ds_write_b128 v10, v[28:31]

    v_add_u32 v9, 64, v5
    v_and_b32 v10, 0xffffffe0, v9
    v_bfe_u32 v11, v9, 2, 1
    v_lshl_add_u32 v10, v11, 4, v10
    v_bfe_u32 v11, v9, 3, 2
    v_lshl_add_u32 v10, v11, 2, v10
    v_and_b32 v11, 3, v9
    v_add_u32 v10, v10, v11
    v_mul_u32_u24 v10, 288, v10
    v_lshl_add_u32 v10, v1, 4, v10
    ds_write_b128 v10, v[32:35]

    v_add_u32 v9, 80, v5
    v_and_b32 v10, 0xffffffe0, v9
    v_bfe_u32 v11, v9, 2, 1
    v_lshl_add_u32 v10, v11, 4, v10
    v_bfe_u32 v11, v9, 3, 2
    v_lshl_add_u32 v10, v11, 2, v10
    v_and_b32 v11, 3, v9
    v_add_u32 v10, v10, v11
    v_mul_u32_u24 v10, 288, v10
    v_lshl_add_u32 v10, v1, 4, v10
    ds_write_b128 v10, v[36:39]

    s_mov_b32 s23, 786432
    buffer_load_dwordx4 v[16:19], v6, s[16:19], s23 offen
    s_mov_b32 s23, 917504
    buffer_load_dwordx4 v[20:23], v6, s[16:19], s23 offen
    s_mov_b32 s23, 1048576
    buffer_load_dwordx4 v[24:27], v6, s[16:19], s23 offen
    s_mov_b32 s23, 1179648
    buffer_load_dwordx4 v[28:31], v6, s[16:19], s23 offen
    s_mov_b32 s23, 1310720
    buffer_load_dwordx4 v[32:35], v6, s[16:19], s23 offen
    s_mov_b32 s23, 1441792
    buffer_load_dwordx4 v[36:39], v6, s[16:19], s23 offen
    s_waitcnt vmcnt(0)
    v_add_u32 v9, 96, v5
    v_and_b32 v10, 0xffffffe0, v9
    v_bfe_u32 v11, v9, 2, 1
    v_lshl_add_u32 v10, v11, 4, v10
    v_bfe_u32 v11, v9, 3, 2
    v_lshl_add_u32 v10, v11, 2, v10
    v_and_b32 v11, 3, v9
    v_add_u32 v10, v10, v11
    v_mul_u32_u24 v10, 288, v10
    v_lshl_add_u32 v10, v1, 4, v10
    ds_write_b128 v10, v[16:19]

    v_add_u32 v9, 112, v5
    v_and_b32 v10, 0xffffffe0, v9
    v_bfe_u32 v11, v9, 2, 1
    v_lshl_add_u32 v10, v11, 4, v10
    v_bfe_u32 v11, v9, 3, 2
    v_lshl_add_u32 v10, v11, 2, v10
    v_and_b32 v11, 3, v9
    v_add_u32 v10, v10, v11
    v_mul_u32_u24 v10, 288, v10
    v_lshl_add_u32 v10, v1, 4, v10
    ds_write_b128 v10, v[20:23]

    v_add_u32 v9, 128, v5
    v_and_b32 v10, 0xffffffe0, v9
    v_bfe_u32 v11, v9, 2, 1
    v_lshl_add_u32 v10, v11, 4, v10
    v_bfe_u32 v11, v9, 3, 2
    v_lshl_add_u32 v10, v11, 2, v10
    v_and_b32 v11, 3, v9
    v_add_u32 v10, v10, v11
    v_mul_u32_u24 v10, 288, v10
    v_lshl_add_u32 v10, v1, 4, v10
    ds_write_b128 v10, v[24:27]

    v_add_u32 v9, 144, v5
    v_and_b32 v10, 0xffffffe0, v9
    v_bfe_u32 v11, v9, 2, 1
    v_lshl_add_u32 v10, v11, 4, v10
    v_bfe_u32 v11, v9, 3, 2
    v_lshl_add_u32 v10, v11, 2, v10
    v_and_b32 v11, 3, v9
    v_add_u32 v10, v10, v11
    v_mul_u32_u24 v10, 288, v10
    v_lshl_add_u32 v10, v1, 4, v10
    ds_write_b128 v10, v[28:31]

    v_add_u32 v9, 160, v5
    v_and_b32 v10, 0xffffffe0, v9
    v_bfe_u32 v11, v9, 2, 1
    v_lshl_add_u32 v10, v11, 4, v10
    v_bfe_u32 v11, v9, 3, 2
    v_lshl_add_u32 v10, v11, 2, v10
    v_and_b32 v11, 3, v9
    v_add_u32 v10, v10, v11
    v_mul_u32_u24 v10, 288, v10
    v_lshl_add_u32 v10, v1, 4, v10
    ds_write_b128 v10, v[32:35]

    v_add_u32 v9, 176, v5
    v_and_b32 v10, 0xffffffe0, v9
    v_bfe_u32 v11, v9, 2, 1
    v_lshl_add_u32 v10, v11, 4, v10
    v_bfe_u32 v11, v9, 3, 2
    v_lshl_add_u32 v10, v11, 2, v10
    v_and_b32 v11, 3, v9
    v_add_u32 v10, v10, v11
    v_mul_u32_u24 v10, 288, v10
    v_lshl_add_u32 v10, v1, 4, v10
    ds_write_b128 v10, v[36:39]

    s_mov_b32 s23, 1572864
    buffer_load_dwordx4 v[16:19], v6, s[16:19], s23 offen
    s_mov_b32 s23, 1703936
    buffer_load_dwordx4 v[20:23], v6, s[16:19], s23 offen
    s_mov_b32 s23, 1835008
    buffer_load_dwordx4 v[24:27], v6, s[16:19], s23 offen
    s_mov_b32 s23, 1966080
    buffer_load_dwordx4 v[28:31], v6, s[16:19], s23 offen
    s_mov_b32 s23, 2097152
    buffer_load_dwordx4 v[32:35], v6, s[16:19], s23 offen
    s_mov_b32 s23, 2228224
    buffer_load_dwordx4 v[36:39], v6, s[16:19], s23 offen
    s_waitcnt vmcnt(0)
    v_add_u32 v9, 192, v5
    v_and_b32 v10, 0xffffffe0, v9
    v_bfe_u32 v11, v9, 2, 1
    v_lshl_add_u32 v10, v11, 4, v10
    v_bfe_u32 v11, v9, 3, 2
    v_lshl_add_u32 v10, v11, 2, v10
    v_and_b32 v11, 3, v9
    v_add_u32 v10, v10, v11
    v_mul_u32_u24 v10, 288, v10
    v_lshl_add_u32 v10, v1, 4, v10
    ds_write_b128 v10, v[16:19]

    v_add_u32 v9, 208, v5
    v_and_b32 v10, 0xffffffe0, v9
    v_bfe_u32 v11, v9, 2, 1
    v_lshl_add_u32 v10, v11, 4, v10
    v_bfe_u32 v11, v9, 3, 2
    v_lshl_add_u32 v10, v11, 2, v10
    v_and_b32 v11, 3, v9
    v_add_u32 v10, v10, v11
    v_mul_u32_u24 v10, 288, v10
    v_lshl_add_u32 v10, v1, 4, v10
    ds_write_b128 v10, v[20:23]

    v_add_u32 v9, 224, v5
    v_and_b32 v10, 0xffffffe0, v9
    v_bfe_u32 v11, v9, 2, 1
    v_lshl_add_u32 v10, v11, 4, v10
    v_bfe_u32 v11, v9, 3, 2
    v_lshl_add_u32 v10, v11, 2, v10
    v_and_b32 v11, 3, v9
    v_add_u32 v10, v10, v11
    v_mul_u32_u24 v10, 288, v10
    v_lshl_add_u32 v10, v1, 4, v10
    ds_write_b128 v10, v[24:27]

    v_add_u32 v9, 240, v5
    v_and_b32 v10, 0xffffffe0, v9
    v_bfe_u32 v11, v9, 2, 1
    v_lshl_add_u32 v10, v11, 4, v10
    v_bfe_u32 v11, v9, 3, 2
    v_lshl_add_u32 v10, v11, 2, v10
    v_and_b32 v11, 3, v9
    v_add_u32 v10, v10, v11
    v_mul_u32_u24 v10, 288, v10
    v_lshl_add_u32 v10, v1, 4, v10
    ds_write_b128 v10, v[28:31]

    v_add_u32 v9, 256, v5
    v_and_b32 v10, 0xffffffe0, v9
    v_bfe_u32 v11, v9, 2, 1
    v_lshl_add_u32 v10, v11, 4, v10
    v_bfe_u32 v11, v9, 3, 2
    v_lshl_add_u32 v10, v11, 2, v10
    v_and_b32 v11, 3, v9
    v_add_u32 v10, v10, v11
    v_mul_u32_u24 v10, 288, v10
    v_lshl_add_u32 v10, v1, 4, v10
    ds_write_b128 v10, v[32:35]

    v_add_u32 v9, 272, v5
    v_and_b32 v10, 0xffffffe0, v9
    v_bfe_u32 v11, v9, 2, 1
    v_lshl_add_u32 v10, v11, 4, v10
    v_bfe_u32 v11, v9, 3, 2
    v_lshl_add_u32 v10, v11, 2, v10
    v_and_b32 v11, 3, v9
    v_add_u32 v10, v10, v11
    v_mul_u32_u24 v10, 288, v10
    v_lshl_add_u32 v10, v1, 4, v10
    ds_write_b128 v10, v[36:39]

    s_waitcnt lgkmcnt(0)
    s_barrier
    v_add_u32 v8, 46080, v7
    ds_read_b64_tr_b16 a[144:145], v7 offset:0
    ds_read_b64_tr_b16 a[146:147], v7 offset:4608
    ds_read_b64_tr_b16 a[148:149], v7 offset:32
    ds_read_b64_tr_b16 a[150:151], v7 offset:4640
    ds_read_b64_tr_b16 a[152:153], v7 offset:9216
    ds_read_b64_tr_b16 a[154:155], v7 offset:13824
    ds_read_b64_tr_b16 a[156:157], v7 offset:9248
    ds_read_b64_tr_b16 a[158:159], v7 offset:13856
    ds_read_b64_tr_b16 a[160:161], v7 offset:18432
    ds_read_b64_tr_b16 a[162:163], v7 offset:23040
    ds_read_b64_tr_b16 a[164:165], v7 offset:18464
    ds_read_b64_tr_b16 a[166:167], v7 offset:23072
    ds_read_b64_tr_b16 a[168:169], v7 offset:27648
    ds_read_b64_tr_b16 a[170:171], v7 offset:32256
    ds_read_b64_tr_b16 a[172:173], v7 offset:27680
    ds_read_b64_tr_b16 a[174:175], v7 offset:32288
    ds_read_b64_tr_b16 a[176:177], v7 offset:36864
    ds_read_b64_tr_b16 a[178:179], v7 offset:41472
    ds_read_b64_tr_b16 a[180:181], v7 offset:36896
    ds_read_b64_tr_b16 a[182:183], v7 offset:41504
    ds_read_b64_tr_b16 a[184:185], v8 offset:0
    ds_read_b64_tr_b16 a[186:187], v8 offset:4608
    ds_read_b64_tr_b16 a[188:189], v8 offset:32
    ds_read_b64_tr_b16 a[190:191], v8 offset:4640
    ds_read_b64_tr_b16 a[192:193], v8 offset:9216
    ds_read_b64_tr_b16 a[194:195], v8 offset:13824
    ds_read_b64_tr_b16 a[196:197], v8 offset:9248
    ds_read_b64_tr_b16 a[198:199], v8 offset:13856
    ds_read_b64_tr_b16 a[200:201], v8 offset:18432
    ds_read_b64_tr_b16 a[202:203], v8 offset:23040
    ds_read_b64_tr_b16 a[204:205], v8 offset:18464
    ds_read_b64_tr_b16 a[206:207], v8 offset:23072
    ds_read_b64_tr_b16 a[208:209], v8 offset:27648
    ds_read_b64_tr_b16 a[210:211], v8 offset:32256
    ds_read_b64_tr_b16 a[212:213], v8 offset:27680
    ds_read_b64_tr_b16 a[214:215], v8 offset:32288
    s_waitcnt lgkmcnt(0)
    s_barrier
    s_mov_b32 s23, 2359296
    buffer_load_dwordx4 v[16:19], v6, s[16:19], s23 offen
    s_mov_b32 s23, 2490368
    buffer_load_dwordx4 v[20:23], v6, s[16:19], s23 offen
    s_mov_b32 s23, 2621440
    buffer_load_dwordx4 v[24:27], v6, s[16:19], s23 offen
    s_mov_b32 s23, 2752512
    buffer_load_dwordx4 v[28:31], v6, s[16:19], s23 offen
    s_mov_b32 s23, 2883584
    buffer_load_dwordx4 v[32:35], v6, s[16:19], s23 offen
    s_mov_b32 s23, 3014656
    buffer_load_dwordx4 v[36:39], v6, s[16:19], s23 offen
    s_waitcnt vmcnt(0)
    v_add_u32 v9, 0, v5
    v_and_b32 v10, 0xffffffe0, v9
    v_bfe_u32 v11, v9, 2, 1
    v_lshl_add_u32 v10, v11, 4, v10
    v_bfe_u32 v11, v9, 3, 2
    v_lshl_add_u32 v10, v11, 2, v10
    v_and_b32 v11, 3, v9
    v_add_u32 v10, v10, v11
    v_mul_u32_u24 v10, 288, v10
    v_lshl_add_u32 v10, v1, 4, v10
    ds_write_b128 v10, v[16:19]

    v_add_u32 v9, 16, v5
    v_and_b32 v10, 0xffffffe0, v9
    v_bfe_u32 v11, v9, 2, 1
    v_lshl_add_u32 v10, v11, 4, v10
    v_bfe_u32 v11, v9, 3, 2
    v_lshl_add_u32 v10, v11, 2, v10
    v_and_b32 v11, 3, v9
    v_add_u32 v10, v10, v11
    v_mul_u32_u24 v10, 288, v10
    v_lshl_add_u32 v10, v1, 4, v10
    ds_write_b128 v10, v[20:23]

    v_add_u32 v9, 32, v5
    v_and_b32 v10, 0xffffffe0, v9
    v_bfe_u32 v11, v9, 2, 1
    v_lshl_add_u32 v10, v11, 4, v10
    v_bfe_u32 v11, v9, 3, 2
    v_lshl_add_u32 v10, v11, 2, v10
    v_and_b32 v11, 3, v9
    v_add_u32 v10, v10, v11
    v_mul_u32_u24 v10, 288, v10
    v_lshl_add_u32 v10, v1, 4, v10
    ds_write_b128 v10, v[24:27]

    v_add_u32 v9, 48, v5
    v_and_b32 v10, 0xffffffe0, v9
    v_bfe_u32 v11, v9, 2, 1
    v_lshl_add_u32 v10, v11, 4, v10
    v_bfe_u32 v11, v9, 3, 2
    v_lshl_add_u32 v10, v11, 2, v10
    v_and_b32 v11, 3, v9
    v_add_u32 v10, v10, v11
    v_mul_u32_u24 v10, 288, v10
    v_lshl_add_u32 v10, v1, 4, v10
    ds_write_b128 v10, v[28:31]

    v_add_u32 v9, 64, v5
    v_and_b32 v10, 0xffffffe0, v9
    v_bfe_u32 v11, v9, 2, 1
    v_lshl_add_u32 v10, v11, 4, v10
    v_bfe_u32 v11, v9, 3, 2
    v_lshl_add_u32 v10, v11, 2, v10
    v_and_b32 v11, 3, v9
    v_add_u32 v10, v10, v11
    v_mul_u32_u24 v10, 288, v10
    v_lshl_add_u32 v10, v1, 4, v10
    ds_write_b128 v10, v[32:35]

    v_add_u32 v9, 80, v5
    v_and_b32 v10, 0xffffffe0, v9
    v_bfe_u32 v11, v9, 2, 1
    v_lshl_add_u32 v10, v11, 4, v10
    v_bfe_u32 v11, v9, 3, 2
    v_lshl_add_u32 v10, v11, 2, v10
    v_and_b32 v11, 3, v9
    v_add_u32 v10, v10, v11
    v_mul_u32_u24 v10, 288, v10
    v_lshl_add_u32 v10, v1, 4, v10
    ds_write_b128 v10, v[36:39]

    s_mov_b32 s23, 3145728
    buffer_load_dwordx4 v[16:19], v6, s[16:19], s23 offen
    s_mov_b32 s23, 3276800
    buffer_load_dwordx4 v[20:23], v6, s[16:19], s23 offen
    s_mov_b32 s23, 3407872
    buffer_load_dwordx4 v[24:27], v6, s[16:19], s23 offen
    s_mov_b32 s23, 3538944
    buffer_load_dwordx4 v[28:31], v6, s[16:19], s23 offen
    s_mov_b32 s23, 3670016
    buffer_load_dwordx4 v[32:35], v6, s[16:19], s23 offen
    s_mov_b32 s23, 3801088
    buffer_load_dwordx4 v[36:39], v6, s[16:19], s23 offen
    s_waitcnt vmcnt(0)
    v_add_u32 v9, 96, v5
    v_and_b32 v10, 0xffffffe0, v9
    v_bfe_u32 v11, v9, 2, 1
    v_lshl_add_u32 v10, v11, 4, v10
    v_bfe_u32 v11, v9, 3, 2
    v_lshl_add_u32 v10, v11, 2, v10
    v_and_b32 v11, 3, v9
    v_add_u32 v10, v10, v11
    v_mul_u32_u24 v10, 288, v10
    v_lshl_add_u32 v10, v1, 4, v10
    ds_write_b128 v10, v[16:19]

    v_add_u32 v9, 112, v5
    v_and_b32 v10, 0xffffffe0, v9
    v_bfe_u32 v11, v9, 2, 1
    v_lshl_add_u32 v10, v11, 4, v10
    v_bfe_u32 v11, v9, 3, 2
    v_lshl_add_u32 v10, v11, 2, v10
    v_and_b32 v11, 3, v9
    v_add_u32 v10, v10, v11
    v_mul_u32_u24 v10, 288, v10
    v_lshl_add_u32 v10, v1, 4, v10
    ds_write_b128 v10, v[20:23]

    v_add_u32 v9, 128, v5
    v_and_b32 v10, 0xffffffe0, v9
    v_bfe_u32 v11, v9, 2, 1
    v_lshl_add_u32 v10, v11, 4, v10
    v_bfe_u32 v11, v9, 3, 2
    v_lshl_add_u32 v10, v11, 2, v10
    v_and_b32 v11, 3, v9
    v_add_u32 v10, v10, v11
    v_mul_u32_u24 v10, 288, v10
    v_lshl_add_u32 v10, v1, 4, v10
    ds_write_b128 v10, v[24:27]

    v_add_u32 v9, 144, v5
    v_and_b32 v10, 0xffffffe0, v9
    v_bfe_u32 v11, v9, 2, 1
    v_lshl_add_u32 v10, v11, 4, v10
    v_bfe_u32 v11, v9, 3, 2
    v_lshl_add_u32 v10, v11, 2, v10
    v_and_b32 v11, 3, v9
    v_add_u32 v10, v10, v11
    v_mul_u32_u24 v10, 288, v10
    v_lshl_add_u32 v10, v1, 4, v10
    ds_write_b128 v10, v[28:31]

    v_add_u32 v9, 160, v5
    v_and_b32 v10, 0xffffffe0, v9
    v_bfe_u32 v11, v9, 2, 1
    v_lshl_add_u32 v10, v11, 4, v10
    v_bfe_u32 v11, v9, 3, 2
    v_lshl_add_u32 v10, v11, 2, v10
    v_and_b32 v11, 3, v9
    v_add_u32 v10, v10, v11
    v_mul_u32_u24 v10, 288, v10
    v_lshl_add_u32 v10, v1, 4, v10
    ds_write_b128 v10, v[32:35]

    v_add_u32 v9, 176, v5
    v_and_b32 v10, 0xffffffe0, v9
    v_bfe_u32 v11, v9, 2, 1
    v_lshl_add_u32 v10, v11, 4, v10
    v_bfe_u32 v11, v9, 3, 2
    v_lshl_add_u32 v10, v11, 2, v10
    v_and_b32 v11, 3, v9
    v_add_u32 v10, v10, v11
    v_mul_u32_u24 v10, 288, v10
    v_lshl_add_u32 v10, v1, 4, v10
    ds_write_b128 v10, v[36:39]

    s_mov_b32 s23, 3932160
    buffer_load_dwordx4 v[16:19], v6, s[16:19], s23 offen
    s_mov_b32 s23, 4063232
    buffer_load_dwordx4 v[20:23], v6, s[16:19], s23 offen
    s_mov_b32 s23, 4194304
    buffer_load_dwordx4 v[24:27], v6, s[16:19], s23 offen
    s_mov_b32 s23, 4325376
    buffer_load_dwordx4 v[28:31], v6, s[16:19], s23 offen
    s_mov_b32 s23, 4456448
    buffer_load_dwordx4 v[32:35], v6, s[16:19], s23 offen
    s_mov_b32 s23, 4587520
    buffer_load_dwordx4 v[36:39], v6, s[16:19], s23 offen
    s_waitcnt vmcnt(0)
    v_add_u32 v9, 192, v5
    v_and_b32 v10, 0xffffffe0, v9
    v_bfe_u32 v11, v9, 2, 1
    v_lshl_add_u32 v10, v11, 4, v10
    v_bfe_u32 v11, v9, 3, 2
    v_lshl_add_u32 v10, v11, 2, v10
    v_and_b32 v11, 3, v9
    v_add_u32 v10, v10, v11
    v_mul_u32_u24 v10, 288, v10
    v_lshl_add_u32 v10, v1, 4, v10
    ds_write_b128 v10, v[16:19]

    v_add_u32 v9, 208, v5
    v_and_b32 v10, 0xffffffe0, v9
    v_bfe_u32 v11, v9, 2, 1
    v_lshl_add_u32 v10, v11, 4, v10
    v_bfe_u32 v11, v9, 3, 2
    v_lshl_add_u32 v10, v11, 2, v10
    v_and_b32 v11, 3, v9
    v_add_u32 v10, v10, v11
    v_mul_u32_u24 v10, 288, v10
    v_lshl_add_u32 v10, v1, 4, v10
    ds_write_b128 v10, v[20:23]

    v_add_u32 v9, 224, v5
    v_and_b32 v10, 0xffffffe0, v9
    v_bfe_u32 v11, v9, 2, 1
    v_lshl_add_u32 v10, v11, 4, v10
    v_bfe_u32 v11, v9, 3, 2
    v_lshl_add_u32 v10, v11, 2, v10
    v_and_b32 v11, 3, v9
    v_add_u32 v10, v10, v11
    v_mul_u32_u24 v10, 288, v10
    v_lshl_add_u32 v10, v1, 4, v10
    ds_write_b128 v10, v[24:27]

    v_add_u32 v9, 240, v5
    v_and_b32 v10, 0xffffffe0, v9
    v_bfe_u32 v11, v9, 2, 1
    v_lshl_add_u32 v10, v11, 4, v10
    v_bfe_u32 v11, v9, 3, 2
    v_lshl_add_u32 v10, v11, 2, v10
    v_and_b32 v11, 3, v9
    v_add_u32 v10, v10, v11
    v_mul_u32_u24 v10, 288, v10
    v_lshl_add_u32 v10, v1, 4, v10
    ds_write_b128 v10, v[28:31]

    v_add_u32 v9, 256, v5
    v_and_b32 v10, 0xffffffe0, v9
    v_bfe_u32 v11, v9, 2, 1
    v_lshl_add_u32 v10, v11, 4, v10
    v_bfe_u32 v11, v9, 3, 2
    v_lshl_add_u32 v10, v11, 2, v10
    v_and_b32 v11, 3, v9
    v_add_u32 v10, v10, v11
    v_mul_u32_u24 v10, 288, v10
    v_lshl_add_u32 v10, v1, 4, v10
    ds_write_b128 v10, v[32:35]

    v_add_u32 v9, 272, v5
    v_and_b32 v10, 0xffffffe0, v9
    v_bfe_u32 v11, v9, 2, 1
    v_lshl_add_u32 v10, v11, 4, v10
    v_bfe_u32 v11, v9, 3, 2
    v_lshl_add_u32 v10, v11, 2, v10
    v_and_b32 v11, 3, v9
    v_add_u32 v10, v10, v11
    v_mul_u32_u24 v10, 288, v10
    v_lshl_add_u32 v10, v1, 4, v10
    ds_write_b128 v10, v[36:39]

    s_waitcnt lgkmcnt(0)
    s_barrier
    v_add_u32 v8, 46080, v7
    ds_read_b64_tr_b16 a[216:217], v7 offset:0
    ds_read_b64_tr_b16 a[218:219], v7 offset:4608
    ds_read_b64_tr_b16 a[220:221], v7 offset:32
    ds_read_b64_tr_b16 a[222:223], v7 offset:4640
    ds_read_b64_tr_b16 a[224:225], v7 offset:9216
    ds_read_b64_tr_b16 a[226:227], v7 offset:13824
    ds_read_b64_tr_b16 a[228:229], v7 offset:9248
    ds_read_b64_tr_b16 a[230:231], v7 offset:13856
    ds_read_b64_tr_b16 a[232:233], v7 offset:18432
    ds_read_b64_tr_b16 a[234:235], v7 offset:23040
    ds_read_b64_tr_b16 a[236:237], v7 offset:18464
    ds_read_b64_tr_b16 a[238:239], v7 offset:23072
    ds_read_b64_tr_b16 a[240:241], v7 offset:27648
    ds_read_b64_tr_b16 a[242:243], v7 offset:32256
    ds_read_b64_tr_b16 a[244:245], v7 offset:27680
    ds_read_b64_tr_b16 a[246:247], v7 offset:32288
    ds_read_b64_tr_b16 a[248:249], v7 offset:36864
    ds_read_b64_tr_b16 a[250:251], v7 offset:41472
    ds_read_b64_tr_b16 a[252:253], v7 offset:36896
    ds_read_b64_tr_b16 a[254:255], v7 offset:41504
    ds_read_b64_tr_b16 v[80:81], v8 offset:0
    ds_read_b64_tr_b16 v[82:83], v8 offset:4608
    ds_read_b64_tr_b16 v[84:85], v8 offset:32
    ds_read_b64_tr_b16 v[86:87], v8 offset:4640
    ds_read_b64_tr_b16 v[88:89], v8 offset:9216
    ds_read_b64_tr_b16 v[90:91], v8 offset:13824
    ds_read_b64_tr_b16 v[92:93], v8 offset:9248
    ds_read_b64_tr_b16 v[94:95], v8 offset:13856
    ds_read_b64_tr_b16 v[96:97], v8 offset:18432
    ds_read_b64_tr_b16 v[98:99], v8 offset:23040
    ds_read_b64_tr_b16 v[100:101], v8 offset:18464
    ds_read_b64_tr_b16 v[102:103], v8 offset:23072
    ds_read_b64_tr_b16 v[104:105], v8 offset:27648
    ds_read_b64_tr_b16 v[106:107], v8 offset:32256
    ds_read_b64_tr_b16 v[108:109], v8 offset:27680
    ds_read_b64_tr_b16 v[110:111], v8 offset:32288
    s_waitcnt lgkmcnt(0)
    s_barrier
    s_mov_b32 s16, s40
    s_mov_b32 s17, s41
    s_mov_b32 s18, 4718592
    s_mov_b32 s19, 0x00020000
    s_mov_b32 s23, 0
    buffer_load_dwordx4 v[16:19], v6, s[16:19], s23 offen
    s_mov_b32 s23, 131072
    buffer_load_dwordx4 v[20:23], v6, s[16:19], s23 offen
    s_mov_b32 s23, 262144
    buffer_load_dwordx4 v[24:27], v6, s[16:19], s23 offen
    s_mov_b32 s23, 393216
    buffer_load_dwordx4 v[28:31], v6, s[16:19], s23 offen
    s_mov_b32 s23, 524288
    buffer_load_dwordx4 v[32:35], v6, s[16:19], s23 offen
    s_mov_b32 s23, 655360
    buffer_load_dwordx4 v[36:39], v6, s[16:19], s23 offen
    s_waitcnt vmcnt(0)
    v_add_u32 v9, 0, v5
    v_and_b32 v10, 0xffffffe0, v9
    v_bfe_u32 v11, v9, 2, 1
    v_lshl_add_u32 v10, v11, 4, v10
    v_bfe_u32 v11, v9, 3, 2
    v_lshl_add_u32 v10, v11, 2, v10
    v_and_b32 v11, 3, v9
    v_add_u32 v10, v10, v11
    v_mul_u32_u24 v10, 288, v10
    v_lshl_add_u32 v10, v1, 4, v10
    ds_write_b128 v10, v[16:19]

    v_add_u32 v9, 16, v5
    v_and_b32 v10, 0xffffffe0, v9
    v_bfe_u32 v11, v9, 2, 1
    v_lshl_add_u32 v10, v11, 4, v10
    v_bfe_u32 v11, v9, 3, 2
    v_lshl_add_u32 v10, v11, 2, v10
    v_and_b32 v11, 3, v9
    v_add_u32 v10, v10, v11
    v_mul_u32_u24 v10, 288, v10
    v_lshl_add_u32 v10, v1, 4, v10
    ds_write_b128 v10, v[20:23]

    v_add_u32 v9, 32, v5
    v_and_b32 v10, 0xffffffe0, v9
    v_bfe_u32 v11, v9, 2, 1
    v_lshl_add_u32 v10, v11, 4, v10
    v_bfe_u32 v11, v9, 3, 2
    v_lshl_add_u32 v10, v11, 2, v10
    v_and_b32 v11, 3, v9
    v_add_u32 v10, v10, v11
    v_mul_u32_u24 v10, 288, v10
    v_lshl_add_u32 v10, v1, 4, v10
    ds_write_b128 v10, v[24:27]

    v_add_u32 v9, 48, v5
    v_and_b32 v10, 0xffffffe0, v9
    v_bfe_u32 v11, v9, 2, 1
    v_lshl_add_u32 v10, v11, 4, v10
    v_bfe_u32 v11, v9, 3, 2
    v_lshl_add_u32 v10, v11, 2, v10
    v_and_b32 v11, 3, v9
    v_add_u32 v10, v10, v11
    v_mul_u32_u24 v10, 288, v10
    v_lshl_add_u32 v10, v1, 4, v10
    ds_write_b128 v10, v[28:31]

    v_add_u32 v9, 64, v5
    v_and_b32 v10, 0xffffffe0, v9
    v_bfe_u32 v11, v9, 2, 1
    v_lshl_add_u32 v10, v11, 4, v10
    v_bfe_u32 v11, v9, 3, 2
    v_lshl_add_u32 v10, v11, 2, v10
    v_and_b32 v11, 3, v9
    v_add_u32 v10, v10, v11
    v_mul_u32_u24 v10, 288, v10
    v_lshl_add_u32 v10, v1, 4, v10
    ds_write_b128 v10, v[32:35]

    v_add_u32 v9, 80, v5
    v_and_b32 v10, 0xffffffe0, v9
    v_bfe_u32 v11, v9, 2, 1
    v_lshl_add_u32 v10, v11, 4, v10
    v_bfe_u32 v11, v9, 3, 2
    v_lshl_add_u32 v10, v11, 2, v10
    v_and_b32 v11, 3, v9
    v_add_u32 v10, v10, v11
    v_mul_u32_u24 v10, 288, v10
    v_lshl_add_u32 v10, v1, 4, v10
    ds_write_b128 v10, v[36:39]

    s_mov_b32 s23, 786432
    buffer_load_dwordx4 v[16:19], v6, s[16:19], s23 offen
    s_mov_b32 s23, 917504
    buffer_load_dwordx4 v[20:23], v6, s[16:19], s23 offen
    s_mov_b32 s23, 1048576
    buffer_load_dwordx4 v[24:27], v6, s[16:19], s23 offen
    s_mov_b32 s23, 1179648
    buffer_load_dwordx4 v[28:31], v6, s[16:19], s23 offen
    s_mov_b32 s23, 1310720
    buffer_load_dwordx4 v[32:35], v6, s[16:19], s23 offen
    s_mov_b32 s23, 1441792
    buffer_load_dwordx4 v[36:39], v6, s[16:19], s23 offen
    s_waitcnt vmcnt(0)
    v_add_u32 v9, 96, v5
    v_and_b32 v10, 0xffffffe0, v9
    v_bfe_u32 v11, v9, 2, 1
    v_lshl_add_u32 v10, v11, 4, v10
    v_bfe_u32 v11, v9, 3, 2
    v_lshl_add_u32 v10, v11, 2, v10
    v_and_b32 v11, 3, v9
    v_add_u32 v10, v10, v11
    v_mul_u32_u24 v10, 288, v10
    v_lshl_add_u32 v10, v1, 4, v10
    ds_write_b128 v10, v[16:19]

    v_add_u32 v9, 112, v5
    v_and_b32 v10, 0xffffffe0, v9
    v_bfe_u32 v11, v9, 2, 1
    v_lshl_add_u32 v10, v11, 4, v10
    v_bfe_u32 v11, v9, 3, 2
    v_lshl_add_u32 v10, v11, 2, v10
    v_and_b32 v11, 3, v9
    v_add_u32 v10, v10, v11
    v_mul_u32_u24 v10, 288, v10
    v_lshl_add_u32 v10, v1, 4, v10
    ds_write_b128 v10, v[20:23]

    v_add_u32 v9, 128, v5
    v_and_b32 v10, 0xffffffe0, v9
    v_bfe_u32 v11, v9, 2, 1
    v_lshl_add_u32 v10, v11, 4, v10
    v_bfe_u32 v11, v9, 3, 2
    v_lshl_add_u32 v10, v11, 2, v10
    v_and_b32 v11, 3, v9
    v_add_u32 v10, v10, v11
    v_mul_u32_u24 v10, 288, v10
    v_lshl_add_u32 v10, v1, 4, v10
    ds_write_b128 v10, v[24:27]

    v_add_u32 v9, 144, v5
    v_and_b32 v10, 0xffffffe0, v9
    v_bfe_u32 v11, v9, 2, 1
    v_lshl_add_u32 v10, v11, 4, v10
    v_bfe_u32 v11, v9, 3, 2
    v_lshl_add_u32 v10, v11, 2, v10
    v_and_b32 v11, 3, v9
    v_add_u32 v10, v10, v11
    v_mul_u32_u24 v10, 288, v10
    v_lshl_add_u32 v10, v1, 4, v10
    ds_write_b128 v10, v[28:31]

    v_add_u32 v9, 160, v5
    v_and_b32 v10, 0xffffffe0, v9
    v_bfe_u32 v11, v9, 2, 1
    v_lshl_add_u32 v10, v11, 4, v10
    v_bfe_u32 v11, v9, 3, 2
    v_lshl_add_u32 v10, v11, 2, v10
    v_and_b32 v11, 3, v9
    v_add_u32 v10, v10, v11
    v_mul_u32_u24 v10, 288, v10
    v_lshl_add_u32 v10, v1, 4, v10
    ds_write_b128 v10, v[32:35]

    v_add_u32 v9, 176, v5
    v_and_b32 v10, 0xffffffe0, v9
    v_bfe_u32 v11, v9, 2, 1
    v_lshl_add_u32 v10, v11, 4, v10
    v_bfe_u32 v11, v9, 3, 2
    v_lshl_add_u32 v10, v11, 2, v10
    v_and_b32 v11, 3, v9
    v_add_u32 v10, v10, v11
    v_mul_u32_u24 v10, 288, v10
    v_lshl_add_u32 v10, v1, 4, v10
    ds_write_b128 v10, v[36:39]

    s_mov_b32 s23, 1572864
    buffer_load_dwordx4 v[16:19], v6, s[16:19], s23 offen
    s_mov_b32 s23, 1703936
    buffer_load_dwordx4 v[20:23], v6, s[16:19], s23 offen
    s_mov_b32 s23, 1835008
    buffer_load_dwordx4 v[24:27], v6, s[16:19], s23 offen
    s_mov_b32 s23, 1966080
    buffer_load_dwordx4 v[28:31], v6, s[16:19], s23 offen
    s_mov_b32 s23, 2097152
    buffer_load_dwordx4 v[32:35], v6, s[16:19], s23 offen
    s_mov_b32 s23, 2228224
    buffer_load_dwordx4 v[36:39], v6, s[16:19], s23 offen
    s_waitcnt vmcnt(0)
    v_add_u32 v9, 192, v5
    v_and_b32 v10, 0xffffffe0, v9
    v_bfe_u32 v11, v9, 2, 1
    v_lshl_add_u32 v10, v11, 4, v10
    v_bfe_u32 v11, v9, 3, 2
    v_lshl_add_u32 v10, v11, 2, v10
    v_and_b32 v11, 3, v9
    v_add_u32 v10, v10, v11
    v_mul_u32_u24 v10, 288, v10
    v_lshl_add_u32 v10, v1, 4, v10
    ds_write_b128 v10, v[16:19]

    v_add_u32 v9, 208, v5
    v_and_b32 v10, 0xffffffe0, v9
    v_bfe_u32 v11, v9, 2, 1
    v_lshl_add_u32 v10, v11, 4, v10
    v_bfe_u32 v11, v9, 3, 2
    v_lshl_add_u32 v10, v11, 2, v10
    v_and_b32 v11, 3, v9
    v_add_u32 v10, v10, v11
    v_mul_u32_u24 v10, 288, v10
    v_lshl_add_u32 v10, v1, 4, v10
    ds_write_b128 v10, v[20:23]

    v_add_u32 v9, 224, v5
    v_and_b32 v10, 0xffffffe0, v9
    v_bfe_u32 v11, v9, 2, 1
    v_lshl_add_u32 v10, v11, 4, v10
    v_bfe_u32 v11, v9, 3, 2
    v_lshl_add_u32 v10, v11, 2, v10
    v_and_b32 v11, 3, v9
    v_add_u32 v10, v10, v11
    v_mul_u32_u24 v10, 288, v10
    v_lshl_add_u32 v10, v1, 4, v10
    ds_write_b128 v10, v[24:27]

    v_add_u32 v9, 240, v5
    v_and_b32 v10, 0xffffffe0, v9
    v_bfe_u32 v11, v9, 2, 1
    v_lshl_add_u32 v10, v11, 4, v10
    v_bfe_u32 v11, v9, 3, 2
    v_lshl_add_u32 v10, v11, 2, v10
    v_and_b32 v11, 3, v9
    v_add_u32 v10, v10, v11
    v_mul_u32_u24 v10, 288, v10
    v_lshl_add_u32 v10, v1, 4, v10
    ds_write_b128 v10, v[28:31]

    v_add_u32 v9, 256, v5
    v_and_b32 v10, 0xffffffe0, v9
    v_bfe_u32 v11, v9, 2, 1
    v_lshl_add_u32 v10, v11, 4, v10
    v_bfe_u32 v11, v9, 3, 2
    v_lshl_add_u32 v10, v11, 2, v10
    v_and_b32 v11, 3, v9
    v_add_u32 v10, v10, v11
    v_mul_u32_u24 v10, 288, v10
    v_lshl_add_u32 v10, v1, 4, v10
    ds_write_b128 v10, v[32:35]

    v_add_u32 v9, 272, v5
    v_and_b32 v10, 0xffffffe0, v9
    v_bfe_u32 v11, v9, 2, 1
    v_lshl_add_u32 v10, v11, 4, v10
    v_bfe_u32 v11, v9, 3, 2
    v_lshl_add_u32 v10, v11, 2, v10
    v_and_b32 v11, 3, v9
    v_add_u32 v10, v10, v11
    v_mul_u32_u24 v10, 288, v10
    v_lshl_add_u32 v10, v1, 4, v10
    ds_write_b128 v10, v[36:39]

    s_waitcnt lgkmcnt(0)
    s_barrier
    v_add_u32 v8, 46080, v7
    ds_read_b64_tr_b16 v[112:113], v7 offset:0
    ds_read_b64_tr_b16 v[114:115], v7 offset:4608
    ds_read_b64_tr_b16 v[116:117], v7 offset:32
    ds_read_b64_tr_b16 v[118:119], v7 offset:4640
    ds_read_b64_tr_b16 v[120:121], v7 offset:9216
    ds_read_b64_tr_b16 v[122:123], v7 offset:13824
    ds_read_b64_tr_b16 v[124:125], v7 offset:9248
    ds_read_b64_tr_b16 v[126:127], v7 offset:13856
    ds_read_b64_tr_b16 v[128:129], v7 offset:18432
    ds_read_b64_tr_b16 v[130:131], v7 offset:23040
    ds_read_b64_tr_b16 v[132:133], v7 offset:18464
    ds_read_b64_tr_b16 v[134:135], v7 offset:23072
    ds_read_b64_tr_b16 v[136:137], v7 offset:27648
    ds_read_b64_tr_b16 v[138:139], v7 offset:32256
    ds_read_b64_tr_b16 v[140:141], v7 offset:27680
    ds_read_b64_tr_b16 v[142:143], v7 offset:32288
    ds_read_b64_tr_b16 v[144:145], v7 offset:36864
    ds_read_b64_tr_b16 v[146:147], v7 offset:41472
    ds_read_b64_tr_b16 v[148:149], v7 offset:36896
    ds_read_b64_tr_b16 v[150:151], v7 offset:41504
    ds_read_b64_tr_b16 v[152:153], v8 offset:0
    ds_read_b64_tr_b16 v[154:155], v8 offset:4608
    ds_read_b64_tr_b16 v[156:157], v8 offset:32
    ds_read_b64_tr_b16 v[158:159], v8 offset:4640
    ds_read_b64_tr_b16 v[160:161], v8 offset:9216
    ds_read_b64_tr_b16 v[162:163], v8 offset:13824
    ds_read_b64_tr_b16 v[164:165], v8 offset:9248
    ds_read_b64_tr_b16 v[166:167], v8 offset:13856
    ds_read_b64_tr_b16 v[168:169], v8 offset:18432
    ds_read_b64_tr_b16 v[170:171], v8 offset:23040
    ds_read_b64_tr_b16 v[172:173], v8 offset:18464
    ds_read_b64_tr_b16 v[174:175], v8 offset:23072
    ds_read_b64_tr_b16 v[176:177], v8 offset:27648
    ds_read_b64_tr_b16 v[178:179], v8 offset:32256
    ds_read_b64_tr_b16 v[180:181], v8 offset:27680
    ds_read_b64_tr_b16 v[182:183], v8 offset:32288
    s_waitcnt lgkmcnt(0)
    s_barrier
    s_mov_b32 s23, 2359296
    buffer_load_dwordx4 v[16:19], v6, s[16:19], s23 offen
    s_mov_b32 s23, 2490368
    buffer_load_dwordx4 v[20:23], v6, s[16:19], s23 offen
    s_mov_b32 s23, 2621440
    buffer_load_dwordx4 v[24:27], v6, s[16:19], s23 offen
    s_mov_b32 s23, 2752512
    buffer_load_dwordx4 v[28:31], v6, s[16:19], s23 offen
    s_mov_b32 s23, 2883584
    buffer_load_dwordx4 v[32:35], v6, s[16:19], s23 offen
    s_mov_b32 s23, 3014656
    buffer_load_dwordx4 v[36:39], v6, s[16:19], s23 offen
    s_waitcnt vmcnt(0)
    v_add_u32 v9, 0, v5
    v_and_b32 v10, 0xffffffe0, v9
    v_bfe_u32 v11, v9, 2, 1
    v_lshl_add_u32 v10, v11, 4, v10
    v_bfe_u32 v11, v9, 3, 2
    v_lshl_add_u32 v10, v11, 2, v10
    v_and_b32 v11, 3, v9
    v_add_u32 v10, v10, v11
    v_mul_u32_u24 v10, 288, v10
    v_lshl_add_u32 v10, v1, 4, v10
    ds_write_b128 v10, v[16:19]

    v_add_u32 v9, 16, v5
    v_and_b32 v10, 0xffffffe0, v9
    v_bfe_u32 v11, v9, 2, 1
    v_lshl_add_u32 v10, v11, 4, v10
    v_bfe_u32 v11, v9, 3, 2
    v_lshl_add_u32 v10, v11, 2, v10
    v_and_b32 v11, 3, v9
    v_add_u32 v10, v10, v11
    v_mul_u32_u24 v10, 288, v10
    v_lshl_add_u32 v10, v1, 4, v10
    ds_write_b128 v10, v[20:23]

    v_add_u32 v9, 32, v5
    v_and_b32 v10, 0xffffffe0, v9
    v_bfe_u32 v11, v9, 2, 1
    v_lshl_add_u32 v10, v11, 4, v10
    v_bfe_u32 v11, v9, 3, 2
    v_lshl_add_u32 v10, v11, 2, v10
    v_and_b32 v11, 3, v9
    v_add_u32 v10, v10, v11
    v_mul_u32_u24 v10, 288, v10
    v_lshl_add_u32 v10, v1, 4, v10
    ds_write_b128 v10, v[24:27]

    v_add_u32 v9, 48, v5
    v_and_b32 v10, 0xffffffe0, v9
    v_bfe_u32 v11, v9, 2, 1
    v_lshl_add_u32 v10, v11, 4, v10
    v_bfe_u32 v11, v9, 3, 2
    v_lshl_add_u32 v10, v11, 2, v10
    v_and_b32 v11, 3, v9
    v_add_u32 v10, v10, v11
    v_mul_u32_u24 v10, 288, v10
    v_lshl_add_u32 v10, v1, 4, v10
    ds_write_b128 v10, v[28:31]

    v_add_u32 v9, 64, v5
    v_and_b32 v10, 0xffffffe0, v9
    v_bfe_u32 v11, v9, 2, 1
    v_lshl_add_u32 v10, v11, 4, v10
    v_bfe_u32 v11, v9, 3, 2
    v_lshl_add_u32 v10, v11, 2, v10
    v_and_b32 v11, 3, v9
    v_add_u32 v10, v10, v11
    v_mul_u32_u24 v10, 288, v10
    v_lshl_add_u32 v10, v1, 4, v10
    ds_write_b128 v10, v[32:35]

    v_add_u32 v9, 80, v5
    v_and_b32 v10, 0xffffffe0, v9
    v_bfe_u32 v11, v9, 2, 1
    v_lshl_add_u32 v10, v11, 4, v10
    v_bfe_u32 v11, v9, 3, 2
    v_lshl_add_u32 v10, v11, 2, v10
    v_and_b32 v11, 3, v9
    v_add_u32 v10, v10, v11
    v_mul_u32_u24 v10, 288, v10
    v_lshl_add_u32 v10, v1, 4, v10
    ds_write_b128 v10, v[36:39]

    s_mov_b32 s23, 3145728
    buffer_load_dwordx4 v[16:19], v6, s[16:19], s23 offen
    s_mov_b32 s23, 3276800
    buffer_load_dwordx4 v[20:23], v6, s[16:19], s23 offen
    s_mov_b32 s23, 3407872
    buffer_load_dwordx4 v[24:27], v6, s[16:19], s23 offen
    s_mov_b32 s23, 3538944
    buffer_load_dwordx4 v[28:31], v6, s[16:19], s23 offen
    s_mov_b32 s23, 3670016
    buffer_load_dwordx4 v[32:35], v6, s[16:19], s23 offen
    s_mov_b32 s23, 3801088
    buffer_load_dwordx4 v[36:39], v6, s[16:19], s23 offen
    s_waitcnt vmcnt(0)
    v_add_u32 v9, 96, v5
    v_and_b32 v10, 0xffffffe0, v9
    v_bfe_u32 v11, v9, 2, 1
    v_lshl_add_u32 v10, v11, 4, v10
    v_bfe_u32 v11, v9, 3, 2
    v_lshl_add_u32 v10, v11, 2, v10
    v_and_b32 v11, 3, v9
    v_add_u32 v10, v10, v11
    v_mul_u32_u24 v10, 288, v10
    v_lshl_add_u32 v10, v1, 4, v10
    ds_write_b128 v10, v[16:19]

    v_add_u32 v9, 112, v5
    v_and_b32 v10, 0xffffffe0, v9
    v_bfe_u32 v11, v9, 2, 1
    v_lshl_add_u32 v10, v11, 4, v10
    v_bfe_u32 v11, v9, 3, 2
    v_lshl_add_u32 v10, v11, 2, v10
    v_and_b32 v11, 3, v9
    v_add_u32 v10, v10, v11
    v_mul_u32_u24 v10, 288, v10
    v_lshl_add_u32 v10, v1, 4, v10
    ds_write_b128 v10, v[20:23]

    v_add_u32 v9, 128, v5
    v_and_b32 v10, 0xffffffe0, v9
    v_bfe_u32 v11, v9, 2, 1
    v_lshl_add_u32 v10, v11, 4, v10
    v_bfe_u32 v11, v9, 3, 2
    v_lshl_add_u32 v10, v11, 2, v10
    v_and_b32 v11, 3, v9
    v_add_u32 v10, v10, v11
    v_mul_u32_u24 v10, 288, v10
    v_lshl_add_u32 v10, v1, 4, v10
    ds_write_b128 v10, v[24:27]

    v_add_u32 v9, 144, v5
    v_and_b32 v10, 0xffffffe0, v9
    v_bfe_u32 v11, v9, 2, 1
    v_lshl_add_u32 v10, v11, 4, v10
    v_bfe_u32 v11, v9, 3, 2
    v_lshl_add_u32 v10, v11, 2, v10
    v_and_b32 v11, 3, v9
    v_add_u32 v10, v10, v11
    v_mul_u32_u24 v10, 288, v10
    v_lshl_add_u32 v10, v1, 4, v10
    ds_write_b128 v10, v[28:31]

    v_add_u32 v9, 160, v5
    v_and_b32 v10, 0xffffffe0, v9
    v_bfe_u32 v11, v9, 2, 1
    v_lshl_add_u32 v10, v11, 4, v10
    v_bfe_u32 v11, v9, 3, 2
    v_lshl_add_u32 v10, v11, 2, v10
    v_and_b32 v11, 3, v9
    v_add_u32 v10, v10, v11
    v_mul_u32_u24 v10, 288, v10
    v_lshl_add_u32 v10, v1, 4, v10
    ds_write_b128 v10, v[32:35]

    v_add_u32 v9, 176, v5
    v_and_b32 v10, 0xffffffe0, v9
    v_bfe_u32 v11, v9, 2, 1
    v_lshl_add_u32 v10, v11, 4, v10
    v_bfe_u32 v11, v9, 3, 2
    v_lshl_add_u32 v10, v11, 2, v10
    v_and_b32 v11, 3, v9
    v_add_u32 v10, v10, v11
    v_mul_u32_u24 v10, 288, v10
    v_lshl_add_u32 v10, v1, 4, v10
    ds_write_b128 v10, v[36:39]

    s_mov_b32 s23, 3932160
    buffer_load_dwordx4 v[16:19], v6, s[16:19], s23 offen
    s_mov_b32 s23, 4063232
    buffer_load_dwordx4 v[20:23], v6, s[16:19], s23 offen
    s_mov_b32 s23, 4194304
    buffer_load_dwordx4 v[24:27], v6, s[16:19], s23 offen
    s_mov_b32 s23, 4325376
    buffer_load_dwordx4 v[28:31], v6, s[16:19], s23 offen
    s_mov_b32 s23, 4456448
    buffer_load_dwordx4 v[32:35], v6, s[16:19], s23 offen
    s_mov_b32 s23, 4587520
    buffer_load_dwordx4 v[36:39], v6, s[16:19], s23 offen
    s_waitcnt vmcnt(0)
    v_add_u32 v9, 192, v5
    v_and_b32 v10, 0xffffffe0, v9
    v_bfe_u32 v11, v9, 2, 1
    v_lshl_add_u32 v10, v11, 4, v10
    v_bfe_u32 v11, v9, 3, 2
    v_lshl_add_u32 v10, v11, 2, v10
    v_and_b32 v11, 3, v9
    v_add_u32 v10, v10, v11
    v_mul_u32_u24 v10, 288, v10
    v_lshl_add_u32 v10, v1, 4, v10
    ds_write_b128 v10, v[16:19]

    v_add_u32 v9, 208, v5
    v_and_b32 v10, 0xffffffe0, v9
    v_bfe_u32 v11, v9, 2, 1
    v_lshl_add_u32 v10, v11, 4, v10
    v_bfe_u32 v11, v9, 3, 2
    v_lshl_add_u32 v10, v11, 2, v10
    v_and_b32 v11, 3, v9
    v_add_u32 v10, v10, v11
    v_mul_u32_u24 v10, 288, v10
    v_lshl_add_u32 v10, v1, 4, v10
    ds_write_b128 v10, v[20:23]

    v_add_u32 v9, 224, v5
    v_and_b32 v10, 0xffffffe0, v9
    v_bfe_u32 v11, v9, 2, 1
    v_lshl_add_u32 v10, v11, 4, v10
    v_bfe_u32 v11, v9, 3, 2
    v_lshl_add_u32 v10, v11, 2, v10
    v_and_b32 v11, 3, v9
    v_add_u32 v10, v10, v11
    v_mul_u32_u24 v10, 288, v10
    v_lshl_add_u32 v10, v1, 4, v10
    ds_write_b128 v10, v[24:27]

    v_add_u32 v9, 240, v5
    v_and_b32 v10, 0xffffffe0, v9
    v_bfe_u32 v11, v9, 2, 1
    v_lshl_add_u32 v10, v11, 4, v10
    v_bfe_u32 v11, v9, 3, 2
    v_lshl_add_u32 v10, v11, 2, v10
    v_and_b32 v11, 3, v9
    v_add_u32 v10, v10, v11
    v_mul_u32_u24 v10, 288, v10
    v_lshl_add_u32 v10, v1, 4, v10
    ds_write_b128 v10, v[28:31]

    v_add_u32 v9, 256, v5
    v_and_b32 v10, 0xffffffe0, v9
    v_bfe_u32 v11, v9, 2, 1
    v_lshl_add_u32 v10, v11, 4, v10
    v_bfe_u32 v11, v9, 3, 2
    v_lshl_add_u32 v10, v11, 2, v10
    v_and_b32 v11, 3, v9
    v_add_u32 v10, v10, v11
    v_mul_u32_u24 v10, 288, v10
    v_lshl_add_u32 v10, v1, 4, v10
    ds_write_b128 v10, v[32:35]

    v_add_u32 v9, 272, v5
    v_and_b32 v10, 0xffffffe0, v9
    v_bfe_u32 v11, v9, 2, 1
    v_lshl_add_u32 v10, v11, 4, v10
    v_bfe_u32 v11, v9, 3, 2
    v_lshl_add_u32 v10, v11, 2, v10
    v_and_b32 v11, 3, v9
    v_add_u32 v10, v10, v11
    v_mul_u32_u24 v10, 288, v10
    v_lshl_add_u32 v10, v1, 4, v10
    ds_write_b128 v10, v[36:39]

    s_waitcnt lgkmcnt(0)
    s_barrier
    v_add_u32 v8, 46080, v7
    ds_read_b64_tr_b16 v[184:185], v7 offset:0
    ds_read_b64_tr_b16 v[186:187], v7 offset:4608
    ds_read_b64_tr_b16 v[188:189], v7 offset:32
    ds_read_b64_tr_b16 v[190:191], v7 offset:4640
    ds_read_b64_tr_b16 v[192:193], v7 offset:9216
    ds_read_b64_tr_b16 v[194:195], v7 offset:13824
    ds_read_b64_tr_b16 v[196:197], v7 offset:9248
    ds_read_b64_tr_b16 v[198:199], v7 offset:13856
    ds_read_b64_tr_b16 v[200:201], v7 offset:18432
    ds_read_b64_tr_b16 v[202:203], v7 offset:23040
    ds_read_b64_tr_b16 v[204:205], v7 offset:18464
    ds_read_b64_tr_b16 v[206:207], v7 offset:23072
    ds_read_b64_tr_b16 v[208:209], v7 offset:27648
    ds_read_b64_tr_b16 v[210:211], v7 offset:32256
    ds_read_b64_tr_b16 v[212:213], v7 offset:27680
    ds_read_b64_tr_b16 v[214:215], v7 offset:32288
    ds_read_b64_tr_b16 v[216:217], v7 offset:36864
    ds_read_b64_tr_b16 v[218:219], v7 offset:41472
    ds_read_b64_tr_b16 v[220:221], v7 offset:36896
    ds_read_b64_tr_b16 v[222:223], v7 offset:41504
    ds_read_b64_tr_b16 v[224:225], v8 offset:0
    ds_read_b64_tr_b16 v[226:227], v8 offset:4608
    ds_read_b64_tr_b16 v[228:229], v8 offset:32
    ds_read_b64_tr_b16 v[230:231], v8 offset:4640
    ds_read_b64_tr_b16 v[232:233], v8 offset:9216
    ds_read_b64_tr_b16 v[234:235], v8 offset:13824
    ds_read_b64_tr_b16 v[236:237], v8 offset:9248
    ds_read_b64_tr_b16 v[238:239], v8 offset:13856
    ds_read_b64_tr_b16 v[240:241], v8 offset:18432
    ds_read_b64_tr_b16 v[242:243], v8 offset:23040
    ds_read_b64_tr_b16 v[244:245], v8 offset:18464
    ds_read_b64_tr_b16 v[246:247], v8 offset:23072
    ds_read_b64_tr_b16 v[248:249], v8 offset:27648
    ds_read_b64_tr_b16 v[250:251], v8 offset:32256
    ds_read_b64_tr_b16 v[252:253], v8 offset:27680
    ds_read_b64_tr_b16 v[254:255], v8 offset:32288
    s_waitcnt lgkmcnt(0)
    s_barrier
    s_mov_b32 s16, s42
    s_mov_b32 s17, s43
    s_mov_b32 s18, 4718592
    s_mov_b32 s19, 0x00020000
    v_lshrrev_b32 v5, 3, v0
    v_and_b32 v6, 7, v0
    s_mul_i32 s22, s2, 147456
    v_mul_u32_u24 v8, 1152, v5
    v_lshl_add_u32 v8, v6, 4, v8
    v_add_u32 v8, s22, v8
    v_mul_u32_u24 v9, 416, v5
    v_lshl_add_u32 v9, v6, 4, v9
    v_add_u32 v9, 147456, v9
    v_bfe_u32 v7, v0, 2, 2
    v_lshl_add_u32 v7, v2, 2, v7
    v_mul_u32_u24 v7, 416, v7
    v_and_b32 v10, 3, v0
    v_lshlrev_b32 v10, 3, v10
    v_add_u32 v7, v7, v10
    v_mul_u32_u24 v10, 96, v3
    v_add_u32 v7, v7, v10
    v_add_u32 v7, 147456, v7
    v_lshlrev_b32 v10, 4, v4
    v_mul_u32_u24 v11, 12288, v3
    v_add_u32 v10, v10, v11

    s_mov_b32 s23, 0
    buffer_load_dwordx4 v[16:19], v8, s[16:19], s23 offen offset:0
    buffer_load_dwordx4 v[20:23], v8, s[16:19], s23 offen offset:128
    buffer_load_dwordx4 v[24:27], v8, s[16:19], s23 offen offset:256
    s_waitcnt vmcnt(0)
    ds_write_b128 v9, v[16:19] offset:0
    ds_write_b128 v9, v[20:23] offset:128
    ds_write_b128 v9, v[24:27] offset:256
    s_waitcnt lgkmcnt(0)
    s_barrier
    ds_read_b64_tr_b16 v[16:17], v7 offset:0
    ds_read_b64_tr_b16 v[18:19], v7 offset:6656
    ds_read_b64_tr_b16 v[20:21], v7 offset:32
    ds_read_b64_tr_b16 v[22:23], v7 offset:6688
    ds_read_b64_tr_b16 v[24:25], v7 offset:64
    ds_read_b64_tr_b16 v[26:27], v7 offset:6720
    s_waitcnt lgkmcnt(0)
    v_add_u32 v11, 0, v10
    ds_write_b128 v11, v[16:19] offset:0
    v_add_u32 v11, 0, v10
    ds_write_b128 v11, v[20:23] offset:4096
    v_add_u32 v11, 0, v10
    ds_write_b128 v11, v[24:27] offset:8192
    s_waitcnt lgkmcnt(0)
    s_barrier
    s_mov_b32 s23, 384
    buffer_load_dwordx4 v[16:19], v8, s[16:19], s23 offen offset:0
    buffer_load_dwordx4 v[20:23], v8, s[16:19], s23 offen offset:128
    buffer_load_dwordx4 v[24:27], v8, s[16:19], s23 offen offset:256
    s_waitcnt vmcnt(0)
    ds_write_b128 v9, v[16:19] offset:0
    ds_write_b128 v9, v[20:23] offset:128
    ds_write_b128 v9, v[24:27] offset:256
    s_waitcnt lgkmcnt(0)
    s_barrier
    ds_read_b64_tr_b16 v[16:17], v7 offset:0
    ds_read_b64_tr_b16 v[18:19], v7 offset:6656
    ds_read_b64_tr_b16 v[20:21], v7 offset:32
    ds_read_b64_tr_b16 v[22:23], v7 offset:6688
    ds_read_b64_tr_b16 v[24:25], v7 offset:64
    ds_read_b64_tr_b16 v[26:27], v7 offset:6720
    s_waitcnt lgkmcnt(0)
    v_add_u32 v11, 49152, v10
    ds_write_b128 v11, v[16:19] offset:0
    v_add_u32 v11, 49152, v10
    ds_write_b128 v11, v[20:23] offset:4096
    v_add_u32 v11, 49152, v10
    ds_write_b128 v11, v[24:27] offset:8192
    s_waitcnt lgkmcnt(0)
    s_barrier
    s_mov_b32 s23, 768
    buffer_load_dwordx4 v[16:19], v8, s[16:19], s23 offen offset:0
    buffer_load_dwordx4 v[20:23], v8, s[16:19], s23 offen offset:128
    buffer_load_dwordx4 v[24:27], v8, s[16:19], s23 offen offset:256
    s_waitcnt vmcnt(0)
    ds_write_b128 v9, v[16:19] offset:0
    ds_write_b128 v9, v[20:23] offset:128
    ds_write_b128 v9, v[24:27] offset:256
    s_waitcnt lgkmcnt(0)
    s_barrier
    ds_read_b64_tr_b16 v[16:17], v7 offset:0
    ds_read_b64_tr_b16 v[18:19], v7 offset:6656
    ds_read_b64_tr_b16 v[20:21], v7 offset:32
    ds_read_b64_tr_b16 v[22:23], v7 offset:6688
    ds_read_b64_tr_b16 v[24:25], v7 offset:64
    ds_read_b64_tr_b16 v[26:27], v7 offset:6720
    s_waitcnt lgkmcnt(0)
    v_add_u32 v11, 98304, v10
    ds_write_b128 v11, v[16:19] offset:0
    v_add_u32 v11, 98304, v10
    ds_write_b128 v11, v[20:23] offset:4096
    v_add_u32 v11, 98304, v10
    ds_write_b128 v11, v[24:27] offset:8192
    s_waitcnt lgkmcnt(0)
    s_barrier
    s_mov_b32 s23, 36864
    buffer_load_dwordx4 v[16:19], v8, s[16:19], s23 offen offset:0
    buffer_load_dwordx4 v[20:23], v8, s[16:19], s23 offen offset:128
    buffer_load_dwordx4 v[24:27], v8, s[16:19], s23 offen offset:256
    s_waitcnt vmcnt(0)
    ds_write_b128 v9, v[16:19] offset:0
    ds_write_b128 v9, v[20:23] offset:128
    ds_write_b128 v9, v[24:27] offset:256
    s_waitcnt lgkmcnt(0)
    s_barrier
    ds_read_b64_tr_b16 v[16:17], v7 offset:0
    ds_read_b64_tr_b16 v[18:19], v7 offset:6656
    ds_read_b64_tr_b16 v[20:21], v7 offset:32
    ds_read_b64_tr_b16 v[22:23], v7 offset:6688
    ds_read_b64_tr_b16 v[24:25], v7 offset:64
    ds_read_b64_tr_b16 v[26:27], v7 offset:6720
    s_waitcnt lgkmcnt(0)
    v_add_u32 v11, 0, v10
    ds_write_b128 v11, v[16:19] offset:1024
    v_add_u32 v11, 0, v10
    ds_write_b128 v11, v[20:23] offset:5120
    v_add_u32 v11, 0, v10
    ds_write_b128 v11, v[24:27] offset:9216
    s_waitcnt lgkmcnt(0)
    s_barrier
    s_mov_b32 s23, 37248
    buffer_load_dwordx4 v[16:19], v8, s[16:19], s23 offen offset:0
    buffer_load_dwordx4 v[20:23], v8, s[16:19], s23 offen offset:128
    buffer_load_dwordx4 v[24:27], v8, s[16:19], s23 offen offset:256
    s_waitcnt vmcnt(0)
    ds_write_b128 v9, v[16:19] offset:0
    ds_write_b128 v9, v[20:23] offset:128
    ds_write_b128 v9, v[24:27] offset:256
    s_waitcnt lgkmcnt(0)
    s_barrier
    ds_read_b64_tr_b16 v[16:17], v7 offset:0
    ds_read_b64_tr_b16 v[18:19], v7 offset:6656
    ds_read_b64_tr_b16 v[20:21], v7 offset:32
    ds_read_b64_tr_b16 v[22:23], v7 offset:6688
    ds_read_b64_tr_b16 v[24:25], v7 offset:64
    ds_read_b64_tr_b16 v[26:27], v7 offset:6720
    s_waitcnt lgkmcnt(0)
    v_add_u32 v11, 49152, v10
    ds_write_b128 v11, v[16:19] offset:1024
    v_add_u32 v11, 49152, v10
    ds_write_b128 v11, v[20:23] offset:5120
    v_add_u32 v11, 49152, v10
    ds_write_b128 v11, v[24:27] offset:9216
    s_waitcnt lgkmcnt(0)
    s_barrier
    s_mov_b32 s23, 37632
    buffer_load_dwordx4 v[16:19], v8, s[16:19], s23 offen offset:0
    buffer_load_dwordx4 v[20:23], v8, s[16:19], s23 offen offset:128
    buffer_load_dwordx4 v[24:27], v8, s[16:19], s23 offen offset:256
    s_waitcnt vmcnt(0)
    ds_write_b128 v9, v[16:19] offset:0
    ds_write_b128 v9, v[20:23] offset:128
    ds_write_b128 v9, v[24:27] offset:256
    s_waitcnt lgkmcnt(0)
    s_barrier
    ds_read_b64_tr_b16 v[16:17], v7 offset:0
    ds_read_b64_tr_b16 v[18:19], v7 offset:6656
    ds_read_b64_tr_b16 v[20:21], v7 offset:32
    ds_read_b64_tr_b16 v[22:23], v7 offset:6688
    ds_read_b64_tr_b16 v[24:25], v7 offset:64
    ds_read_b64_tr_b16 v[26:27], v7 offset:6720
    s_waitcnt lgkmcnt(0)
    v_add_u32 v11, 98304, v10
    ds_write_b128 v11, v[16:19] offset:1024
    v_add_u32 v11, 98304, v10
    ds_write_b128 v11, v[20:23] offset:5120
    v_add_u32 v11, 98304, v10
    ds_write_b128 v11, v[24:27] offset:9216
    s_waitcnt lgkmcnt(0)
    s_barrier
    s_mov_b32 s23, 73728
    buffer_load_dwordx4 v[16:19], v8, s[16:19], s23 offen offset:0
    buffer_load_dwordx4 v[20:23], v8, s[16:19], s23 offen offset:128
    buffer_load_dwordx4 v[24:27], v8, s[16:19], s23 offen offset:256
    s_waitcnt vmcnt(0)
    ds_write_b128 v9, v[16:19] offset:0
    ds_write_b128 v9, v[20:23] offset:128
    ds_write_b128 v9, v[24:27] offset:256
    s_waitcnt lgkmcnt(0)
    s_barrier
    ds_read_b64_tr_b16 v[16:17], v7 offset:0
    ds_read_b64_tr_b16 v[18:19], v7 offset:6656
    ds_read_b64_tr_b16 v[20:21], v7 offset:32
    ds_read_b64_tr_b16 v[22:23], v7 offset:6688
    ds_read_b64_tr_b16 v[24:25], v7 offset:64
    ds_read_b64_tr_b16 v[26:27], v7 offset:6720
    s_waitcnt lgkmcnt(0)
    v_add_u32 v11, 0, v10
    ds_write_b128 v11, v[16:19] offset:2048
    v_add_u32 v11, 0, v10
    ds_write_b128 v11, v[20:23] offset:6144
    v_add_u32 v11, 0, v10
    ds_write_b128 v11, v[24:27] offset:10240
    s_waitcnt lgkmcnt(0)
    s_barrier
    s_mov_b32 s23, 74112
    buffer_load_dwordx4 v[16:19], v8, s[16:19], s23 offen offset:0
    buffer_load_dwordx4 v[20:23], v8, s[16:19], s23 offen offset:128
    buffer_load_dwordx4 v[24:27], v8, s[16:19], s23 offen offset:256
    s_waitcnt vmcnt(0)
    ds_write_b128 v9, v[16:19] offset:0
    ds_write_b128 v9, v[20:23] offset:128
    ds_write_b128 v9, v[24:27] offset:256
    s_waitcnt lgkmcnt(0)
    s_barrier
    ds_read_b64_tr_b16 v[16:17], v7 offset:0
    ds_read_b64_tr_b16 v[18:19], v7 offset:6656
    ds_read_b64_tr_b16 v[20:21], v7 offset:32
    ds_read_b64_tr_b16 v[22:23], v7 offset:6688
    ds_read_b64_tr_b16 v[24:25], v7 offset:64
    ds_read_b64_tr_b16 v[26:27], v7 offset:6720
    s_waitcnt lgkmcnt(0)
    v_add_u32 v11, 49152, v10
    ds_write_b128 v11, v[16:19] offset:2048
    v_add_u32 v11, 49152, v10
    ds_write_b128 v11, v[20:23] offset:6144
    v_add_u32 v11, 49152, v10
    ds_write_b128 v11, v[24:27] offset:10240
    s_waitcnt lgkmcnt(0)
    s_barrier
    s_mov_b32 s23, 74496
    buffer_load_dwordx4 v[16:19], v8, s[16:19], s23 offen offset:0
    buffer_load_dwordx4 v[20:23], v8, s[16:19], s23 offen offset:128
    buffer_load_dwordx4 v[24:27], v8, s[16:19], s23 offen offset:256
    s_waitcnt vmcnt(0)
    ds_write_b128 v9, v[16:19] offset:0
    ds_write_b128 v9, v[20:23] offset:128
    ds_write_b128 v9, v[24:27] offset:256
    s_waitcnt lgkmcnt(0)
    s_barrier
    ds_read_b64_tr_b16 v[16:17], v7 offset:0
    ds_read_b64_tr_b16 v[18:19], v7 offset:6656
    ds_read_b64_tr_b16 v[20:21], v7 offset:32
    ds_read_b64_tr_b16 v[22:23], v7 offset:6688
    ds_read_b64_tr_b16 v[24:25], v7 offset:64
    ds_read_b64_tr_b16 v[26:27], v7 offset:6720
    s_waitcnt lgkmcnt(0)
    v_add_u32 v11, 98304, v10
    ds_write_b128 v11, v[16:19] offset:2048
    v_add_u32 v11, 98304, v10
    ds_write_b128 v11, v[20:23] offset:6144
    v_add_u32 v11, 98304, v10
    ds_write_b128 v11, v[24:27] offset:10240
    s_waitcnt lgkmcnt(0)
    s_barrier
    s_mov_b32 s23, 110592
    buffer_load_dwordx4 v[16:19], v8, s[16:19], s23 offen offset:0
    buffer_load_dwordx4 v[20:23], v8, s[16:19], s23 offen offset:128
    buffer_load_dwordx4 v[24:27], v8, s[16:19], s23 offen offset:256
    s_waitcnt vmcnt(0)
    ds_write_b128 v9, v[16:19] offset:0
    ds_write_b128 v9, v[20:23] offset:128
    ds_write_b128 v9, v[24:27] offset:256
    s_waitcnt lgkmcnt(0)
    s_barrier
    ds_read_b64_tr_b16 v[16:17], v7 offset:0
    ds_read_b64_tr_b16 v[18:19], v7 offset:6656
    ds_read_b64_tr_b16 v[20:21], v7 offset:32
    ds_read_b64_tr_b16 v[22:23], v7 offset:6688
    ds_read_b64_tr_b16 v[24:25], v7 offset:64
    ds_read_b64_tr_b16 v[26:27], v7 offset:6720
    s_waitcnt lgkmcnt(0)
    v_add_u32 v11, 0, v10
    ds_write_b128 v11, v[16:19] offset:3072
    v_add_u32 v11, 0, v10
    ds_write_b128 v11, v[20:23] offset:7168
    v_add_u32 v11, 0, v10
    ds_write_b128 v11, v[24:27] offset:11264
    s_waitcnt lgkmcnt(0)
    s_barrier
    s_mov_b32 s23, 110976
    buffer_load_dwordx4 v[16:19], v8, s[16:19], s23 offen offset:0
    buffer_load_dwordx4 v[20:23], v8, s[16:19], s23 offen offset:128
    buffer_load_dwordx4 v[24:27], v8, s[16:19], s23 offen offset:256
    s_waitcnt vmcnt(0)
    ds_write_b128 v9, v[16:19] offset:0
    ds_write_b128 v9, v[20:23] offset:128
    ds_write_b128 v9, v[24:27] offset:256
    s_waitcnt lgkmcnt(0)
    s_barrier
    ds_read_b64_tr_b16 v[16:17], v7 offset:0
    ds_read_b64_tr_b16 v[18:19], v7 offset:6656
    ds_read_b64_tr_b16 v[20:21], v7 offset:32
    ds_read_b64_tr_b16 v[22:23], v7 offset:6688
    ds_read_b64_tr_b16 v[24:25], v7 offset:64
    ds_read_b64_tr_b16 v[26:27], v7 offset:6720
    s_waitcnt lgkmcnt(0)
    v_add_u32 v11, 49152, v10
    ds_write_b128 v11, v[16:19] offset:3072
    v_add_u32 v11, 49152, v10
    ds_write_b128 v11, v[20:23] offset:7168
    v_add_u32 v11, 49152, v10
    ds_write_b128 v11, v[24:27] offset:11264
    s_waitcnt lgkmcnt(0)
    s_barrier
    s_mov_b32 s23, 111360
    buffer_load_dwordx4 v[16:19], v8, s[16:19], s23 offen offset:0
    buffer_load_dwordx4 v[20:23], v8, s[16:19], s23 offen offset:128
    buffer_load_dwordx4 v[24:27], v8, s[16:19], s23 offen offset:256
    s_waitcnt vmcnt(0)
    ds_write_b128 v9, v[16:19] offset:0
    ds_write_b128 v9, v[20:23] offset:128
    ds_write_b128 v9, v[24:27] offset:256
    s_waitcnt lgkmcnt(0)
    s_barrier
    ds_read_b64_tr_b16 v[16:17], v7 offset:0
    ds_read_b64_tr_b16 v[18:19], v7 offset:6656
    ds_read_b64_tr_b16 v[20:21], v7 offset:32
    ds_read_b64_tr_b16 v[22:23], v7 offset:6688
    ds_read_b64_tr_b16 v[24:25], v7 offset:64
    ds_read_b64_tr_b16 v[26:27], v7 offset:6720
    s_waitcnt lgkmcnt(0)
    v_add_u32 v11, 98304, v10
    ds_write_b128 v11, v[16:19] offset:3072
    v_add_u32 v11, 98304, v10
    ds_write_b128 v11, v[20:23] offset:7168
    v_add_u32 v11, 98304, v10
    ds_write_b128 v11, v[24:27] offset:11264
    s_waitcnt lgkmcnt(0)
    s_barrier
    v_and_b32 v15, 7, v0
    v_mul_u32_u24 v5, 1152, v15
    v_lshl_add_u32 v5, v2, 4, v5
    v_add_u32 v5, 147456, v5
    v_mul_u32_u24 v6, 576, v3
    v_add_u32 v6, v6, v4
    v_lshlrev_b32 v7, 3, v6
    v_lshlrev_b32 v6, 2, v6
    v_add_u32 v6, 147456, v6
    v_lshlrev_b32 v8, 13, v1
    v_lshl_add_u32 v8, v3, 6, v8
    v_lshl_add_u32 v8, v2, 3, v8
    v_lshl_add_u32 v9, v3, 5, v1
    v_lshlrev_b32 v9, 6, v9
    v_lshl_add_u32 v9, v2, 3, v9
    v_lshl_add_u32 v10, v15, 2, v2
    v_mul_u32_u24 v10, 48, v10
    v_add_u32 v10, 156672, v10
    v_lshlrev_b32 v11, 4, v4
    v_lshlrev_b32 v12, 2, v2
    v_mul_u32_u24 v12, 2304, v12
    v_lshl_add_u32 v12, v1, 2, v12
    v_mul_u32_u24 v13, 576, v3
    v_add_u32 v12, v12, v13
    v_lshlrev_b32 v13, 8, v1
    v_lshl_add_u32 v13, v3, 6, v13
    v_lshl_add_u32 v13, v2, 3, v13
    v_lshl_add_u32 v14, v3, 5, v1
    v_lshlrev_b32 v14, 4, v14
    v_lshl_add_u32 v14, v2, 3, v14
    s_mov_b32 s20, 0
    s_mov_b32 s44, 0x3fb8aa3b
    s_mov_b32 s45, 0x3db504f3
    v_cmp_gt_u32 s[46:47], 2, v2
    v_cmp_gt_u32 s[48:49], 8, v1
    v_add_u32 v0, 147456, v11
    v_mul_u32_u24 v3, 36864, v3
    v_add_u32 v3, v3, v11

chain_loop:
    s_cmp_eq_u32 s20, 0
    s_cbranch_scc1 chain_kernel_first1
    s_lshl_b32 s24, s20, 8
    s_add_u32 s24, s24, 16384
    v_mov_b32 v72, 0
    s_mov_b32 s27, 0
    s_cmp_lg_u32 s21, 0
    s_cbranch_scc1 chain_kernel_pdone4

chain_kernel_poll3:
    buffer_load_dword v73, v72, s[8:11], s24 offen sc1
    s_waitcnt vmcnt(0)
    v_readfirstlane_b32 s26, v73
    s_cmp_ge_u32 s26, 32
    s_cbranch_scc1 chain_kernel_pdone4
    s_sleep 1
    s_add_u32 s27, s27, 1
    s_cmp_lt_u32 s27, 2000000
    s_cbranch_scc1 chain_kernel_poll3

chain_kernel_pdone4:
    s_barrier
    s_mul_i32 s24, s20, 36864
    s_add_u32 s24, s24, 32768

    s_add_u32 s25, s24, 0
    s_add_u32 s26, s24, 4096
    buffer_load_dwordx2 v[40:41], v7, s[8:11], s25 offen offset:0 sc1
    buffer_load_dwordx2 v[42:43], v7, s[8:11], s25 offen offset:512 sc1
    buffer_load_dwordx2 v[44:45], v7, s[8:11], s25 offen offset:1024 sc1
    buffer_load_dwordx2 v[46:47], v7, s[8:11], s25 offen offset:1536 sc1
    buffer_load_dwordx2 v[48:49], v7, s[8:11], s25 offen offset:2048 sc1
    buffer_load_dwordx2 v[50:51], v7, s[8:11], s25 offen offset:2560 sc1
    buffer_load_dwordx2 v[52:53], v7, s[8:11], s25 offen offset:3072 sc1
    buffer_load_dwordx2 v[54:55], v7, s[8:11], s25 offen offset:3584 sc1
    buffer_load_dwordx2 v[56:57], v7, s[8:11], s26 offen sc1
    s_add_u32 s25, s24, 18432
    s_add_u32 s26, s24, 22528
    buffer_load_dwordx2 v[58:59], v7, s[8:11], s25 offen offset:0 sc1
    buffer_load_dwordx2 v[60:61], v7, s[8:11], s25 offen offset:512 sc1
    buffer_load_dwordx2 v[62:63], v7, s[8:11], s25 offen offset:1024 sc1
    buffer_load_dwordx2 v[64:65], v7, s[8:11], s25 offen offset:1536 sc1
    buffer_load_dwordx2 v[66:67], v7, s[8:11], s25 offen offset:2048 sc1
    buffer_load_dwordx2 v[68:69], v7, s[8:11], s25 offen offset:2560 sc1
    buffer_load_dwordx2 v[70:71], v7, s[8:11], s25 offen offset:3072 sc1
    buffer_load_dwordx2 v[72:73], v7, s[8:11], s25 offen offset:3584 sc1
    buffer_load_dwordx2 v[74:75], v7, s[8:11], s26 offen sc1
    s_waitcnt vmcnt(0)
    v_add_f32 v40, v40, v58
    v_mov_b32 v16, v40
    v_add_f32 v41, v41, v59
    v_mov_b32 v17, v41
    v_add_f32 v42, v42, v60
    v_mov_b32 v18, v42
    v_add_f32 v43, v43, v61
    v_mov_b32 v19, v43
    v_add_f32 v44, v44, v62
    v_mov_b32 v20, v44
    v_add_f32 v45, v45, v63
    v_mov_b32 v21, v45
    v_add_f32 v46, v46, v64
    v_mov_b32 v22, v46
    v_add_f32 v47, v47, v65
    v_mov_b32 v23, v47
    v_add_f32 v48, v48, v66
    v_mov_b32 v24, v48
    v_add_f32 v49, v49, v67
    v_mov_b32 v25, v49
    v_add_f32 v50, v50, v68
    v_mov_b32 v26, v50
    v_add_f32 v51, v51, v69
    v_mov_b32 v27, v51
    v_add_f32 v52, v52, v70
    v_mov_b32 v28, v52
    v_add_f32 v53, v53, v71
    v_mov_b32 v29, v53
    v_add_f32 v54, v54, v72
    v_mov_b32 v30, v54
    v_add_f32 v55, v55, v73
    v_mov_b32 v31, v55
    v_add_f32 v56, v56, v74
    v_mov_b32 v32, v56
    v_add_f32 v57, v57, v75
    v_mov_b32 v33, v57
    v_cvt_pk_bf16_f32 v16, v16, v17
    ds_write_b32 v6, v16 offset:0
    v_cvt_pk_bf16_f32 v18, v18, v19
    ds_write_b32 v6, v18 offset:256
    v_cvt_pk_bf16_f32 v20, v20, v21
    ds_write_b32 v6, v20 offset:512
    v_cvt_pk_bf16_f32 v22, v22, v23
    ds_write_b32 v6, v22 offset:768
    v_cvt_pk_bf16_f32 v24, v24, v25
    ds_write_b32 v6, v24 offset:1024
    v_cvt_pk_bf16_f32 v26, v26, v27
    ds_write_b32 v6, v26 offset:1280
    v_cvt_pk_bf16_f32 v28, v28, v29
    ds_write_b32 v6, v28 offset:1536
    v_cvt_pk_bf16_f32 v30, v30, v31
    ds_write_b32 v6, v30 offset:1792
    v_cvt_pk_bf16_f32 v32, v32, v33
    ds_write_b32 v6, v32 offset:2048
    s_branch chain_kernel_memdone2
chain_kernel_first1:
    v_lshrrev_b32 v79, 1, v7
    buffer_load_dword v72, v79, s[12:15], 0 offen offset:0
    buffer_load_dword v73, v79, s[12:15], 0 offen offset:256
    buffer_load_dword v74, v79, s[12:15], 0 offen offset:512
    buffer_load_dword v75, v79, s[12:15], 0 offen offset:768
    buffer_load_dword v76, v79, s[12:15], 0 offen offset:1024
    buffer_load_dword v77, v79, s[12:15], 0 offen offset:1280
    s_waitcnt vmcnt(0)
    ds_write_b32 v6, v72 offset:0
    ds_write_b32 v6, v73 offset:256
    ds_write_b32 v6, v74 offset:512
    ds_write_b32 v6, v75 offset:768
    ds_write_b32 v6, v76 offset:1024
    ds_write_b32 v6, v77 offset:1280
    buffer_load_dword v72, v79, s[12:15], 0 offen offset:1536
    buffer_load_dword v73, v79, s[12:15], 0 offen offset:1792
    buffer_load_dword v74, v79, s[12:15], 0 offen offset:2048
    s_waitcnt vmcnt(0)
    ds_write_b32 v6, v72 offset:1536
    ds_write_b32 v6, v73 offset:1792
    ds_write_b32 v6, v74 offset:2048
chain_kernel_memdone2:
    s_lshl_b32 s24, s20, 18
    s_lshl_b32 s25, s2, 8
    s_add_u32 s24, s24, s25
    s_add_u32 s24, s24, 21528576
    s_add_u32 s26, s24, 131072
    s_lshl_b32 s25, s20, 5
    s_add_u32 s25, s25, s2
    s_lshl_b32 s25, s25, 13
    s_add_u32 s25, s25, 38305792
    buffer_load_dwordx2 v[16:17], v8, s[8:11], s24 offen
    buffer_load_dwordx2 v[18:19], v8, s[8:11], s24 offen offset:32
    buffer_load_dwordx2 v[20:21], v8, s[8:11], s26 offen
    buffer_load_dwordx2 v[22:23], v8, s[8:11], s26 offen offset:32

    buffer_load_dwordx2 v[26:27], v9, s[8:11], s25 offen offset:0
    buffer_load_dwordx2 v[28:29], v9, s[8:11], s25 offen offset:32
    v_mov_b32 v30, 0
    v_mov_b32 v31, 0
    buffer_load_dwordx2 v[34:35], v9, s[8:11], s25 offen offset:1024
    buffer_load_dwordx2 v[36:37], v9, s[8:11], s25 offen offset:1056
    v_mov_b32 v38, 0
    v_mov_b32 v39, 0
    s_waitcnt lgkmcnt(0)
    s_barrier
    ds_read_b128 v[64:67], v5
    ds_read_b128 v[68:71], v5 offset:64
    s_waitcnt lgkmcnt(1)
    v_mfma_f32_16x16x32_bf16 v[40:43], a[0:3], v[64:67], 0
    v_mfma_f32_16x16x32_bf16 v[44:47], a[4:7], v[64:67], 0
    v_mfma_f32_16x16x32_bf16 v[48:51], a[144:147], v[64:67], 0
    v_mfma_f32_16x16x32_bf16 v[52:55], a[148:151], v[64:67], 0
    v_mfma_f32_16x16x32_bf16 v[56:59], v[64:67], v[112:115], 0
    v_mfma_f32_16x16x32_bf16 v[60:63], v[64:67], v[116:119], 0
    ds_read_b128 v[64:67], v5 offset:128
    s_waitcnt lgkmcnt(1)
    v_mfma_f32_16x16x32_bf16 v[40:43], a[8:11], v[68:71], v[40:43]
    v_mfma_f32_16x16x32_bf16 v[44:47], a[12:15], v[68:71], v[44:47]
    v_mfma_f32_16x16x32_bf16 v[48:51], a[152:155], v[68:71], v[48:51]
    v_mfma_f32_16x16x32_bf16 v[52:55], a[156:159], v[68:71], v[52:55]
    v_mfma_f32_16x16x32_bf16 v[56:59], v[68:71], v[120:123], v[56:59]
    v_mfma_f32_16x16x32_bf16 v[60:63], v[68:71], v[124:127], v[60:63]
    ds_read_b128 v[68:71], v5 offset:192
    s_waitcnt lgkmcnt(1)
    v_mfma_f32_16x16x32_bf16 v[40:43], a[16:19], v[64:67], v[40:43]
    v_mfma_f32_16x16x32_bf16 v[44:47], a[20:23], v[64:67], v[44:47]
    v_mfma_f32_16x16x32_bf16 v[48:51], a[160:163], v[64:67], v[48:51]
    v_mfma_f32_16x16x32_bf16 v[52:55], a[164:167], v[64:67], v[52:55]
    v_mfma_f32_16x16x32_bf16 v[56:59], v[64:67], v[128:131], v[56:59]
    v_mfma_f32_16x16x32_bf16 v[60:63], v[64:67], v[132:135], v[60:63]
    ds_read_b128 v[64:67], v5 offset:256
    s_waitcnt lgkmcnt(1)
    v_mfma_f32_16x16x32_bf16 v[40:43], a[24:27], v[68:71], v[40:43]
    v_mfma_f32_16x16x32_bf16 v[44:47], a[28:31], v[68:71], v[44:47]
    v_mfma_f32_16x16x32_bf16 v[48:51], a[168:171], v[68:71], v[48:51]
    v_mfma_f32_16x16x32_bf16 v[52:55], a[172:175], v[68:71], v[52:55]
    v_mfma_f32_16x16x32_bf16 v[56:59], v[68:71], v[136:139], v[56:59]
    v_mfma_f32_16x16x32_bf16 v[60:63], v[68:71], v[140:143], v[60:63]
    ds_read_b128 v[68:71], v5 offset:320
    s_waitcnt lgkmcnt(1)
    v_mfma_f32_16x16x32_bf16 v[40:43], a[32:35], v[64:67], v[40:43]
    v_mfma_f32_16x16x32_bf16 v[44:47], a[36:39], v[64:67], v[44:47]
    v_mfma_f32_16x16x32_bf16 v[48:51], a[176:179], v[64:67], v[48:51]
    v_mfma_f32_16x16x32_bf16 v[52:55], a[180:183], v[64:67], v[52:55]
    v_mfma_f32_16x16x32_bf16 v[56:59], v[64:67], v[144:147], v[56:59]
    v_mfma_f32_16x16x32_bf16 v[60:63], v[64:67], v[148:151], v[60:63]
    ds_read_b128 v[64:67], v5 offset:384
    s_waitcnt lgkmcnt(1)
    v_mfma_f32_16x16x32_bf16 v[40:43], a[40:43], v[68:71], v[40:43]
    v_mfma_f32_16x16x32_bf16 v[44:47], a[44:47], v[68:71], v[44:47]
    v_mfma_f32_16x16x32_bf16 v[48:51], a[184:187], v[68:71], v[48:51]
    v_mfma_f32_16x16x32_bf16 v[52:55], a[188:191], v[68:71], v[52:55]
    v_mfma_f32_16x16x32_bf16 v[56:59], v[68:71], v[152:155], v[56:59]
    v_mfma_f32_16x16x32_bf16 v[60:63], v[68:71], v[156:159], v[60:63]
    ds_read_b128 v[68:71], v5 offset:448
    s_waitcnt lgkmcnt(1)
    v_mfma_f32_16x16x32_bf16 v[40:43], a[48:51], v[64:67], v[40:43]
    v_mfma_f32_16x16x32_bf16 v[44:47], a[52:55], v[64:67], v[44:47]
    v_mfma_f32_16x16x32_bf16 v[48:51], a[192:195], v[64:67], v[48:51]
    v_mfma_f32_16x16x32_bf16 v[52:55], a[196:199], v[64:67], v[52:55]
    v_mfma_f32_16x16x32_bf16 v[56:59], v[64:67], v[160:163], v[56:59]
    v_mfma_f32_16x16x32_bf16 v[60:63], v[64:67], v[164:167], v[60:63]
    ds_read_b128 v[64:67], v5 offset:512
    s_waitcnt lgkmcnt(1)
    v_mfma_f32_16x16x32_bf16 v[40:43], a[56:59], v[68:71], v[40:43]
    v_mfma_f32_16x16x32_bf16 v[44:47], a[60:63], v[68:71], v[44:47]
    v_mfma_f32_16x16x32_bf16 v[48:51], a[200:203], v[68:71], v[48:51]
    v_mfma_f32_16x16x32_bf16 v[52:55], a[204:207], v[68:71], v[52:55]
    v_mfma_f32_16x16x32_bf16 v[56:59], v[68:71], v[168:171], v[56:59]
    v_mfma_f32_16x16x32_bf16 v[60:63], v[68:71], v[172:175], v[60:63]
    ds_read_b128 v[68:71], v5 offset:576
    s_waitcnt lgkmcnt(1)
    v_mfma_f32_16x16x32_bf16 v[40:43], a[64:67], v[64:67], v[40:43]
    v_mfma_f32_16x16x32_bf16 v[44:47], a[68:71], v[64:67], v[44:47]
    v_mfma_f32_16x16x32_bf16 v[48:51], a[208:211], v[64:67], v[48:51]
    v_mfma_f32_16x16x32_bf16 v[52:55], a[212:215], v[64:67], v[52:55]
    v_mfma_f32_16x16x32_bf16 v[56:59], v[64:67], v[176:179], v[56:59]
    v_mfma_f32_16x16x32_bf16 v[60:63], v[64:67], v[180:183], v[60:63]
    ds_read_b128 v[64:67], v5 offset:640
    s_waitcnt lgkmcnt(1)
    v_mfma_f32_16x16x32_bf16 v[40:43], a[72:75], v[68:71], v[40:43]
    v_mfma_f32_16x16x32_bf16 v[44:47], a[76:79], v[68:71], v[44:47]
    v_mfma_f32_16x16x32_bf16 v[48:51], a[216:219], v[68:71], v[48:51]
    v_mfma_f32_16x16x32_bf16 v[52:55], a[220:223], v[68:71], v[52:55]
    v_mfma_f32_16x16x32_bf16 v[56:59], v[68:71], v[184:187], v[56:59]
    v_mfma_f32_16x16x32_bf16 v[60:63], v[68:71], v[188:191], v[60:63]
    ds_read_b128 v[68:71], v5 offset:704
    s_waitcnt lgkmcnt(1)
    v_mfma_f32_16x16x32_bf16 v[40:43], a[80:83], v[64:67], v[40:43]
    v_mfma_f32_16x16x32_bf16 v[44:47], a[84:87], v[64:67], v[44:47]
    v_mfma_f32_16x16x32_bf16 v[48:51], a[224:227], v[64:67], v[48:51]
    v_mfma_f32_16x16x32_bf16 v[52:55], a[228:231], v[64:67], v[52:55]
    v_mfma_f32_16x16x32_bf16 v[56:59], v[64:67], v[192:195], v[56:59]
    v_mfma_f32_16x16x32_bf16 v[60:63], v[64:67], v[196:199], v[60:63]
    ds_read_b128 v[64:67], v5 offset:768
    s_waitcnt lgkmcnt(1)
    v_mfma_f32_16x16x32_bf16 v[40:43], a[88:91], v[68:71], v[40:43]
    v_mfma_f32_16x16x32_bf16 v[44:47], a[92:95], v[68:71], v[44:47]
    v_mfma_f32_16x16x32_bf16 v[48:51], a[232:235], v[68:71], v[48:51]
    v_mfma_f32_16x16x32_bf16 v[52:55], a[236:239], v[68:71], v[52:55]
    v_mfma_f32_16x16x32_bf16 v[56:59], v[68:71], v[200:203], v[56:59]
    v_mfma_f32_16x16x32_bf16 v[60:63], v[68:71], v[204:207], v[60:63]
    ds_read_b128 v[68:71], v5 offset:832
    s_waitcnt lgkmcnt(1)
    v_mfma_f32_16x16x32_bf16 v[40:43], a[96:99], v[64:67], v[40:43]
    v_mfma_f32_16x16x32_bf16 v[44:47], a[100:103], v[64:67], v[44:47]
    v_mfma_f32_16x16x32_bf16 v[48:51], a[240:243], v[64:67], v[48:51]
    v_mfma_f32_16x16x32_bf16 v[52:55], a[244:247], v[64:67], v[52:55]
    v_mfma_f32_16x16x32_bf16 v[56:59], v[64:67], v[208:211], v[56:59]
    v_mfma_f32_16x16x32_bf16 v[60:63], v[64:67], v[212:215], v[60:63]
    ds_read_b128 v[64:67], v5 offset:896
    s_waitcnt lgkmcnt(1)
    v_mfma_f32_16x16x32_bf16 v[40:43], a[104:107], v[68:71], v[40:43]
    v_mfma_f32_16x16x32_bf16 v[44:47], a[108:111], v[68:71], v[44:47]
    v_mfma_f32_16x16x32_bf16 v[48:51], a[248:251], v[68:71], v[48:51]
    v_mfma_f32_16x16x32_bf16 v[52:55], a[252:255], v[68:71], v[52:55]
    v_mfma_f32_16x16x32_bf16 v[56:59], v[68:71], v[216:219], v[56:59]
    v_mfma_f32_16x16x32_bf16 v[60:63], v[68:71], v[220:223], v[60:63]
    ds_read_b128 v[68:71], v5 offset:960
    s_waitcnt lgkmcnt(1)
    v_mfma_f32_16x16x32_bf16 v[40:43], a[112:115], v[64:67], v[40:43]
    v_mfma_f32_16x16x32_bf16 v[44:47], a[116:119], v[64:67], v[44:47]
    v_mfma_f32_16x16x32_bf16 v[48:51], v[80:83], v[64:67], v[48:51]
    v_mfma_f32_16x16x32_bf16 v[52:55], v[84:87], v[64:67], v[52:55]
    v_mfma_f32_16x16x32_bf16 v[56:59], v[64:67], v[224:227], v[56:59]
    v_mfma_f32_16x16x32_bf16 v[60:63], v[64:67], v[228:231], v[60:63]
    ds_read_b128 v[64:67], v5 offset:1024
    s_waitcnt lgkmcnt(1)
    v_mfma_f32_16x16x32_bf16 v[40:43], a[120:123], v[68:71], v[40:43]
    v_mfma_f32_16x16x32_bf16 v[44:47], a[124:127], v[68:71], v[44:47]
    v_mfma_f32_16x16x32_bf16 v[48:51], v[88:91], v[68:71], v[48:51]
    v_mfma_f32_16x16x32_bf16 v[52:55], v[92:95], v[68:71], v[52:55]
    v_mfma_f32_16x16x32_bf16 v[56:59], v[68:71], v[232:235], v[56:59]
    v_mfma_f32_16x16x32_bf16 v[60:63], v[68:71], v[236:239], v[60:63]
    ds_read_b128 v[68:71], v5 offset:1088
    s_waitcnt lgkmcnt(1)
    v_mfma_f32_16x16x32_bf16 v[40:43], a[128:131], v[64:67], v[40:43]
    v_mfma_f32_16x16x32_bf16 v[44:47], a[132:135], v[64:67], v[44:47]
    v_mfma_f32_16x16x32_bf16 v[48:51], v[96:99], v[64:67], v[48:51]
    v_mfma_f32_16x16x32_bf16 v[52:55], v[100:103], v[64:67], v[52:55]
    v_mfma_f32_16x16x32_bf16 v[56:59], v[64:67], v[240:243], v[56:59]
    v_mfma_f32_16x16x32_bf16 v[60:63], v[64:67], v[244:247], v[60:63]
    s_waitcnt lgkmcnt(0)
    v_mfma_f32_16x16x32_bf16 v[40:43], a[136:139], v[68:71], v[40:43]
    v_mfma_f32_16x16x32_bf16 v[44:47], a[140:143], v[68:71], v[44:47]
    v_mfma_f32_16x16x32_bf16 v[48:51], v[104:107], v[68:71], v[48:51]
    v_mfma_f32_16x16x32_bf16 v[52:55], v[108:111], v[68:71], v[52:55]
    v_mfma_f32_16x16x32_bf16 v[56:59], v[68:71], v[248:251], v[56:59]
    v_mfma_f32_16x16x32_bf16 v[60:63], v[68:71], v[252:255], v[60:63]
    s_nop 7
    s_nop 1
    v_cvt_pk_bf16_f32 v64, v40, v41
    v_cvt_pk_bf16_f32 v68, v48, v49
    v_cvt_pk_bf16_f32 v65, v42, v43
    v_cvt_pk_bf16_f32 v69, v50, v51
    v_cvt_pk_bf16_f32 v66, v44, v45
    v_cvt_pk_bf16_f32 v70, v52, v53
    v_cvt_pk_bf16_f32 v67, v46, v47
    v_cvt_pk_bf16_f32 v71, v54, v55
    v_cvt_pk_bf16_f32 v24, v56, v57
    v_cvt_pk_bf16_f32 v25, v58, v59
    v_cvt_pk_bf16_f32 v32, v60, v61
    v_cvt_pk_bf16_f32 v33, v62, v63
    s_lshl_b32 s24, s20, 5
    s_add_u32 s24, s24, s2
    s_lshl_b32 s24, s24, 11
    s_add_u32 s25, s24, 59277312
    s_add_u32 s24, s24, 55083008
    s_mov_b64 s[50:51], exec
    s_mov_b64 exec, s[48:49]
    buffer_store_dwordx2 v[68:69], v13, s[8:11], s24 offen
    buffer_store_dwordx2 v[70:71], v13, s[8:11], s24 offen offset:32
    s_mov_b64 exec, s[46:47]
    buffer_store_dwordx2 v[24:25], v14, s[8:11], s25 offen
    buffer_store_dwordx2 v[32:33], v14, s[8:11], s25 offen offset:256
    s_mov_b64 exec, s[50:51]

    s_cmp_ge_u32 s20, 63
    s_cbranch_scc1 chain_kernel_last5
    s_waitcnt vmcnt(0)

    v_mfma_f32_16x16x32_bf16 v[40:43], v[68:71], v[64:67], 0
    v_mfma_f32_16x16x32_bf16 v[44:47], v[16:19], v[64:67], 0
    v_mfma_f32_16x16x32_bf16 v[48:51], v[20:23], v[64:67], 0
    s_nop 7
    s_nop 1
    s_mul_i32 s24, s21, 1536
    v_add_u32 v72, s24, v10
    s_mov_b64 exec, s[48:49]
    ds_write_b128 v72, v[40:43]
    ds_write_b128 v72, v[44:47] offset:16
    ds_write_b128 v72, v[48:51] offset:32
    s_mov_b64 exec, s[50:51]
    s_waitcnt lgkmcnt(0)
    s_barrier

    ds_read_b128 v[40:43], v10
    ds_read_b128 v[44:47], v10 offset:16
    ds_read_b128 v[48:51], v10 offset:32

    ds_read_b128 v[52:55], v10 offset:1536
    ds_read_b128 v[56:59], v10 offset:1552
    ds_read_b128 v[60:63], v10 offset:1568
    s_waitcnt lgkmcnt(0)

    v_add_f32 v40, v40, v52
    v_add_f32 v41, v41, v53
    v_add_f32 v42, v42, v54
    v_add_f32 v43, v43, v55
    v_add_f32 v44, v44, v56
    v_add_f32 v45, v45, v57
    v_add_f32 v46, v46, v58
    v_add_f32 v47, v47, v59
    v_add_f32 v48, v48, v60
    v_add_f32 v49, v49, v61
    v_add_f32 v50, v50, v62
    v_add_f32 v51, v51, v63
    ds_read_b128 v[52:55], v10 offset:3072
    ds_read_b128 v[56:59], v10 offset:3088
    ds_read_b128 v[60:63], v10 offset:3104
    s_waitcnt lgkmcnt(0)

    v_add_f32 v40, v40, v52
    v_add_f32 v41, v41, v53
    v_add_f32 v42, v42, v54
    v_add_f32 v43, v43, v55
    v_add_f32 v44, v44, v56
    v_add_f32 v45, v45, v57
    v_add_f32 v46, v46, v58
    v_add_f32 v47, v47, v59
    v_add_f32 v48, v48, v60
    v_add_f32 v49, v49, v61
    v_add_f32 v50, v50, v62
    v_add_f32 v51, v51, v63
    ds_read_b128 v[52:55], v10 offset:4608
    ds_read_b128 v[56:59], v10 offset:4624
    ds_read_b128 v[60:63], v10 offset:4640
    s_waitcnt lgkmcnt(0)

    v_add_f32 v40, v40, v52
    v_add_f32 v41, v41, v53
    v_add_f32 v42, v42, v54
    v_add_f32 v43, v43, v55
    v_add_f32 v44, v44, v56
    v_add_f32 v45, v45, v57
    v_add_f32 v46, v46, v58
    v_add_f32 v47, v47, v59
    v_add_f32 v48, v48, v60
    v_add_f32 v49, v49, v61
    v_add_f32 v50, v50, v62
    v_add_f32 v51, v51, v63
    v_cvt_pk_bf16_f32 v72, v40, v41
    v_lshlrev_b32 v40, 16, v72
    v_and_b32 v41, 0xffff0000, v72
    v_mul_f32 v40, s45, v40
    v_mul_f32 v41, s45, v41
    v_cvt_pk_bf16_f32 v72, v40, v41
    v_lshlrev_b32 v40, 16, v72
    v_and_b32 v41, 0xffff0000, v72

    v_cvt_pk_bf16_f32 v72, v42, v43
    v_lshlrev_b32 v42, 16, v72
    v_and_b32 v43, 0xffff0000, v72
    v_mul_f32 v42, s45, v42
    v_mul_f32 v43, s45, v43
    v_cvt_pk_bf16_f32 v72, v42, v43
    v_lshlrev_b32 v42, 16, v72
    v_and_b32 v43, 0xffff0000, v72

    v_cvt_pk_bf16_f32 v72, v44, v45
    v_lshlrev_b32 v44, 16, v72
    v_and_b32 v45, 0xffff0000, v72
    v_mul_f32 v44, s45, v44
    v_mul_f32 v45, s45, v45
    v_cvt_pk_bf16_f32 v72, v44, v45
    v_lshlrev_b32 v44, 16, v72
    v_and_b32 v45, 0xffff0000, v72

    v_cvt_pk_bf16_f32 v72, v46, v47
    v_lshlrev_b32 v46, 16, v72
    v_and_b32 v47, 0xffff0000, v72
    v_mul_f32 v46, s45, v46
    v_mul_f32 v47, s45, v47
    v_cvt_pk_bf16_f32 v72, v46, v47
    v_lshlrev_b32 v46, 16, v72
    v_and_b32 v47, 0xffff0000, v72

    v_cvt_pk_bf16_f32 v72, v48, v49
    v_lshlrev_b32 v48, 16, v72
    v_and_b32 v49, 0xffff0000, v72
    v_mul_f32 v48, s45, v48
    v_mul_f32 v49, s45, v49
    v_cvt_pk_bf16_f32 v72, v48, v49
    v_lshlrev_b32 v48, 16, v72
    v_and_b32 v49, 0xffff0000, v72

    v_cvt_pk_bf16_f32 v72, v50, v51
    v_lshlrev_b32 v50, 16, v72
    v_and_b32 v51, 0xffff0000, v72
    v_mul_f32 v50, s45, v50
    v_mul_f32 v51, s45, v51
    v_cvt_pk_bf16_f32 v72, v50, v51
    v_lshlrev_b32 v50, 16, v72
    v_and_b32 v51, 0xffff0000, v72

    v_mov_b32 v73, 0xff800000
    v_cndmask_b32 v40, v73, v40, s[46:47]
    v_cndmask_b32 v41, v73, v41, s[46:47]
    v_cndmask_b32 v42, v73, v42, s[46:47]
    v_cndmask_b32 v43, v73, v43, s[46:47]
    v_max3_f32 v72, v40, v41, v42
    v_max3_f32 v72, v72, v43, v44
    v_max3_f32 v72, v72, v45, v46
    v_max3_f32 v72, v72, v47, v48
    v_max3_f32 v72, v72, v49, v50
    v_max_f32 v72, v72, v51
    v_mov_b32 v73, v72
    s_nop 1
    v_permlane32_swap_b32 v72, v73
    s_nop 1
    v_max_f32 v72, v72, v73
    v_mov_b32 v73, v72
    s_nop 1
    v_permlane16_swap_b32 v72, v73
    s_nop 1
    v_max_f32 v72, v72, v73

    v_sub_f32 v40, v40, v72
    v_mul_f32 v40, s44, v40
    v_exp_f32 v40, v40

    v_sub_f32 v41, v41, v72
    v_mul_f32 v41, s44, v41
    v_exp_f32 v41, v41

    v_sub_f32 v42, v42, v72
    v_mul_f32 v42, s44, v42
    v_exp_f32 v42, v42

    v_sub_f32 v43, v43, v72
    v_mul_f32 v43, s44, v43
    v_exp_f32 v43, v43

    v_sub_f32 v44, v44, v72
    v_mul_f32 v44, s44, v44
    v_exp_f32 v44, v44

    v_sub_f32 v45, v45, v72
    v_mul_f32 v45, s44, v45
    v_exp_f32 v45, v45

    v_sub_f32 v46, v46, v72
    v_mul_f32 v46, s44, v46
    v_exp_f32 v46, v46

    v_sub_f32 v47, v47, v72
    v_mul_f32 v47, s44, v47
    v_exp_f32 v47, v47

    v_sub_f32 v48, v48, v72
    v_mul_f32 v48, s44, v48
    v_exp_f32 v48, v48

    v_sub_f32 v49, v49, v72
    v_mul_f32 v49, s44, v49
    v_exp_f32 v49, v49

    v_sub_f32 v50, v50, v72
    v_mul_f32 v50, s44, v50
    v_exp_f32 v50, v50

    v_sub_f32 v51, v51, v72
    v_mul_f32 v51, s44, v51
    v_exp_f32 v51, v51

    s_nop 0
    v_add_f32 v72, v40, v41
    v_add_f32 v72, v72, v42
    v_add_f32 v72, v72, v43
    v_add_f32 v72, v72, v44
    v_add_f32 v72, v72, v45
    v_add_f32 v72, v72, v46
    v_add_f32 v72, v72, v47
    v_add_f32 v72, v72, v48
    v_add_f32 v72, v72, v49
    v_add_f32 v72, v72, v50
    v_add_f32 v72, v72, v51
    v_mov_b32 v73, v72
    s_nop 1
    v_permlane32_swap_b32 v72, v73
    s_nop 1
    v_add_f32 v72, v72, v73
    v_mov_b32 v73, v72
    s_nop 1
    v_permlane16_swap_b32 v72, v73
    s_nop 1
    v_add_f32 v72, v72, v73
    v_rcp_f32 v72, v72
    s_nop 0

    v_mul_f32 v40, v40, v72
    v_mul_f32 v41, v41, v72
    v_mul_f32 v42, v42, v72
    v_mul_f32 v43, v43, v72
    v_mul_f32 v44, v44, v72
    v_mul_f32 v45, v45, v72
    v_mul_f32 v46, v46, v72
    v_mul_f32 v47, v47, v72
    v_mul_f32 v48, v48, v72
    v_mul_f32 v49, v49, v72
    v_mul_f32 v50, v50, v72
    v_mul_f32 v51, v51, v72
    v_cvt_pk_bf16_f32 v64, v40, v41
    v_cvt_pk_bf16_f32 v65, v42, v43
    v_cvt_pk_bf16_f32 v66, v44, v45
    v_cvt_pk_bf16_f32 v67, v46, v47
    v_cvt_pk_bf16_f32 v68, v48, v49
    v_cvt_pk_bf16_f32 v69, v50, v51
    v_mov_b32 v70, 0
    v_mov_b32 v71, 0
    s_nop 1
    v_mfma_f32_16x16x32_bf16 v[40:43], v[24:27], v[64:67], 0
    v_mfma_f32_16x16x32_bf16 v[44:47], v[32:35], v[64:67], 0
    v_mfma_f32_16x16x32_bf16 v[40:43], v[28:31], v[68:71], v[40:43]
    v_mfma_f32_16x16x32_bf16 v[44:47], v[36:39], v[68:71], v[44:47]
    s_nop 7
    s_nop 1
    v_cvt_pk_bf16_f32 v72, v40, v41
    v_cvt_pk_bf16_f32 v73, v42, v43
    v_cvt_pk_bf16_f32 v74, v44, v45
    v_cvt_pk_bf16_f32 v75, v46, v47
    s_lshl_b32 s24, s21, 10
    s_add_u32 s24, s24, 147456
    v_add_u32 v76, s24, v11
    ds_write_b128 v76, v[72:75]

    s_waitcnt lgkmcnt(0)
    s_barrier
    ds_read_b128 v[40:43], v0 offset:0
    ds_read_b128 v[44:47], v0 offset:1024
    ds_read_b128 v[48:51], v0 offset:2048
    ds_read_b128 v[52:55], v0 offset:3072
    s_add_u32 s24, s20, 1
    s_mul_i32 s24, s24, 36864
    s_add_u32 s24, s24, 32768
    s_and_b32 s25, s2, 1
    s_mul_i32 s25, s25, 18432
    s_add_u32 s24, s24, s25
    s_add_u32 s25, s24, 2304
    s_add_u32 s26, s24, 4608
    s_add_u32 s27, s24, 6912

    ds_read_b128 v[56:59], v3 offset:0
    ds_read_b128 v[60:63], v3 offset:1024
    ds_read_b128 v[64:67], v3 offset:2048
    ds_read_b128 v[68:71], v3 offset:3072
    s_waitcnt lgkmcnt(3)
    v_mfma_f32_16x16x32_bf16 v[72:75], v[40:43], v[56:59], 0
    ds_read_b128 v[56:59], v3 offset:4096
    s_waitcnt lgkmcnt(3)
    v_mfma_f32_16x16x32_bf16 v[72:75], v[44:47], v[60:63], v[72:75]
    ds_read_b128 v[60:63], v3 offset:5120
    s_waitcnt lgkmcnt(3)
    v_mfma_f32_16x16x32_bf16 v[72:75], v[48:51], v[64:67], v[72:75]
    ds_read_b128 v[64:67], v3 offset:6144
    s_waitcnt lgkmcnt(3)
    v_mfma_f32_16x16x32_bf16 v[72:75], v[52:55], v[68:71], v[72:75]
    ds_read_b128 v[68:71], v3 offset:7168
    s_waitcnt lgkmcnt(3)
    v_mfma_f32_16x16x32_bf16 v[76:79], v[40:43], v[56:59], 0
    ds_read_b128 v[56:59], v3 offset:8192
    s_waitcnt lgkmcnt(3)
    v_mfma_f32_16x16x32_bf16 v[76:79], v[44:47], v[60:63], v[76:79]
    s_nop 2
    s_mov_b64 exec, s[46:47]
    buffer_atomic_add_f32 v72, v12, s[8:11], s24 offen offset:0
    buffer_atomic_add_f32 v73, v12, s[8:11], s25 offen offset:0
    buffer_atomic_add_f32 v74, v12, s[8:11], s26 offen offset:0
    buffer_atomic_add_f32 v75, v12, s[8:11], s27 offen offset:0
    s_mov_b64 exec, s[50:51]
    ds_read_b128 v[60:63], v3 offset:9216
    s_waitcnt lgkmcnt(3)
    v_mfma_f32_16x16x32_bf16 v[76:79], v[48:51], v[64:67], v[76:79]
    ds_read_b128 v[64:67], v3 offset:10240
    s_waitcnt lgkmcnt(3)
    v_mfma_f32_16x16x32_bf16 v[76:79], v[52:55], v[68:71], v[76:79]
    ds_read_b128 v[68:71], v3 offset:11264
    s_waitcnt lgkmcnt(3)
    v_mfma_f32_16x16x32_bf16 v[72:75], v[40:43], v[56:59], 0
    ds_read_b128 v[56:59], v3 offset:12288
    s_waitcnt lgkmcnt(3)
    v_mfma_f32_16x16x32_bf16 v[72:75], v[44:47], v[60:63], v[72:75]
    s_nop 2
    s_mov_b64 exec, s[46:47]
    buffer_atomic_add_f32 v76, v12, s[8:11], s24 offen offset:64
    buffer_atomic_add_f32 v77, v12, s[8:11], s25 offen offset:64
    buffer_atomic_add_f32 v78, v12, s[8:11], s26 offen offset:64
    buffer_atomic_add_f32 v79, v12, s[8:11], s27 offen offset:64
    s_mov_b64 exec, s[50:51]
    ds_read_b128 v[60:63], v3 offset:13312
    s_waitcnt lgkmcnt(3)
    v_mfma_f32_16x16x32_bf16 v[72:75], v[48:51], v[64:67], v[72:75]
    ds_read_b128 v[64:67], v3 offset:14336
    s_waitcnt lgkmcnt(3)
    v_mfma_f32_16x16x32_bf16 v[72:75], v[52:55], v[68:71], v[72:75]
    ds_read_b128 v[68:71], v3 offset:15360
    s_waitcnt lgkmcnt(3)
    v_mfma_f32_16x16x32_bf16 v[76:79], v[40:43], v[56:59], 0
    ds_read_b128 v[56:59], v3 offset:16384
    s_waitcnt lgkmcnt(3)
    v_mfma_f32_16x16x32_bf16 v[76:79], v[44:47], v[60:63], v[76:79]
    s_nop 2
    s_mov_b64 exec, s[46:47]
    buffer_atomic_add_f32 v72, v12, s[8:11], s24 offen offset:128
    buffer_atomic_add_f32 v73, v12, s[8:11], s25 offen offset:128
    buffer_atomic_add_f32 v74, v12, s[8:11], s26 offen offset:128
    buffer_atomic_add_f32 v75, v12, s[8:11], s27 offen offset:128
    s_mov_b64 exec, s[50:51]
    ds_read_b128 v[60:63], v3 offset:17408
    s_waitcnt lgkmcnt(3)
    v_mfma_f32_16x16x32_bf16 v[76:79], v[48:51], v[64:67], v[76:79]
    ds_read_b128 v[64:67], v3 offset:18432
    s_waitcnt lgkmcnt(3)
    v_mfma_f32_16x16x32_bf16 v[76:79], v[52:55], v[68:71], v[76:79]
    ds_read_b128 v[68:71], v3 offset:19456
    s_waitcnt lgkmcnt(3)
    v_mfma_f32_16x16x32_bf16 v[72:75], v[40:43], v[56:59], 0
    ds_read_b128 v[56:59], v3 offset:20480
    s_waitcnt lgkmcnt(3)
    v_mfma_f32_16x16x32_bf16 v[72:75], v[44:47], v[60:63], v[72:75]
    s_nop 2
    s_mov_b64 exec, s[46:47]
    buffer_atomic_add_f32 v76, v12, s[8:11], s24 offen offset:192
    buffer_atomic_add_f32 v77, v12, s[8:11], s25 offen offset:192
    buffer_atomic_add_f32 v78, v12, s[8:11], s26 offen offset:192
    buffer_atomic_add_f32 v79, v12, s[8:11], s27 offen offset:192
    s_mov_b64 exec, s[50:51]
    ds_read_b128 v[60:63], v3 offset:21504
    s_waitcnt lgkmcnt(3)
    v_mfma_f32_16x16x32_bf16 v[72:75], v[48:51], v[64:67], v[72:75]
    ds_read_b128 v[64:67], v3 offset:22528
    s_waitcnt lgkmcnt(3)
    v_mfma_f32_16x16x32_bf16 v[72:75], v[52:55], v[68:71], v[72:75]
    ds_read_b128 v[68:71], v3 offset:23552
    s_waitcnt lgkmcnt(3)
    v_mfma_f32_16x16x32_bf16 v[76:79], v[40:43], v[56:59], 0
    ds_read_b128 v[56:59], v3 offset:24576
    s_waitcnt lgkmcnt(3)
    v_mfma_f32_16x16x32_bf16 v[76:79], v[44:47], v[60:63], v[76:79]
    s_nop 2
    s_mov_b64 exec, s[46:47]
    buffer_atomic_add_f32 v72, v12, s[8:11], s24 offen offset:256
    buffer_atomic_add_f32 v73, v12, s[8:11], s25 offen offset:256
    buffer_atomic_add_f32 v74, v12, s[8:11], s26 offen offset:256
    buffer_atomic_add_f32 v75, v12, s[8:11], s27 offen offset:256
    s_mov_b64 exec, s[50:51]
    ds_read_b128 v[60:63], v3 offset:25600
    s_waitcnt lgkmcnt(3)
    v_mfma_f32_16x16x32_bf16 v[76:79], v[48:51], v[64:67], v[76:79]
    ds_read_b128 v[64:67], v3 offset:26624
    s_waitcnt lgkmcnt(3)
    v_mfma_f32_16x16x32_bf16 v[76:79], v[52:55], v[68:71], v[76:79]
    ds_read_b128 v[68:71], v3 offset:27648
    s_waitcnt lgkmcnt(3)
    v_mfma_f32_16x16x32_bf16 v[72:75], v[40:43], v[56:59], 0
    ds_read_b128 v[56:59], v3 offset:28672
    s_waitcnt lgkmcnt(3)
    v_mfma_f32_16x16x32_bf16 v[72:75], v[44:47], v[60:63], v[72:75]
    s_nop 2
    s_mov_b64 exec, s[46:47]
    buffer_atomic_add_f32 v76, v12, s[8:11], s24 offen offset:320
    buffer_atomic_add_f32 v77, v12, s[8:11], s25 offen offset:320
    buffer_atomic_add_f32 v78, v12, s[8:11], s26 offen offset:320
    buffer_atomic_add_f32 v79, v12, s[8:11], s27 offen offset:320
    s_mov_b64 exec, s[50:51]
    ds_read_b128 v[60:63], v3 offset:29696
    s_waitcnt lgkmcnt(3)
    v_mfma_f32_16x16x32_bf16 v[72:75], v[48:51], v[64:67], v[72:75]
    ds_read_b128 v[64:67], v3 offset:30720
    s_waitcnt lgkmcnt(3)
    v_mfma_f32_16x16x32_bf16 v[72:75], v[52:55], v[68:71], v[72:75]
    ds_read_b128 v[68:71], v3 offset:31744
    s_waitcnt lgkmcnt(3)
    v_mfma_f32_16x16x32_bf16 v[76:79], v[40:43], v[56:59], 0
    ds_read_b128 v[56:59], v3 offset:32768
    s_waitcnt lgkmcnt(3)
    v_mfma_f32_16x16x32_bf16 v[76:79], v[44:47], v[60:63], v[76:79]
    s_nop 2
    s_mov_b64 exec, s[46:47]
    buffer_atomic_add_f32 v72, v12, s[8:11], s24 offen offset:384
    buffer_atomic_add_f32 v73, v12, s[8:11], s25 offen offset:384
    buffer_atomic_add_f32 v74, v12, s[8:11], s26 offen offset:384
    buffer_atomic_add_f32 v75, v12, s[8:11], s27 offen offset:384
    s_mov_b64 exec, s[50:51]
    ds_read_b128 v[60:63], v3 offset:33792
    s_waitcnt lgkmcnt(3)
    v_mfma_f32_16x16x32_bf16 v[76:79], v[48:51], v[64:67], v[76:79]
    ds_read_b128 v[64:67], v3 offset:34816
    s_waitcnt lgkmcnt(3)
    v_mfma_f32_16x16x32_bf16 v[76:79], v[52:55], v[68:71], v[76:79]
    ds_read_b128 v[68:71], v3 offset:35840
    s_waitcnt lgkmcnt(3)
    v_mfma_f32_16x16x32_bf16 v[72:75], v[40:43], v[56:59], 0
    s_waitcnt lgkmcnt(2)
    v_mfma_f32_16x16x32_bf16 v[72:75], v[44:47], v[60:63], v[72:75]
    s_nop 2
    s_mov_b64 exec, s[46:47]
    buffer_atomic_add_f32 v76, v12, s[8:11], s24 offen offset:448
    buffer_atomic_add_f32 v77, v12, s[8:11], s25 offen offset:448
    buffer_atomic_add_f32 v78, v12, s[8:11], s26 offen offset:448
    buffer_atomic_add_f32 v79, v12, s[8:11], s27 offen offset:448
    s_mov_b64 exec, s[50:51]
    s_waitcnt lgkmcnt(1)
    v_mfma_f32_16x16x32_bf16 v[72:75], v[48:51], v[64:67], v[72:75]
    s_waitcnt lgkmcnt(0)
    v_mfma_f32_16x16x32_bf16 v[72:75], v[52:55], v[68:71], v[72:75]
    s_nop 7
    s_nop 1
    s_mov_b64 exec, s[46:47]
    buffer_atomic_add_f32 v72, v12, s[8:11], s24 offen offset:512
    buffer_atomic_add_f32 v73, v12, s[8:11], s25 offen offset:512
    buffer_atomic_add_f32 v74, v12, s[8:11], s26 offen offset:512
    buffer_atomic_add_f32 v75, v12, s[8:11], s27 offen offset:512
    s_mov_b64 exec, s[50:51]
    s_waitcnt vmcnt(0)
    s_barrier
    s_cmp_lg_u32 s21, 0
    s_cbranch_scc1 chain_kernel_nocnt6
    s_add_u32 s24, s20, 1
    s_lshl_b32 s24, s24, 8
    s_add_u32 s24, s24, 16384
    v_mov_b32 v72, 0
    v_mov_b32 v73, 1
    s_mov_b64 exec, 1
    buffer_atomic_add v73, v72, s[8:11], s24 offen
    s_mov_b64 exec, s[50:51]

chain_kernel_nocnt6:
    s_add_u32 s20, s20, 1
    s_branch chain_loop

chain_kernel_last5:
    s_waitcnt vmcnt(0)
chain_kernel_end:
    s_endpgm
.section .rodata,"a"
.p2align 6
.amdhsa_kernel chain_kernel
  .amdhsa_next_free_vgpr 512
  .amdhsa_next_free_sgpr 72
  .amdhsa_accum_offset 256
  .amdhsa_group_segment_fixed_size 0
  .amdhsa_kernarg_size 128
  .amdhsa_user_sgpr_count 2
  .amdhsa_user_sgpr_kernarg_segment_ptr 1
  .amdhsa_system_sgpr_workgroup_id_x 1
.end_amdhsa_kernel
.text
.p2align 8
.globl attn_kernel
.type attn_kernel,@function
attn_kernel:
    s_cmp_ge_u32 s2, 512
    s_cbranch_scc1 attn_kernel_end
    s_load_dwordx2 s[4:5], s[0:1], 120
    v_and_b32 v1, 15, v0
    v_bfe_u32 v2, v0, 4, 2
    v_lshrrev_b32 v3, 6, v0
    s_nop 0
    v_readfirstlane_b32 s21, v3
    s_lshr_b32 s22, s2, 3
    s_and_b32 s23, s2, 7
    s_lshl_b32 s23, s23, 2
    s_waitcnt lgkmcnt(0)
    s_add_u32 s23, s23, s21

    s_mov_b32 s8, s4
    s_mov_b32 s9, s5
    s_mov_b32 s10, 103841792
    s_mov_b32 s11, 0x00020000
    s_lshl_b32 s24, s22, 18
    s_lshl_b32 s25, s23, 8
    s_add_u32 s24, s24, s25
    s_add_u32 s26, s24, 21528576
    s_add_u32 s24, s24, 4751360
    s_lshl_b32 s25, s22, 5
    s_add_u32 s25, s25, s23
    s_lshl_b32 s27, s25, 11
    s_add_u32 s28, s27, 59277312
    s_add_u32 s27, s27, 55083008
    s_lshl_b32 s29, s25, 13
    s_add_u32 s29, s29, 38305792
    v_lshlrev_b32 v4, 13, v1
    v_lshl_add_u32 v4, v2, 4, v4
    v_and_b32 v5, 7, v0
    v_lshlrev_b32 v5, 8, v5
    v_lshl_add_u32 v5, v2, 4, v5
    v_lshlrev_b32 v6, 6, v1
    v_lshl_add_u32 v6, v2, 3, v6
    v_and_b32 v7, 1, v2
    v_lshlrev_b32 v7, 3, v7
    v_lshl_add_u32 v7, v1, 4, v7
    s_add_u32 s30, s24, 131072
    s_add_u32 s31, s26, 131072

    buffer_load_dwordx4 v[16:19], v4, s[8:11], s24 offen offset:0
    buffer_load_dwordx4 v[20:23], v4, s[8:11], s24 offen offset:64
    buffer_load_dwordx4 v[24:27], v4, s[8:11], s24 offen offset:128
    buffer_load_dwordx4 v[28:31], v4, s[8:11], s24 offen offset:192
    buffer_load_dwordx4 v[32:35], v4, s[8:11], s30 offen offset:0
    buffer_load_dwordx4 v[36:39], v4, s[8:11], s30 offen offset:64
    buffer_load_dwordx4 v[40:43], v4, s[8:11], s30 offen offset:128
    buffer_load_dwordx4 v[44:47], v4, s[8:11], s30 offen offset:192
    buffer_load_dwordx4 v[48:51], v5, s[8:11], s27 offen offset:0
    buffer_load_dwordx4 v[52:55], v5, s[8:11], s27 offen offset:64
    buffer_load_dwordx4 v[56:59], v5, s[8:11], s27 offen offset:128
    buffer_load_dwordx4 v[60:63], v5, s[8:11], s27 offen offset:192
    buffer_load_dwordx4 v[64:67], v4, s[8:11], s26 offen offset:0
    buffer_load_dwordx4 v[68:71], v4, s[8:11], s26 offen offset:64
    buffer_load_dwordx4 v[72:75], v4, s[8:11], s26 offen offset:128
    buffer_load_dwordx4 v[76:79], v4, s[8:11], s26 offen offset:192
    buffer_load_dwordx4 v[80:83], v4, s[8:11], s31 offen offset:0
    buffer_load_dwordx4 v[84:87], v4, s[8:11], s31 offen offset:64
    buffer_load_dwordx4 v[88:91], v4, s[8:11], s31 offen offset:128
    buffer_load_dwordx4 v[92:95], v4, s[8:11], s31 offen offset:192
    buffer_load_dwordx2 v[96:97], v7, s[8:11], s28 offen offset:0
    buffer_load_dwordx2 v[98:99], v6, s[8:11], s29 offen offset:0
    buffer_load_dwordx2 v[100:101], v6, s[8:11], s29 offen offset:32
    v_mov_b32 v102, 0
    v_mov_b32 v103, 0
    buffer_load_dwordx2 v[104:105], v7, s[8:11], s28 offen offset:256
    buffer_load_dwordx2 v[106:107], v6, s[8:11], s29 offen offset:1024
    buffer_load_dwordx2 v[108:109], v6, s[8:11], s29 offen offset:1056
    v_mov_b32 v110, 0
    v_mov_b32 v111, 0
    buffer_load_dwordx2 v[112:113], v7, s[8:11], s28 offen offset:512
    buffer_load_dwordx2 v[114:115], v6, s[8:11], s29 offen offset:2048
    buffer_load_dwordx2 v[116:117], v6, s[8:11], s29 offen offset:2080
    v_mov_b32 v118, 0
    v_mov_b32 v119, 0
    buffer_load_dwordx2 v[120:121], v7, s[8:11], s28 offen offset:768
    buffer_load_dwordx2 v[122:123], v6, s[8:11], s29 offen offset:3072
    buffer_load_dwordx2 v[124:125], v6, s[8:11], s29 offen offset:3104
    v_mov_b32 v126, 0
    v_mov_b32 v127, 0
    buffer_load_dwordx2 v[128:129], v7, s[8:11], s28 offen offset:1024
    v_add_u32 v6, 4096, v6
    buffer_load_dwordx2 v[130:131], v6, s[8:11], s29 offen offset:0
    buffer_load_dwordx2 v[132:133], v6, s[8:11], s29 offen offset:32
    v_mov_b32 v134, 0
    v_mov_b32 v135, 0
    buffer_load_dwordx2 v[136:137], v7, s[8:11], s28 offen offset:1280
    buffer_load_dwordx2 v[138:139], v6, s[8:11], s29 offen offset:1024
    buffer_load_dwordx2 v[140:141], v6, s[8:11], s29 offen offset:1056
    v_mov_b32 v142, 0
    v_mov_b32 v143, 0
    buffer_load_dwordx2 v[144:145], v7, s[8:11], s28 offen offset:1536
    buffer_load_dwordx2 v[146:147], v6, s[8:11], s29 offen offset:2048
    buffer_load_dwordx2 v[148:149], v6, s[8:11], s29 offen offset:2080
    v_mov_b32 v150, 0
    v_mov_b32 v151, 0
    buffer_load_dwordx2 v[152:153], v7, s[8:11], s28 offen offset:1792
    buffer_load_dwordx2 v[154:155], v6, s[8:11], s29 offen offset:3072
    buffer_load_dwordx2 v[156:157], v6, s[8:11], s29 offen offset:3104
    v_mov_b32 v158, 0
    v_mov_b32 v159, 0
    s_waitcnt vmcnt(24)
    v_mfma_f32_16x16x32_bf16 v[160:163], v[48:51], v[16:19], 0
    v_mfma_f32_16x16x32_bf16 v[160:163], v[52:55], v[20:23], v[160:163]
    v_mfma_f32_16x16x32_bf16 v[160:163], v[56:59], v[24:27], v[160:163]
    v_mfma_f32_16x16x32_bf16 v[160:163], v[60:63], v[28:31], v[160:163]
    v_mfma_f32_16x16x32_bf16 v[164:167], v[64:67], v[16:19], 0
    v_mfma_f32_16x16x32_bf16 v[164:167], v[68:71], v[20:23], v[164:167]
    v_mfma_f32_16x16x32_bf16 v[164:167], v[72:75], v[24:27], v[164:167]
    v_mfma_f32_16x16x32_bf16 v[164:167], v[76:79], v[28:31], v[164:167]
    v_mfma_f32_16x16x32_bf16 v[168:171], v[80:83], v[16:19], 0
    v_mfma_f32_16x16x32_bf16 v[168:171], v[84:87], v[20:23], v[168:171]
    v_mfma_f32_16x16x32_bf16 v[168:171], v[88:91], v[24:27], v[168:171]
    v_mfma_f32_16x16x32_bf16 v[168:171], v[92:95], v[28:31], v[168:171]
    v_mfma_f32_16x16x32_bf16 v[172:175], v[48:51], v[32:35], 0
    v_mfma_f32_16x16x32_bf16 v[172:175], v[52:55], v[36:39], v[172:175]
    v_mfma_f32_16x16x32_bf16 v[172:175], v[56:59], v[40:43], v[172:175]
    v_mfma_f32_16x16x32_bf16 v[172:175], v[60:63], v[44:47], v[172:175]
    v_mfma_f32_16x16x32_bf16 v[176:179], v[64:67], v[32:35], 0
    v_mfma_f32_16x16x32_bf16 v[176:179], v[68:71], v[36:39], v[176:179]
    v_mfma_f32_16x16x32_bf16 v[176:179], v[72:75], v[40:43], v[176:179]
    v_mfma_f32_16x16x32_bf16 v[176:179], v[76:79], v[44:47], v[176:179]
    v_mfma_f32_16x16x32_bf16 v[180:183], v[80:83], v[32:35], 0
    v_mfma_f32_16x16x32_bf16 v[180:183], v[84:87], v[36:39], v[180:183]
    v_mfma_f32_16x16x32_bf16 v[180:183], v[88:91], v[40:43], v[180:183]
    v_mfma_f32_16x16x32_bf16 v[180:183], v[92:95], v[44:47], v[180:183]
    s_nop 7
    s_nop 1
    s_mov_b32 s44, 0x3fb8aa3b
    s_mov_b32 s45, 0x3db504f3
    v_mov_b32 v8, 0xce6e6b28
    v_lshlrev_b32 v9, 2, v2

    v_cvt_pk_bf16_f32 v200, v160, v161
    v_lshlrev_b32 v160, 16, v200
    v_and_b32 v161, 0xffff0000, v200
    v_mul_f32 v160, s45, v160
    v_mul_f32 v161, s45, v161
    v_cvt_pk_bf16_f32 v200, v160, v161
    v_lshlrev_b32 v160, 16, v200
    v_and_b32 v161, 0xffff0000, v200

    v_cvt_pk_bf16_f32 v200, v162, v163
    v_lshlrev_b32 v162, 16, v200
    v_and_b32 v163, 0xffff0000, v200
    v_mul_f32 v162, s45, v162
    v_mul_f32 v163, s45, v163
    v_cvt_pk_bf16_f32 v200, v162, v163
    v_lshlrev_b32 v162, 16, v200
    v_and_b32 v163, 0xffff0000, v200

    v_cvt_pk_bf16_f32 v200, v164, v165
    v_lshlrev_b32 v164, 16, v200
    v_and_b32 v165, 0xffff0000, v200
    v_mul_f32 v164, s45, v164
    v_mul_f32 v165, s45, v165
    v_cvt_pk_bf16_f32 v200, v164, v165
    v_lshlrev_b32 v164, 16, v200
    v_and_b32 v165, 0xffff0000, v200

    v_cvt_pk_bf16_f32 v200, v166, v167
    v_lshlrev_b32 v166, 16, v200
    v_and_b32 v167, 0xffff0000, v200
    v_mul_f32 v166, s45, v166
    v_mul_f32 v167, s45, v167
    v_cvt_pk_bf16_f32 v200, v166, v167
    v_lshlrev_b32 v166, 16, v200
    v_and_b32 v167, 0xffff0000, v200

    v_cvt_pk_bf16_f32 v200, v168, v169
    v_lshlrev_b32 v168, 16, v200
    v_and_b32 v169, 0xffff0000, v200
    v_mul_f32 v168, s45, v168
    v_mul_f32 v169, s45, v169
    v_cvt_pk_bf16_f32 v200, v168, v169
    v_lshlrev_b32 v168, 16, v200
    v_and_b32 v169, 0xffff0000, v200

    v_cvt_pk_bf16_f32 v200, v170, v171
    v_lshlrev_b32 v170, 16, v200
    v_and_b32 v171, 0xffff0000, v200
    v_mul_f32 v170, s45, v170
    v_mul_f32 v171, s45, v171
    v_cvt_pk_bf16_f32 v200, v170, v171
    v_lshlrev_b32 v170, 16, v200
    v_and_b32 v171, 0xffff0000, v200

    v_cmp_gt_u32 vcc, 2, v2
    v_mov_b32 v10, 0xff800000
    s_nop 1
    v_cndmask_b32 v160, v10, v160, vcc
    v_cndmask_b32 v161, v10, v161, vcc
    v_cndmask_b32 v162, v10, v162, vcc
    v_cndmask_b32 v163, v10, v163, vcc
    v_add_u32 v10, 0, v9
    v_cmp_le_i32 vcc, v10, v1
    s_nop 1
    v_cndmask_b32 v164, v8, v164, vcc
    v_add_u32 v10, 1, v9
    v_cmp_le_i32 vcc, v10, v1
    s_nop 1
    v_cndmask_b32 v165, v8, v165, vcc
    v_add_u32 v10, 2, v9
    v_cmp_le_i32 vcc, v10, v1
    s_nop 1
    v_cndmask_b32 v166, v8, v166, vcc
    v_add_u32 v10, 3, v9
    v_cmp_le_i32 vcc, v10, v1
    s_nop 1
    v_cndmask_b32 v167, v8, v167, vcc
    v_add_u32 v10, 16, v9
    v_cmp_le_i32 vcc, v10, v1
    s_nop 1
    v_cndmask_b32 v168, v8, v168, vcc
    v_add_u32 v10, 17, v9
    v_cmp_le_i32 vcc, v10, v1
    s_nop 1
    v_cndmask_b32 v169, v8, v169, vcc
    v_add_u32 v10, 18, v9
    v_cmp_le_i32 vcc, v10, v1
    s_nop 1
    v_cndmask_b32 v170, v8, v170, vcc
    v_add_u32 v10, 19, v9
    v_cmp_le_i32 vcc, v10, v1
    s_nop 1
    v_cndmask_b32 v171, v8, v171, vcc
    v_max3_f32 v200, v160, v161, v162
    v_max3_f32 v200, v200, v163, v164
    v_max3_f32 v200, v200, v165, v166
    v_max3_f32 v200, v200, v167, v168
    v_max3_f32 v200, v200, v169, v170
    v_max_f32 v200, v200, v171
    v_mov_b32 v201, v200
    s_nop 1
    v_permlane32_swap_b32 v200, v201
    s_nop 1
    v_max_f32 v200, v200, v201
    v_mov_b32 v201, v200
    s_nop 1
    v_permlane16_swap_b32 v200, v201
    s_nop 1
    v_max_f32 v200, v200, v201

    v_sub_f32 v160, v160, v200
    v_mul_f32 v160, s44, v160
    v_exp_f32 v160, v160

    v_sub_f32 v161, v161, v200
    v_mul_f32 v161, s44, v161
    v_exp_f32 v161, v161

    v_sub_f32 v162, v162, v200
    v_mul_f32 v162, s44, v162
    v_exp_f32 v162, v162

    v_sub_f32 v163, v163, v200
    v_mul_f32 v163, s44, v163
    v_exp_f32 v163, v163

    v_sub_f32 v164, v164, v200
    v_mul_f32 v164, s44, v164
    v_exp_f32 v164, v164

    v_sub_f32 v165, v165, v200
    v_mul_f32 v165, s44, v165
    v_exp_f32 v165, v165

    v_sub_f32 v166, v166, v200
    v_mul_f32 v166, s44, v166
    v_exp_f32 v166, v166

    v_sub_f32 v167, v167, v200
    v_mul_f32 v167, s44, v167
    v_exp_f32 v167, v167

    v_sub_f32 v168, v168, v200
    v_mul_f32 v168, s44, v168
    v_exp_f32 v168, v168

    v_sub_f32 v169, v169, v200
    v_mul_f32 v169, s44, v169
    v_exp_f32 v169, v169

    v_sub_f32 v170, v170, v200
    v_mul_f32 v170, s44, v170
    v_exp_f32 v170, v170

    v_sub_f32 v171, v171, v200
    v_mul_f32 v171, s44, v171
    v_exp_f32 v171, v171

    s_nop 0
    v_add_f32 v200, v160, v161
    v_add_f32 v200, v200, v162
    v_add_f32 v200, v200, v163
    v_add_f32 v200, v200, v164
    v_add_f32 v200, v200, v165
    v_add_f32 v200, v200, v166
    v_add_f32 v200, v200, v167
    v_add_f32 v200, v200, v168
    v_add_f32 v200, v200, v169
    v_add_f32 v200, v200, v170
    v_add_f32 v200, v200, v171
    v_mov_b32 v201, v200
    s_nop 1
    v_permlane32_swap_b32 v200, v201
    s_nop 1
    v_add_f32 v200, v200, v201
    v_mov_b32 v201, v200
    s_nop 1
    v_permlane16_swap_b32 v200, v201
    s_nop 1
    v_add_f32 v200, v200, v201
    v_rcp_f32 v200, v200
    s_nop 0

    v_mul_f32 v160, v160, v200
    v_mul_f32 v161, v161, v200
    v_mul_f32 v162, v162, v200
    v_mul_f32 v163, v163, v200
    v_mul_f32 v164, v164, v200
    v_mul_f32 v165, v165, v200
    v_mul_f32 v166, v166, v200
    v_mul_f32 v167, v167, v200
    v_mul_f32 v168, v168, v200
    v_mul_f32 v169, v169, v200
    v_mul_f32 v170, v170, v200
    v_mul_f32 v171, v171, v200
    v_cvt_pk_bf16_f32 v208, v160, v161
    v_cvt_pk_bf16_f32 v209, v162, v163
    v_cvt_pk_bf16_f32 v210, v164, v165
    v_cvt_pk_bf16_f32 v211, v166, v167
    v_cvt_pk_bf16_f32 v212, v168, v169
    v_cvt_pk_bf16_f32 v213, v170, v171
    v_mov_b32 v214, 0
    v_mov_b32 v215, 0
    v_cvt_pk_bf16_f32 v200, v172, v173
    v_lshlrev_b32 v172, 16, v200
    v_and_b32 v173, 0xffff0000, v200
    v_mul_f32 v172, s45, v172
    v_mul_f32 v173, s45, v173
    v_cvt_pk_bf16_f32 v200, v172, v173
    v_lshlrev_b32 v172, 16, v200
    v_and_b32 v173, 0xffff0000, v200

    v_cvt_pk_bf16_f32 v200, v174, v175
    v_lshlrev_b32 v174, 16, v200
    v_and_b32 v175, 0xffff0000, v200
    v_mul_f32 v174, s45, v174
    v_mul_f32 v175, s45, v175
    v_cvt_pk_bf16_f32 v200, v174, v175
    v_lshlrev_b32 v174, 16, v200
    v_and_b32 v175, 0xffff0000, v200

    v_cvt_pk_bf16_f32 v200, v176, v177
    v_lshlrev_b32 v176, 16, v200
    v_and_b32 v177, 0xffff0000, v200
    v_mul_f32 v176, s45, v176
    v_mul_f32 v177, s45, v177
    v_cvt_pk_bf16_f32 v200, v176, v177
    v_lshlrev_b32 v176, 16, v200
    v_and_b32 v177, 0xffff0000, v200

    v_cvt_pk_bf16_f32 v200, v178, v179
    v_lshlrev_b32 v178, 16, v200
    v_and_b32 v179, 0xffff0000, v200
    v_mul_f32 v178, s45, v178
    v_mul_f32 v179, s45, v179
    v_cvt_pk_bf16_f32 v200, v178, v179
    v_lshlrev_b32 v178, 16, v200
    v_and_b32 v179, 0xffff0000, v200

    v_cvt_pk_bf16_f32 v200, v180, v181
    v_lshlrev_b32 v180, 16, v200
    v_and_b32 v181, 0xffff0000, v200
    v_mul_f32 v180, s45, v180
    v_mul_f32 v181, s45, v181
    v_cvt_pk_bf16_f32 v200, v180, v181
    v_lshlrev_b32 v180, 16, v200
    v_and_b32 v181, 0xffff0000, v200

    v_cvt_pk_bf16_f32 v200, v182, v183
    v_lshlrev_b32 v182, 16, v200
    v_and_b32 v183, 0xffff0000, v200
    v_mul_f32 v182, s45, v182
    v_mul_f32 v183, s45, v183
    v_cvt_pk_bf16_f32 v200, v182, v183
    v_lshlrev_b32 v182, 16, v200
    v_and_b32 v183, 0xffff0000, v200

    v_cmp_gt_u32 vcc, 2, v2
    v_mov_b32 v10, 0xff800000
    s_nop 1
    v_cndmask_b32 v172, v10, v172, vcc
    v_cndmask_b32 v173, v10, v173, vcc
    v_cndmask_b32 v174, v10, v174, vcc
    v_cndmask_b32 v175, v10, v175, vcc
    v_add_u32 v10, -16, v9
    v_cmp_le_i32 vcc, v10, v1
    s_nop 1
    v_cndmask_b32 v176, v8, v176, vcc
    v_add_u32 v10, -15, v9
    v_cmp_le_i32 vcc, v10, v1
    s_nop 1
    v_cndmask_b32 v177, v8, v177, vcc
    v_add_u32 v10, -14, v9
    v_cmp_le_i32 vcc, v10, v1
    s_nop 1
    v_cndmask_b32 v178, v8, v178, vcc
    v_add_u32 v10, -13, v9
    v_cmp_le_i32 vcc, v10, v1
    s_nop 1
    v_cndmask_b32 v179, v8, v179, vcc
    v_add_u32 v10, 0, v9
    v_cmp_le_i32 vcc, v10, v1
    s_nop 1
    v_cndmask_b32 v180, v8, v180, vcc
    v_add_u32 v10, 1, v9
    v_cmp_le_i32 vcc, v10, v1
    s_nop 1
    v_cndmask_b32 v181, v8, v181, vcc
    v_add_u32 v10, 2, v9
    v_cmp_le_i32 vcc, v10, v1
    s_nop 1
    v_cndmask_b32 v182, v8, v182, vcc
    v_add_u32 v10, 3, v9
    v_cmp_le_i32 vcc, v10, v1
    s_nop 1
    v_cndmask_b32 v183, v8, v183, vcc
    v_max3_f32 v200, v172, v173, v174
    v_max3_f32 v200, v200, v175, v176
    v_max3_f32 v200, v200, v177, v178
    v_max3_f32 v200, v200, v179, v180
    v_max3_f32 v200, v200, v181, v182
    v_max_f32 v200, v200, v183
    v_mov_b32 v201, v200
    s_nop 1
    v_permlane32_swap_b32 v200, v201
    s_nop 1
    v_max_f32 v200, v200, v201
    v_mov_b32 v201, v200
    s_nop 1
    v_permlane16_swap_b32 v200, v201
    s_nop 1
    v_max_f32 v200, v200, v201

    v_sub_f32 v172, v172, v200
    v_mul_f32 v172, s44, v172
    v_exp_f32 v172, v172

    v_sub_f32 v173, v173, v200
    v_mul_f32 v173, s44, v173
    v_exp_f32 v173, v173

    v_sub_f32 v174, v174, v200
    v_mul_f32 v174, s44, v174
    v_exp_f32 v174, v174

    v_sub_f32 v175, v175, v200
    v_mul_f32 v175, s44, v175
    v_exp_f32 v175, v175

    v_sub_f32 v176, v176, v200
    v_mul_f32 v176, s44, v176
    v_exp_f32 v176, v176

    v_sub_f32 v177, v177, v200
    v_mul_f32 v177, s44, v177
    v_exp_f32 v177, v177

    v_sub_f32 v178, v178, v200
    v_mul_f32 v178, s44, v178
    v_exp_f32 v178, v178

    v_sub_f32 v179, v179, v200
    v_mul_f32 v179, s44, v179
    v_exp_f32 v179, v179

    v_sub_f32 v180, v180, v200
    v_mul_f32 v180, s44, v180
    v_exp_f32 v180, v180

    v_sub_f32 v181, v181, v200
    v_mul_f32 v181, s44, v181
    v_exp_f32 v181, v181

    v_sub_f32 v182, v182, v200
    v_mul_f32 v182, s44, v182
    v_exp_f32 v182, v182

    v_sub_f32 v183, v183, v200
    v_mul_f32 v183, s44, v183
    v_exp_f32 v183, v183

    s_nop 0
    v_add_f32 v200, v172, v173
    v_add_f32 v200, v200, v174
    v_add_f32 v200, v200, v175
    v_add_f32 v200, v200, v176
    v_add_f32 v200, v200, v177
    v_add_f32 v200, v200, v178
    v_add_f32 v200, v200, v179
    v_add_f32 v200, v200, v180
    v_add_f32 v200, v200, v181
    v_add_f32 v200, v200, v182
    v_add_f32 v200, v200, v183
    v_mov_b32 v201, v200
    s_nop 1
    v_permlane32_swap_b32 v200, v201
    s_nop 1
    v_add_f32 v200, v200, v201
    v_mov_b32 v201, v200
    s_nop 1
    v_permlane16_swap_b32 v200, v201
    s_nop 1
    v_add_f32 v200, v200, v201
    v_rcp_f32 v200, v200
    s_nop 0

    v_mul_f32 v172, v172, v200
    v_mul_f32 v173, v173, v200
    v_mul_f32 v174, v174, v200
    v_mul_f32 v175, v175, v200
    v_mul_f32 v176, v176, v200
    v_mul_f32 v177, v177, v200
    v_mul_f32 v178, v178, v200
    v_mul_f32 v179, v179, v200
    v_mul_f32 v180, v180, v200
    v_mul_f32 v181, v181, v200
    v_mul_f32 v182, v182, v200
    v_mul_f32 v183, v183, v200
    v_cvt_pk_bf16_f32 v216, v172, v173
    v_cvt_pk_bf16_f32 v217, v174, v175
    v_cvt_pk_bf16_f32 v218, v176, v177
    v_cvt_pk_bf16_f32 v219, v178, v179
    v_cvt_pk_bf16_f32 v220, v180, v181
    v_cvt_pk_bf16_f32 v221, v182, v183
    v_mov_b32 v222, 0
    v_mov_b32 v223, 0
    s_waitcnt vmcnt(0)
    s_nop 1
    s_lshl_b32 s24, s22, 18
    s_lshl_b32 s25, s23, 8
    s_add_u32 s24, s24, s25
    s_add_u32 s24, s24, 63471616
    s_add_u32 s30, s24, 131072
    v_lshlrev_b32 v4, 13, v1
    v_lshl_add_u32 v4, v2, 3, v4

    v_mfma_f32_16x16x32_bf16 v[16:19], v[96:99], v[208:211], 0
    v_mfma_f32_16x16x32_bf16 v[16:19], v[100:103], v[212:215], v[16:19]
    v_mfma_f32_16x16x32_bf16 v[20:23], v[104:107], v[208:211], 0
    v_mfma_f32_16x16x32_bf16 v[20:23], v[108:111], v[212:215], v[20:23]
    v_mfma_f32_16x16x32_bf16 v[24:27], v[112:115], v[208:211], 0
    v_mfma_f32_16x16x32_bf16 v[24:27], v[116:119], v[212:215], v[24:27]
    v_mfma_f32_16x16x32_bf16 v[28:31], v[120:123], v[208:211], 0
    v_mfma_f32_16x16x32_bf16 v[28:31], v[124:127], v[212:215], v[28:31]
    v_mfma_f32_16x16x32_bf16 v[32:35], v[128:131], v[208:211], 0
    v_mfma_f32_16x16x32_bf16 v[32:35], v[132:135], v[212:215], v[32:35]
    v_mfma_f32_16x16x32_bf16 v[36:39], v[136:139], v[208:211], 0
    v_mfma_f32_16x16x32_bf16 v[36:39], v[140:143], v[212:215], v[36:39]
    v_mfma_f32_16x16x32_bf16 v[40:43], v[144:147], v[208:211], 0
    v_mfma_f32_16x16x32_bf16 v[40:43], v[148:151], v[212:215], v[40:43]
    v_mfma_f32_16x16x32_bf16 v[44:47], v[152:155], v[208:211], 0
    v_mfma_f32_16x16x32_bf16 v[44:47], v[156:159], v[212:215], v[44:47]
    v_mfma_f32_16x16x32_bf16 v[48:51], v[96:99], v[216:219], 0
    v_mfma_f32_16x16x32_bf16 v[48:51], v[100:103], v[220:223], v[48:51]
    v_mfma_f32_16x16x32_bf16 v[52:55], v[104:107], v[216:219], 0
    v_mfma_f32_16x16x32_bf16 v[52:55], v[108:111], v[220:223], v[52:55]
    v_mfma_f32_16x16x32_bf16 v[56:59], v[112:115], v[216:219], 0
    v_mfma_f32_16x16x32_bf16 v[56:59], v[116:119], v[220:223], v[56:59]
    v_mfma_f32_16x16x32_bf16 v[60:63], v[120:123], v[216:219], 0
    v_mfma_f32_16x16x32_bf16 v[60:63], v[124:127], v[220:223], v[60:63]
    v_mfma_f32_16x16x32_bf16 v[64:67], v[128:131], v[216:219], 0
    v_mfma_f32_16x16x32_bf16 v[64:67], v[132:135], v[220:223], v[64:67]
    v_mfma_f32_16x16x32_bf16 v[68:71], v[136:139], v[216:219], 0
    v_mfma_f32_16x16x32_bf16 v[68:71], v[140:143], v[220:223], v[68:71]
    v_mfma_f32_16x16x32_bf16 v[72:75], v[144:147], v[216:219], 0
    v_mfma_f32_16x16x32_bf16 v[72:75], v[148:151], v[220:223], v[72:75]
    v_mfma_f32_16x16x32_bf16 v[76:79], v[152:155], v[216:219], 0
    v_mfma_f32_16x16x32_bf16 v[76:79], v[156:159], v[220:223], v[76:79]
    s_nop 7
    s_nop 1
    v_cvt_pk_bf16_f32 v16, v16, v17
    v_cvt_pk_bf16_f32 v17, v18, v19
    v_cvt_pk_bf16_f32 v20, v20, v21
    v_cvt_pk_bf16_f32 v21, v22, v23
    v_cvt_pk_bf16_f32 v24, v24, v25
    v_cvt_pk_bf16_f32 v25, v26, v27
    v_cvt_pk_bf16_f32 v28, v28, v29
    v_cvt_pk_bf16_f32 v29, v30, v31
    v_cvt_pk_bf16_f32 v32, v32, v33
    v_cvt_pk_bf16_f32 v33, v34, v35
    v_cvt_pk_bf16_f32 v36, v36, v37
    v_cvt_pk_bf16_f32 v37, v38, v39
    v_cvt_pk_bf16_f32 v40, v40, v41
    v_cvt_pk_bf16_f32 v41, v42, v43
    v_cvt_pk_bf16_f32 v44, v44, v45
    v_cvt_pk_bf16_f32 v45, v46, v47
    buffer_store_dwordx2 v[16:17], v4, s[8:11], s24 offen offset:0
    buffer_store_dwordx2 v[20:21], v4, s[8:11], s24 offen offset:32
    buffer_store_dwordx2 v[24:25], v4, s[8:11], s24 offen offset:64
    buffer_store_dwordx2 v[28:29], v4, s[8:11], s24 offen offset:96
    buffer_store_dwordx2 v[32:33], v4, s[8:11], s24 offen offset:128
    buffer_store_dwordx2 v[36:37], v4, s[8:11], s24 offen offset:160
    buffer_store_dwordx2 v[40:41], v4, s[8:11], s24 offen offset:192
    buffer_store_dwordx2 v[44:45], v4, s[8:11], s24 offen offset:224
    v_cvt_pk_bf16_f32 v48, v48, v49
    v_cvt_pk_bf16_f32 v49, v50, v51
    v_cvt_pk_bf16_f32 v52, v52, v53
    v_cvt_pk_bf16_f32 v53, v54, v55
    v_cvt_pk_bf16_f32 v56, v56, v57
    v_cvt_pk_bf16_f32 v57, v58, v59
    v_cvt_pk_bf16_f32 v60, v60, v61
    v_cvt_pk_bf16_f32 v61, v62, v63
    v_cvt_pk_bf16_f32 v64, v64, v65
    v_cvt_pk_bf16_f32 v65, v66, v67
    v_cvt_pk_bf16_f32 v68, v68, v69
    v_cvt_pk_bf16_f32 v69, v70, v71
    v_cvt_pk_bf16_f32 v72, v72, v73
    v_cvt_pk_bf16_f32 v73, v74, v75
    v_cvt_pk_bf16_f32 v76, v76, v77
    v_cvt_pk_bf16_f32 v77, v78, v79
    buffer_store_dwordx2 v[48:49], v4, s[8:11], s30 offen offset:0
    buffer_store_dwordx2 v[52:53], v4, s[8:11], s30 offen offset:32
    buffer_store_dwordx2 v[56:57], v4, s[8:11], s30 offen offset:64
    buffer_store_dwordx2 v[60:61], v4, s[8:11], s30 offen offset:96
    buffer_store_dwordx2 v[64:65], v4, s[8:11], s30 offen offset:128
    buffer_store_dwordx2 v[68:69], v4, s[8:11], s30 offen offset:160
    buffer_store_dwordx2 v[72:73], v4, s[8:11], s30 offen offset:192
    buffer_store_dwordx2 v[76:77], v4, s[8:11], s30 offen offset:224
attn_kernel_end:
    s_endpgm
.section .rodata,"a"
.p2align 6
.amdhsa_kernel attn_kernel
  .amdhsa_next_free_vgpr 232
  .amdhsa_next_free_sgpr 48
  .amdhsa_accum_offset 232
  .amdhsa_group_segment_fixed_size 0
  .amdhsa_kernarg_size 128
  .amdhsa_user_sgpr_count 2
  .amdhsa_user_sgpr_kernarg_segment_ptr 1
  .amdhsa_system_sgpr_workgroup_id_x 1
.end_amdhsa_kernel
.text
.p2align 8
.globl wo_gemm_kernel
.type wo_gemm_kernel,@function
wo_gemm_kernel:
    s_cmp_ge_u32 s2, 144
    s_cbranch_scc1 wo_gemm_kernel_end
    s_load_dwordx2 s[4:5], s[0:1], 120
    s_load_dwordx2 s[8:9], s[0:1], 120
    s_and_b32 s22, s2, 15
    s_lshr_b32 s23, s2, 4

    s_load_dwordx2 s[10:11], s[0:1], 40
    s_mul_i32 s24, s23, 128
    s_mov_b32 s29, 0

    s_waitcnt lgkmcnt(0)
    s_add_u32 s12, s4, 63471616
    s_addc_u32 s13, s5, 0
    s_mov_b32 s14, 16777216
    s_mov_b32 s15, 0x00020000
    s_mov_b32 s16, s10
    s_mov_b32 s17, s11
    s_mov_b32 s18, 4718592
    s_mov_b32 s19, 0x00020000
    v_and_b32 v1, 63, v0
    v_lshrrev_b32 v2, 6, v0
    v_and_b32 v3, 15, v0
    v_bfe_u32 v4, v0, 4, 2

    v_lshrrev_b32 v5, 3, v0
    v_and_b32 v6, 7, v0
    s_mul_i32 s25, s22, 1048576
    v_mul_u32_u24 v7, 8192, v5
    v_lshl_add_u32 v7, v6, 4, v7
    v_add_u32 v7, s25, v7
    v_mul_u32_u24 v8, 144, v5
    v_lshl_add_u32 v8, v6, 4, v8

    v_lshrrev_b32 v9, 3, v0
    v_and_b32 v10, 7, v0
    v_mul_u32_u24 v11, 1152, v9
    v_lshl_add_u32 v11, v10, 4, v11
    v_add_u32 v11, s24, v11

    v_add_u32 v12, 0, v9
    v_and_b32 v13, 0xffffffe0, v12
    v_bfe_u32 v14, v12, 2, 1
    v_lshl_add_u32 v13, v14, 4, v13
    v_bfe_u32 v14, v12, 3, 2
    v_lshl_add_u32 v13, v14, 2, v13
    v_and_b32 v14, 3, v12
    v_add_u32 v13, v13, v14
    v_mul_u32_u24 v13, 160, v13
    v_lshl_add_u32 v13, v10, 4, v13
    v_add_u32 v16, 18432, v13

    v_add_u32 v12, 32, v9
    v_and_b32 v13, 0xffffffe0, v12
    v_bfe_u32 v14, v12, 2, 1
    v_lshl_add_u32 v13, v14, 4, v13
    v_bfe_u32 v14, v12, 3, 2
    v_lshl_add_u32 v13, v14, 2, v13
    v_and_b32 v14, 3, v12
    v_add_u32 v13, v13, v14
    v_mul_u32_u24 v13, 160, v13
    v_lshl_add_u32 v13, v10, 4, v13
    v_add_u32 v17, 18432, v13

    v_lshrrev_b32 v12, 1, v2
    v_and_b32 v13, 1, v2
    v_lshlrev_b32 v14, 6, v12
    v_add_u32 v14, v14, v3
    v_mul_u32_u24 v14, 144, v14
    v_lshl_add_u32 v20, v4, 4, v14

    v_bfe_u32 v14, v0, 2, 2
    v_and_b32 v15, 3, v0
    v_lshl_add_u32 v14, v4, 2, v14
    v_mul_u32_u24 v14, 160, v14
    v_mul_u32_u24 v21, 32, v13
    v_lshl_add_u32 v21, v15, 2, v21
    v_lshl_add_u32 v21, v21, 1, v14
    v_add_u32 v21, 18432, v21

    v_mov_b32 v64, 0
    v_mov_b32 v65, 0
    v_mov_b32 v66, 0
    v_mov_b32 v67, 0
    v_mov_b32 v68, 0
    v_mov_b32 v69, 0
    v_mov_b32 v70, 0
    v_mov_b32 v71, 0
    v_mov_b32 v72, 0
    v_mov_b32 v73, 0
    v_mov_b32 v74, 0
    v_mov_b32 v75, 0
    v_mov_b32 v76, 0
    v_mov_b32 v77, 0
    v_mov_b32 v78, 0
    v_mov_b32 v79, 0
    v_mov_b32 v80, 0
    v_mov_b32 v81, 0
    v_mov_b32 v82, 0
    v_mov_b32 v83, 0
    v_mov_b32 v84, 0
    v_mov_b32 v85, 0
    v_mov_b32 v86, 0
    v_mov_b32 v87, 0
    v_mov_b32 v88, 0
    v_mov_b32 v89, 0
    v_mov_b32 v90, 0
    v_mov_b32 v91, 0
    v_mov_b32 v92, 0
    v_mov_b32 v93, 0
    v_mov_b32 v94, 0
    v_mov_b32 v95, 0
    v_add_u32 v25, 262144, v7
    v_add_u32 v26, 524288, v7
    v_add_u32 v27, 786432, v7
    v_add_u32 v29, 36864, v11
    s_mov_b32 s26, 0
    s_mov_b32 s27, 0
    s_mov_b32 s28, 0
    buffer_load_dwordx4 v[32:35], v7, s[12:15], s26 offen offset:0
    buffer_load_dwordx4 v[36:39], v25, s[12:15], s26 offen
    buffer_load_dwordx4 v[40:43], v26, s[12:15], s26 offen
    buffer_load_dwordx4 v[44:47], v27, s[12:15], s26 offen
    buffer_load_dwordx4 v[48:51], v11, s[16:19], s27 offen
    buffer_load_dwordx4 v[52:55], v29, s[16:19], s27 offen
    s_waitcnt vmcnt(0)
    ds_write_b128 v8, v[32:35] offset:0
    ds_write_b128 v8, v[36:39] offset:4608
    ds_write_b128 v8, v[40:43] offset:9216
    ds_write_b128 v8, v[44:47] offset:13824
    ds_write_b128 v16, v[48:51]
    ds_write_b128 v17, v[52:55]
    s_waitcnt lgkmcnt(0)
    s_barrier
wo_gemm_kernel_loop1:
    s_add_u32 s26, s26, 128
    s_add_u32 s27, s27, 73728
    s_add_u32 s28, s28, 1

    buffer_load_dwordx4 v[32:35], v7, s[12:15], s26 offen offset:0
    buffer_load_dwordx4 v[36:39], v25, s[12:15], s26 offen
    buffer_load_dwordx4 v[40:43], v26, s[12:15], s26 offen
    buffer_load_dwordx4 v[44:47], v27, s[12:15], s26 offen
    buffer_load_dwordx4 v[48:51], v11, s[16:19], s27 offen
    buffer_load_dwordx4 v[52:55], v29, s[16:19], s27 offen
    ds_read_b128 v[128:131], v20 offset:0
    ds_read_b128 v[132:135], v20 offset:2304
    ds_read_b128 v[136:139], v20 offset:4608
    ds_read_b128 v[140:143], v20 offset:6912
    ds_read_b64_tr_b16 v[144:145], v21 offset:0
    ds_read_b64_tr_b16 v[146:147], v21 offset:2560
    ds_read_b64_tr_b16 v[148:149], v21 offset:32
    ds_read_b64_tr_b16 v[150:151], v21 offset:2592
    s_waitcnt lgkmcnt(0)
    v_mfma_f32_16x16x32_bf16 v[64:67], v[144:147], v[128:131], v[64:67]
    v_mfma_f32_16x16x32_bf16 v[68:71], v[148:151], v[128:131], v[68:71]
    v_mfma_f32_16x16x32_bf16 v[72:75], v[144:147], v[132:135], v[72:75]
    v_mfma_f32_16x16x32_bf16 v[76:79], v[148:151], v[132:135], v[76:79]
    v_mfma_f32_16x16x32_bf16 v[80:83], v[144:147], v[136:139], v[80:83]
    v_mfma_f32_16x16x32_bf16 v[84:87], v[148:151], v[136:139], v[84:87]
    v_mfma_f32_16x16x32_bf16 v[88:91], v[144:147], v[140:143], v[88:91]
    v_mfma_f32_16x16x32_bf16 v[92:95], v[148:151], v[140:143], v[92:95]
    ds_read_b128 v[128:131], v20 offset:64
    ds_read_b128 v[132:135], v20 offset:2368
    ds_read_b128 v[136:139], v20 offset:4672
    ds_read_b128 v[140:143], v20 offset:6976
    ds_read_b64_tr_b16 v[144:145], v21 offset:5120
    ds_read_b64_tr_b16 v[146:147], v21 offset:7680
    ds_read_b64_tr_b16 v[148:149], v21 offset:5152
    ds_read_b64_tr_b16 v[150:151], v21 offset:7712
    s_waitcnt lgkmcnt(0)
    v_mfma_f32_16x16x32_bf16 v[64:67], v[144:147], v[128:131], v[64:67]
    v_mfma_f32_16x16x32_bf16 v[68:71], v[148:151], v[128:131], v[68:71]
    v_mfma_f32_16x16x32_bf16 v[72:75], v[144:147], v[132:135], v[72:75]
    v_mfma_f32_16x16x32_bf16 v[76:79], v[148:151], v[132:135], v[76:79]
    v_mfma_f32_16x16x32_bf16 v[80:83], v[144:147], v[136:139], v[80:83]
    v_mfma_f32_16x16x32_bf16 v[84:87], v[148:151], v[136:139], v[84:87]
    v_mfma_f32_16x16x32_bf16 v[88:91], v[144:147], v[140:143], v[88:91]
    v_mfma_f32_16x16x32_bf16 v[92:95], v[148:151], v[140:143], v[92:95]
    v_xor_b32 v8, 32768, v8
    v_xor_b32 v20, 32768, v20
    v_xor_b32 v21, 32768, v21

    v_xor_b32 v16, 32768, v16
    v_xor_b32 v17, 32768, v17
    s_cmp_ge_u32 s28, 64
    s_cbranch_scc1 wo_gemm_kernel_skip2
    s_waitcnt vmcnt(0)

    ds_write_b128 v8, v[32:35] offset:0
    ds_write_b128 v8, v[36:39] offset:4608
    ds_write_b128 v8, v[40:43] offset:9216
    ds_write_b128 v8, v[44:47] offset:13824
    ds_write_b128 v16, v[48:51]
    ds_write_b128 v17, v[52:55]
    s_waitcnt lgkmcnt(0)
    s_barrier
    s_branch wo_gemm_kernel_loop1
wo_gemm_kernel_skip2:
    s_waitcnt vmcnt(0)
    s_nop 7
    s_nop 7
    s_load_dwordx2 s[4:5], s[0:1], 0
    s_load_dwordx2 s[6:7], s[0:1], 120
    s_waitcnt lgkmcnt(0)
    s_mov_b32 s32, s4
    s_mov_b32 s33, s5
    s_mov_b32 s34, 2359296
    s_mov_b32 s35, 0x00020000
    s_add_u32 s36, s6, 80248832
    s_addc_u32 s37, s7, 0
    s_mov_b32 s38, 2359296
    s_mov_b32 s39, 0x00020000
    s_mov_b32 s40, s8
    s_mov_b32 s41, s9
    s_mov_b32 s42, 13824
    s_mov_b32 s43, 0x00020000
    v_lshrrev_b32 v12, 1, v2
    v_and_b32 v13, 1, v2
    s_lshl_b32 s25, s22, 7
    v_lshl_add_u32 v14, v12, 6, v3
    v_add_u32 v14, s25, v14
    v_mul_u32_u24 v14, 1152, v14
    v_mul_u32_u24 v15, 32, v13
    v_lshl_add_u32 v15, v4, 2, v15
    s_mul_i32 s25, s23, 64
    v_add_u32 v15, s25, v15
    v_lshl_add_u32 v14, v15, 1, v14
    v_lshlrev_b32 v15, 2, v15
    v_add_u32 v15, 4608, v15

    buffer_load_dwordx4 v[16:19], v15, s[40:43], 0 offen offset:0
    buffer_load_dwordx4 v[20:23], v15, s[40:43], 0 offen offset:64
    buffer_load_dwordx2 v[32:33], v14, s[32:35], 0 offen offset:0
    buffer_load_dwordx2 v[34:35], v14, s[32:35], 0 offen offset:32
    s_waitcnt vmcnt(0)
    v_cvt_pk_bf16_f32 v48, v64, v65
    v_cvt_pk_bf16_f32 v49, v66, v67
    v_lshlrev_b32 v64, 16, v48
    v_and_b32 v65, 0xffff0000, v48
    v_lshlrev_b32 v66, 16, v49
    v_and_b32 v67, 0xffff0000, v49
    v_mul_f32 v64, v64, v16
    v_mul_f32 v65, v65, v17
    v_mul_f32 v66, v66, v18
    v_mul_f32 v67, v67, v19
    v_cvt_pk_bf16_f32 v48, v64, v65
    v_cvt_pk_bf16_f32 v49, v66, v67
    v_lshlrev_b32 v64, 16, v48
    v_and_b32 v65, 0xffff0000, v48
    v_lshlrev_b32 v66, 16, v49
    v_and_b32 v67, 0xffff0000, v49
    v_lshlrev_b32 v50, 16, v32
    v_and_b32 v51, 0xffff0000, v32
    v_lshlrev_b32 v52, 16, v33
    v_and_b32 v53, 0xffff0000, v33
    v_add_f32 v64, v64, v50
    v_add_f32 v65, v65, v51
    v_add_f32 v66, v66, v52
    v_add_f32 v67, v67, v53
    v_cvt_pk_bf16_f32 v64, v64, v65
    v_cvt_pk_bf16_f32 v65, v66, v67

    v_cvt_pk_bf16_f32 v48, v68, v69
    v_cvt_pk_bf16_f32 v49, v70, v71
    v_lshlrev_b32 v68, 16, v48
    v_and_b32 v69, 0xffff0000, v48
    v_lshlrev_b32 v70, 16, v49
    v_and_b32 v71, 0xffff0000, v49
    v_mul_f32 v68, v68, v20
    v_mul_f32 v69, v69, v21
    v_mul_f32 v70, v70, v22
    v_mul_f32 v71, v71, v23
    v_cvt_pk_bf16_f32 v48, v68, v69
    v_cvt_pk_bf16_f32 v49, v70, v71
    v_lshlrev_b32 v68, 16, v48
    v_and_b32 v69, 0xffff0000, v48
    v_lshlrev_b32 v70, 16, v49
    v_and_b32 v71, 0xffff0000, v49
    v_lshlrev_b32 v50, 16, v34
    v_and_b32 v51, 0xffff0000, v34
    v_lshlrev_b32 v52, 16, v35
    v_and_b32 v53, 0xffff0000, v35
    v_add_f32 v68, v68, v50
    v_add_f32 v69, v69, v51
    v_add_f32 v70, v70, v52
    v_add_f32 v71, v71, v53
    v_cvt_pk_bf16_f32 v68, v68, v69
    v_cvt_pk_bf16_f32 v69, v70, v71

    buffer_store_dwordx2 v[64:65], v14, s[36:39], 0 offen offset:0
    buffer_store_dwordx2 v[68:69], v14, s[36:39], 0 offen offset:32
    v_add_u32 v14, 18432, v14
    buffer_load_dwordx2 v[32:33], v14, s[32:35], 0 offen offset:0
    buffer_load_dwordx2 v[34:35], v14, s[32:35], 0 offen offset:32
    s_waitcnt vmcnt(0)
    v_cvt_pk_bf16_f32 v48, v72, v73
    v_cvt_pk_bf16_f32 v49, v74, v75
    v_lshlrev_b32 v72, 16, v48
    v_and_b32 v73, 0xffff0000, v48
    v_lshlrev_b32 v74, 16, v49
    v_and_b32 v75, 0xffff0000, v49
    v_mul_f32 v72, v72, v16
    v_mul_f32 v73, v73, v17
    v_mul_f32 v74, v74, v18
    v_mul_f32 v75, v75, v19
    v_cvt_pk_bf16_f32 v48, v72, v73
    v_cvt_pk_bf16_f32 v49, v74, v75
    v_lshlrev_b32 v72, 16, v48
    v_and_b32 v73, 0xffff0000, v48
    v_lshlrev_b32 v74, 16, v49
    v_and_b32 v75, 0xffff0000, v49
    v_lshlrev_b32 v50, 16, v32
    v_and_b32 v51, 0xffff0000, v32
    v_lshlrev_b32 v52, 16, v33
    v_and_b32 v53, 0xffff0000, v33
    v_add_f32 v72, v72, v50
    v_add_f32 v73, v73, v51
    v_add_f32 v74, v74, v52
    v_add_f32 v75, v75, v53
    v_cvt_pk_bf16_f32 v72, v72, v73
    v_cvt_pk_bf16_f32 v73, v74, v75

    v_cvt_pk_bf16_f32 v48, v76, v77
    v_cvt_pk_bf16_f32 v49, v78, v79
    v_lshlrev_b32 v76, 16, v48
    v_and_b32 v77, 0xffff0000, v48
    v_lshlrev_b32 v78, 16, v49
    v_and_b32 v79, 0xffff0000, v49
    v_mul_f32 v76, v76, v20
    v_mul_f32 v77, v77, v21
    v_mul_f32 v78, v78, v22
    v_mul_f32 v79, v79, v23
    v_cvt_pk_bf16_f32 v48, v76, v77
    v_cvt_pk_bf16_f32 v49, v78, v79
    v_lshlrev_b32 v76, 16, v48
    v_and_b32 v77, 0xffff0000, v48
    v_lshlrev_b32 v78, 16, v49
    v_and_b32 v79, 0xffff0000, v49
    v_lshlrev_b32 v50, 16, v34
    v_and_b32 v51, 0xffff0000, v34
    v_lshlrev_b32 v52, 16, v35
    v_and_b32 v53, 0xffff0000, v35
    v_add_f32 v76, v76, v50
    v_add_f32 v77, v77, v51
    v_add_f32 v78, v78, v52
    v_add_f32 v79, v79, v53
    v_cvt_pk_bf16_f32 v76, v76, v77
    v_cvt_pk_bf16_f32 v77, v78, v79

    buffer_store_dwordx2 v[72:73], v14, s[36:39], 0 offen offset:0
    buffer_store_dwordx2 v[76:77], v14, s[36:39], 0 offen offset:32
    v_add_u32 v14, 18432, v14
    buffer_load_dwordx2 v[32:33], v14, s[32:35], 0 offen offset:0
    buffer_load_dwordx2 v[34:35], v14, s[32:35], 0 offen offset:32
    s_waitcnt vmcnt(0)
    v_cvt_pk_bf16_f32 v48, v80, v81
    v_cvt_pk_bf16_f32 v49, v82, v83
    v_lshlrev_b32 v80, 16, v48
    v_and_b32 v81, 0xffff0000, v48
    v_lshlrev_b32 v82, 16, v49
    v_and_b32 v83, 0xffff0000, v49
    v_mul_f32 v80, v80, v16
    v_mul_f32 v81, v81, v17
    v_mul_f32 v82, v82, v18
    v_mul_f32 v83, v83, v19
    v_cvt_pk_bf16_f32 v48, v80, v81
    v_cvt_pk_bf16_f32 v49, v82, v83
    v_lshlrev_b32 v80, 16, v48
    v_and_b32 v81, 0xffff0000, v48
    v_lshlrev_b32 v82, 16, v49
    v_and_b32 v83, 0xffff0000, v49
    v_lshlrev_b32 v50, 16, v32
    v_and_b32 v51, 0xffff0000, v32
    v_lshlrev_b32 v52, 16, v33
    v_and_b32 v53, 0xffff0000, v33
    v_add_f32 v80, v80, v50
    v_add_f32 v81, v81, v51
    v_add_f32 v82, v82, v52
    v_add_f32 v83, v83, v53
    v_cvt_pk_bf16_f32 v80, v80, v81
    v_cvt_pk_bf16_f32 v81, v82, v83

    v_cvt_pk_bf16_f32 v48, v84, v85
    v_cvt_pk_bf16_f32 v49, v86, v87
    v_lshlrev_b32 v84, 16, v48
    v_and_b32 v85, 0xffff0000, v48
    v_lshlrev_b32 v86, 16, v49
    v_and_b32 v87, 0xffff0000, v49
    v_mul_f32 v84, v84, v20
    v_mul_f32 v85, v85, v21
    v_mul_f32 v86, v86, v22
    v_mul_f32 v87, v87, v23
    v_cvt_pk_bf16_f32 v48, v84, v85
    v_cvt_pk_bf16_f32 v49, v86, v87
    v_lshlrev_b32 v84, 16, v48
    v_and_b32 v85, 0xffff0000, v48
    v_lshlrev_b32 v86, 16, v49
    v_and_b32 v87, 0xffff0000, v49
    v_lshlrev_b32 v50, 16, v34
    v_and_b32 v51, 0xffff0000, v34
    v_lshlrev_b32 v52, 16, v35
    v_and_b32 v53, 0xffff0000, v35
    v_add_f32 v84, v84, v50
    v_add_f32 v85, v85, v51
    v_add_f32 v86, v86, v52
    v_add_f32 v87, v87, v53
    v_cvt_pk_bf16_f32 v84, v84, v85
    v_cvt_pk_bf16_f32 v85, v86, v87

    buffer_store_dwordx2 v[80:81], v14, s[36:39], 0 offen offset:0
    buffer_store_dwordx2 v[84:85], v14, s[36:39], 0 offen offset:32
    v_add_u32 v14, 18432, v14
    buffer_load_dwordx2 v[32:33], v14, s[32:35], 0 offen offset:0
    buffer_load_dwordx2 v[34:35], v14, s[32:35], 0 offen offset:32
    s_waitcnt vmcnt(0)
    v_cvt_pk_bf16_f32 v48, v88, v89
    v_cvt_pk_bf16_f32 v49, v90, v91
    v_lshlrev_b32 v88, 16, v48
    v_and_b32 v89, 0xffff0000, v48
    v_lshlrev_b32 v90, 16, v49
    v_and_b32 v91, 0xffff0000, v49
    v_mul_f32 v88, v88, v16
    v_mul_f32 v89, v89, v17
    v_mul_f32 v90, v90, v18
    v_mul_f32 v91, v91, v19
    v_cvt_pk_bf16_f32 v48, v88, v89
    v_cvt_pk_bf16_f32 v49, v90, v91
    v_lshlrev_b32 v88, 16, v48
    v_and_b32 v89, 0xffff0000, v48
    v_lshlrev_b32 v90, 16, v49
    v_and_b32 v91, 0xffff0000, v49
    v_lshlrev_b32 v50, 16, v32
    v_and_b32 v51, 0xffff0000, v32
    v_lshlrev_b32 v52, 16, v33
    v_and_b32 v53, 0xffff0000, v33
    v_add_f32 v88, v88, v50
    v_add_f32 v89, v89, v51
    v_add_f32 v90, v90, v52
    v_add_f32 v91, v91, v53
    v_cvt_pk_bf16_f32 v88, v88, v89
    v_cvt_pk_bf16_f32 v89, v90, v91

    v_cvt_pk_bf16_f32 v48, v92, v93
    v_cvt_pk_bf16_f32 v49, v94, v95
    v_lshlrev_b32 v92, 16, v48
    v_and_b32 v93, 0xffff0000, v48
    v_lshlrev_b32 v94, 16, v49
    v_and_b32 v95, 0xffff0000, v49
    v_mul_f32 v92, v92, v20
    v_mul_f32 v93, v93, v21
    v_mul_f32 v94, v94, v22
    v_mul_f32 v95, v95, v23
    v_cvt_pk_bf16_f32 v48, v92, v93
    v_cvt_pk_bf16_f32 v49, v94, v95
    v_lshlrev_b32 v92, 16, v48
    v_and_b32 v93, 0xffff0000, v48
    v_lshlrev_b32 v94, 16, v49
    v_and_b32 v95, 0xffff0000, v49
    v_lshlrev_b32 v50, 16, v34
    v_and_b32 v51, 0xffff0000, v34
    v_lshlrev_b32 v52, 16, v35
    v_and_b32 v53, 0xffff0000, v35
    v_add_f32 v92, v92, v50
    v_add_f32 v93, v93, v51
    v_add_f32 v94, v94, v52
    v_add_f32 v95, v95, v53
    v_cvt_pk_bf16_f32 v92, v92, v93
    v_cvt_pk_bf16_f32 v93, v94, v95

    buffer_store_dwordx2 v[88:89], v14, s[36:39], 0 offen offset:0
    buffer_store_dwordx2 v[92:93], v14, s[36:39], 0 offen offset:32
    v_add_u32 v14, 18432, v14
wo_gemm_kernel_end:
    s_endpgm
.section .rodata,"a"
.p2align 6
.amdhsa_kernel wo_gemm_kernel
  .amdhsa_next_free_vgpr 160
  .amdhsa_next_free_sgpr 48
  .amdhsa_accum_offset 160
  .amdhsa_group_segment_fixed_size 0
  .amdhsa_kernarg_size 128
  .amdhsa_user_sgpr_count 2
  .amdhsa_user_sgpr_kernarg_segment_ptr 1
  .amdhsa_system_sgpr_workgroup_id_x 1
.end_amdhsa_kernel
.text
.p2align 8
.globl ln2_kernel
.type ln2_kernel,@function
ln2_kernel:
    s_cmp_ge_u32 s2, 512
    s_cbranch_scc1 ln2_kernel_end
    s_load_dwordx2 s[4:5], s[0:1], 120
    s_load_dwordx2 s[8:9], s[0:1], 120
    v_and_b32 v1, 63, v0
    v_lshrrev_b32 v2, 6, v0
    s_waitcnt lgkmcnt(0)

    s_add_u32 s12, s4, 80248832
    s_addc_u32 s13, s5, 0
    s_mov_b32 s14, 2359296
    s_mov_b32 s15, 0x00020000
    s_mov_b32 s16, s8
    s_mov_b32 s17, s9
    s_mov_b32 s18, 13824
    s_mov_b32 s19, 0x00020000
    s_add_u32 s20, s8, 82608128
    s_addc_u32 s21, s9, 0
    s_mov_b32 s22, 2359296
    s_mov_b32 s23, 0x00020000
    s_lshl_b32 s3, s2, 2
    v_add_u32 v3, s3, v2
    v_mul_u32_u24 v3, 1152, v3
    v_lshlrev_b32 v4, 2, v1
    v_add_u32 v3, v3, v4
    v_lshlrev_b32 v5, 3, v1
    v_add_u32 v6, 9216, v5
    v_add_u32 v7, 6912, v5
    v_mov_b32 v14, 0
    v_mov_b32 v24, 0
    v_mov_b32 v25, 0
    v_mov_b32 v34, 0
    v_mov_b32 v35, 0

    buffer_load_dword v10, v3, s[12:15], 0 offen offset:0
    buffer_load_dwordx2 v[20:21], v6, s[16:19], 0 offen offset:0
    buffer_load_dwordx2 v[30:31], v7, s[16:19], 0 offen offset:0
    buffer_load_dword v11, v3, s[12:15], 0 offen offset:256
    buffer_load_dwordx2 v[22:23], v6, s[16:19], 0 offen offset:512
    buffer_load_dwordx2 v[32:33], v7, s[16:19], 0 offen offset:512
    buffer_load_dword v12, v3, s[12:15], 0 offen offset:512
    buffer_load_dwordx2 v[24:25], v6, s[16:19], 0 offen offset:1024
    buffer_load_dwordx2 v[34:35], v7, s[16:19], 0 offen offset:1024
    buffer_load_dword v13, v3, s[12:15], 0 offen offset:768
    buffer_load_dwordx2 v[26:27], v6, s[16:19], 0 offen offset:1536
    buffer_load_dwordx2 v[36:37], v7, s[16:19], 0 offen offset:1536
    v_cmp_gt_u32 vcc, 32, v1
    s_and_saveexec_b64 s[26:27], vcc
    buffer_load_dword v14, v3, s[12:15], 0 offen offset:1024
    buffer_load_dwordx2 v[28:29], v6, s[16:19], 0 offen offset:2048
    buffer_load_dwordx2 v[38:39], v7, s[16:19], 0 offen offset:2048
    s_mov_b64 exec, s[26:27]
    s_waitcnt vmcnt(0)

    v_lshlrev_b32 v40, 16, v10
    v_and_b32 v41, 0xffff0000, v10
    v_lshlrev_b32 v42, 16, v11
    v_and_b32 v43, 0xffff0000, v11
    v_lshlrev_b32 v44, 16, v12
    v_and_b32 v45, 0xffff0000, v12
    v_lshlrev_b32 v46, 16, v13
    v_and_b32 v47, 0xffff0000, v13
    v_lshlrev_b32 v48, 16, v14
    v_and_b32 v49, 0xffff0000, v14
    v_add_f32 v50, v40, v41
    v_add_f32 v50, v50, v42
    v_add_f32 v50, v50, v43
    v_add_f32 v50, v50, v44
    v_add_f32 v50, v50, v45
    v_add_f32 v50, v50, v46
    v_add_f32 v50, v50, v47
    v_add_f32 v50, v50, v48
    v_add_f32 v50, v50, v49
    ds_swizzle_b32 v51, v50 offset:1055
    s_waitcnt lgkmcnt(0)
    v_add_f32 v50, v50, v51

    ds_swizzle_b32 v51, v50 offset:2079
    s_waitcnt lgkmcnt(0)
    v_add_f32 v50, v50, v51

    ds_swizzle_b32 v51, v50 offset:4127
    s_waitcnt lgkmcnt(0)
    v_add_f32 v50, v50, v51

    ds_swizzle_b32 v51, v50 offset:8223
    s_waitcnt lgkmcnt(0)
    v_add_f32 v50, v50, v51

    ds_swizzle_b32 v51, v50 offset:16415
    s_waitcnt lgkmcnt(0)
    v_add_f32 v50, v50, v51

    s_nop 0
    v_readlane_b32 s30, v50, 32
    s_nop 1
    v_add_f32 v50, s30, v50
    s_nop 0
    v_readlane_b32 s30, v50, 0
    s_nop 1

    v_mov_b32 v51, 0x3ae38e39
    v_mul_f32 v51, s30, v51

    v_mov_b32 v50, 0
    v_sub_f32 v52, v40, v51
    v_fmac_f32 v50, v52, v52

    v_sub_f32 v52, v41, v51
    v_fmac_f32 v50, v52, v52

    v_sub_f32 v52, v42, v51
    v_fmac_f32 v50, v52, v52

    v_sub_f32 v52, v43, v51
    v_fmac_f32 v50, v52, v52

    v_sub_f32 v52, v44, v51
    v_fmac_f32 v50, v52, v52

    v_sub_f32 v52, v45, v51
    v_fmac_f32 v50, v52, v52

    v_sub_f32 v52, v46, v51
    v_fmac_f32 v50, v52, v52

    v_sub_f32 v52, v47, v51
    v_fmac_f32 v50, v52, v52

    v_sub_f32 v52, v48, v51
    v_mul_f32 v52, v52, v52
    v_sub_f32 v53, v49, v51
    v_fmac_f32 v52, v53, v53
    v_cmp_gt_u32 vcc, 32, v1
    v_cndmask_b32 v52, 0, v52, vcc
    v_add_f32 v50, v50, v52

    ds_swizzle_b32 v52, v50 offset:1055
    s_waitcnt lgkmcnt(0)
    v_add_f32 v50, v50, v52

    ds_swizzle_b32 v52, v50 offset:2079
    s_waitcnt lgkmcnt(0)
    v_add_f32 v50, v50, v52

    ds_swizzle_b32 v52, v50 offset:4127
    s_waitcnt lgkmcnt(0)
    v_add_f32 v50, v50, v52

    ds_swizzle_b32 v52, v50 offset:8223
    s_waitcnt lgkmcnt(0)
    v_add_f32 v50, v50, v52

    ds_swizzle_b32 v52, v50 offset:16415
    s_waitcnt lgkmcnt(0)
    v_add_f32 v50, v50, v52

    s_nop 0
    v_readlane_b32 s31, v50, 32
    s_nop 1
    v_add_f32 v50, s31, v50
    s_nop 0
    v_readlane_b32 s31, v50, 0
    s_nop 1

    v_mov_b32 v52, 0x3ae38e39
    v_mul_f32 v52, s31, v52
    v_cvt_pk_bf16_f32 v52, v52, v51
    v_and_b32 v51, 0xffff0000, v52
    v_lshlrev_b32 v52, 16, v52
    v_add_f32 v52, 0x3727c5ac, v52
    v_cvt_pk_bf16_f32 v52, v52, v52
    v_lshlrev_b32 v52, 16, v52
    v_sqrt_f32 v52, v52
    s_nop 0
    v_cvt_pk_bf16_f32 v52, v52, v52
    v_lshlrev_b32 v52, 16, v52
    v_rcp_f32 v52, v52
    s_nop 0

    v_sub_f32 v40, v40, v51
    v_cvt_pk_bf16_f32 v40, v40, v40
    v_lshlrev_b32 v40, 16, v40
    v_mul_f32 v40, v40, v52
    v_cvt_pk_bf16_f32 v40, v40, v40
    v_lshlrev_b32 v40, 16, v40
    v_add_f32 v20, 1.0, v20
    v_cvt_pk_bf16_f32 v20, v20, v20
    v_lshlrev_b32 v20, 16, v20
    v_mul_f32 v40, v40, v20
    v_cvt_pk_bf16_f32 v40, v40, v40
    v_lshlrev_b32 v40, 16, v40
    v_add_f32 v40, v40, v30

    v_sub_f32 v41, v41, v51
    v_cvt_pk_bf16_f32 v41, v41, v41
    v_lshlrev_b32 v41, 16, v41
    v_mul_f32 v41, v41, v52
    v_cvt_pk_bf16_f32 v41, v41, v41
    v_lshlrev_b32 v41, 16, v41
    v_add_f32 v21, 1.0, v21
    v_cvt_pk_bf16_f32 v21, v21, v21
    v_lshlrev_b32 v21, 16, v21
    v_mul_f32 v41, v41, v21
    v_cvt_pk_bf16_f32 v41, v41, v41
    v_lshlrev_b32 v41, 16, v41
    v_add_f32 v41, v41, v31

    v_sub_f32 v42, v42, v51
    v_cvt_pk_bf16_f32 v42, v42, v42
    v_lshlrev_b32 v42, 16, v42
    v_mul_f32 v42, v42, v52
    v_cvt_pk_bf16_f32 v42, v42, v42
    v_lshlrev_b32 v42, 16, v42
    v_add_f32 v22, 1.0, v22
    v_cvt_pk_bf16_f32 v22, v22, v22
    v_lshlrev_b32 v22, 16, v22
    v_mul_f32 v42, v42, v22
    v_cvt_pk_bf16_f32 v42, v42, v42
    v_lshlrev_b32 v42, 16, v42
    v_add_f32 v42, v42, v32

    v_sub_f32 v43, v43, v51
    v_cvt_pk_bf16_f32 v43, v43, v43
    v_lshlrev_b32 v43, 16, v43
    v_mul_f32 v43, v43, v52
    v_cvt_pk_bf16_f32 v43, v43, v43
    v_lshlrev_b32 v43, 16, v43
    v_add_f32 v23, 1.0, v23
    v_cvt_pk_bf16_f32 v23, v23, v23
    v_lshlrev_b32 v23, 16, v23
    v_mul_f32 v43, v43, v23
    v_cvt_pk_bf16_f32 v43, v43, v43
    v_lshlrev_b32 v43, 16, v43
    v_add_f32 v43, v43, v33

    v_sub_f32 v44, v44, v51
    v_cvt_pk_bf16_f32 v44, v44, v44
    v_lshlrev_b32 v44, 16, v44
    v_mul_f32 v44, v44, v52
    v_cvt_pk_bf16_f32 v44, v44, v44
    v_lshlrev_b32 v44, 16, v44
    v_add_f32 v24, 1.0, v24
    v_cvt_pk_bf16_f32 v24, v24, v24
    v_lshlrev_b32 v24, 16, v24
    v_mul_f32 v44, v44, v24
    v_cvt_pk_bf16_f32 v44, v44, v44
    v_lshlrev_b32 v44, 16, v44
    v_add_f32 v44, v44, v34

    v_sub_f32 v45, v45, v51
    v_cvt_pk_bf16_f32 v45, v45, v45
    v_lshlrev_b32 v45, 16, v45
    v_mul_f32 v45, v45, v52
    v_cvt_pk_bf16_f32 v45, v45, v45
    v_lshlrev_b32 v45, 16, v45
    v_add_f32 v25, 1.0, v25
    v_cvt_pk_bf16_f32 v25, v25, v25
    v_lshlrev_b32 v25, 16, v25
    v_mul_f32 v45, v45, v25
    v_cvt_pk_bf16_f32 v45, v45, v45
    v_lshlrev_b32 v45, 16, v45
    v_add_f32 v45, v45, v35

    v_sub_f32 v46, v46, v51
    v_cvt_pk_bf16_f32 v46, v46, v46
    v_lshlrev_b32 v46, 16, v46
    v_mul_f32 v46, v46, v52
    v_cvt_pk_bf16_f32 v46, v46, v46
    v_lshlrev_b32 v46, 16, v46
    v_add_f32 v26, 1.0, v26
    v_cvt_pk_bf16_f32 v26, v26, v26
    v_lshlrev_b32 v26, 16, v26
    v_mul_f32 v46, v46, v26
    v_cvt_pk_bf16_f32 v46, v46, v46
    v_lshlrev_b32 v46, 16, v46
    v_add_f32 v46, v46, v36

    v_sub_f32 v47, v47, v51
    v_cvt_pk_bf16_f32 v47, v47, v47
    v_lshlrev_b32 v47, 16, v47
    v_mul_f32 v47, v47, v52
    v_cvt_pk_bf16_f32 v47, v47, v47
    v_lshlrev_b32 v47, 16, v47
    v_add_f32 v27, 1.0, v27
    v_cvt_pk_bf16_f32 v27, v27, v27
    v_lshlrev_b32 v27, 16, v27
    v_mul_f32 v47, v47, v27
    v_cvt_pk_bf16_f32 v47, v47, v47
    v_lshlrev_b32 v47, 16, v47
    v_add_f32 v47, v47, v37

    v_sub_f32 v48, v48, v51
    v_cvt_pk_bf16_f32 v48, v48, v48
    v_lshlrev_b32 v48, 16, v48
    v_mul_f32 v48, v48, v52
    v_cvt_pk_bf16_f32 v48, v48, v48
    v_lshlrev_b32 v48, 16, v48
    v_add_f32 v28, 1.0, v28
    v_cvt_pk_bf16_f32 v28, v28, v28
    v_lshlrev_b32 v28, 16, v28
    v_mul_f32 v48, v48, v28
    v_cvt_pk_bf16_f32 v48, v48, v48
    v_lshlrev_b32 v48, 16, v48
    v_add_f32 v48, v48, v38

    v_sub_f32 v49, v49, v51
    v_cvt_pk_bf16_f32 v49, v49, v49
    v_lshlrev_b32 v49, 16, v49
    v_mul_f32 v49, v49, v52
    v_cvt_pk_bf16_f32 v49, v49, v49
    v_lshlrev_b32 v49, 16, v49
    v_add_f32 v29, 1.0, v29
    v_cvt_pk_bf16_f32 v29, v29, v29
    v_lshlrev_b32 v29, 16, v29
    v_mul_f32 v49, v49, v29
    v_cvt_pk_bf16_f32 v49, v49, v49
    v_lshlrev_b32 v49, 16, v49
    v_add_f32 v49, v49, v39

    v_cvt_pk_bf16_f32 v10, v40, v41
    v_cvt_pk_bf16_f32 v11, v42, v43
    v_cvt_pk_bf16_f32 v12, v44, v45
    v_cvt_pk_bf16_f32 v13, v46, v47
    v_cvt_pk_bf16_f32 v14, v48, v49
    buffer_store_dword v10, v3, s[20:23], 0 offen offset:0
    buffer_store_dword v11, v3, s[20:23], 0 offen offset:256
    buffer_store_dword v12, v3, s[20:23], 0 offen offset:512
    buffer_store_dword v13, v3, s[20:23], 0 offen offset:768
    v_cmp_gt_u32 vcc, 32, v1
    s_and_saveexec_b64 s[26:27], vcc
    buffer_store_dword v14, v3, s[20:23], 0 offen offset:1024

ln2_kernel_end:
    s_endpgm
.section .rodata,"a"
.p2align 6
.amdhsa_kernel ln2_kernel
  .amdhsa_next_free_vgpr 64
  .amdhsa_next_free_sgpr 40
  .amdhsa_accum_offset 64
  .amdhsa_group_segment_fixed_size 0
  .amdhsa_kernarg_size 128
  .amdhsa_user_sgpr_count 2
  .amdhsa_user_sgpr_kernarg_segment_ptr 1
  .amdhsa_system_sgpr_workgroup_id_x 1
.end_amdhsa_kernel
.text
.p2align 8
.globl ffn1_kernel
.type ffn1_kernel,@function
ffn1_kernel:
    s_cmp_ge_u32 s2, 1152
    s_cbranch_scc1 ffn1_kernel_end
    s_load_dwordx2 s[4:5], s[0:1], 120
    s_load_dwordx2 s[8:9], s[0:1], 120
    s_and_b32 s22, s2, 15
    s_lshr_b32 s23, s2, 4

    s_load_dwordx2 s[10:11], s[0:1], 64
    s_load_dwordx2 s[6:7], s[0:1], 72
    s_lshl_b32 s24, s23, 7
    s_mov_b32 s29, 0

    s_waitcnt lgkmcnt(0)
    s_add_u32 s12, s4, 82608128
    s_addc_u32 s13, s5, 0
    s_mov_b32 s14, 2359296
    s_mov_b32 s15, 0x00020000
    s_mov_b32 s16, s10
    s_mov_b32 s17, s11
    s_mov_b32 s18, 5308416
    s_mov_b32 s19, 0x00020000
    s_mov_b32 s36, s6
    s_mov_b32 s37, s7
    s_mov_b32 s38, 5308416
    s_mov_b32 s39, 0x00020000
    v_and_b32 v1, 63, v0
    v_lshrrev_b32 v2, 6, v0
    v_and_b32 v3, 15, v0
    v_bfe_u32 v4, v0, 4, 2

    v_lshrrev_b32 v5, 3, v0
    v_and_b32 v6, 7, v0
    s_mul_i32 s25, s22, 147456
    v_mul_u32_u24 v7, 1152, v5
    v_lshl_add_u32 v7, v6, 4, v7
    v_add_u32 v7, s25, v7
    v_mul_u32_u24 v8, 144, v5
    v_lshl_add_u32 v8, v6, 4, v8

    v_lshrrev_b32 v9, 4, v0
    v_and_b32 v10, 15, v0
    v_mul_u32_u24 v11, 9216, v9
    v_lshl_add_u32 v11, v10, 4, v11
    v_add_u32 v11, s24, v11

    v_mul_u32_u24 v11, 9216, v9
    v_lshrrev_b32 v12, 2, v10
    v_lshlrev_b32 v12, 5, v12
    v_and_b32 v13, 1, v10
    v_lshl_add_u32 v12, v13, 4, v12
    v_add_u32 v11, v11, v12
    v_add_u32 v11, s24, v11
    v_bfe_u32 v12, v10, 1, 1
    v_cmp_eq_u32 s[40:41], 1, v12

    v_add_u32 v12, 0, v9
    v_and_b32 v13, 0xffffffe0, v12
    v_bfe_u32 v14, v12, 2, 1
    v_lshl_add_u32 v13, v14, 4, v13
    v_bfe_u32 v14, v12, 3, 2
    v_lshl_add_u32 v13, v14, 2, v13
    v_and_b32 v14, 3, v12
    v_add_u32 v13, v13, v14
    v_mul_u32_u24 v13, 288, v13
    v_lshl_add_u32 v13, v10, 4, v13
    v_add_u32 v16, 18432, v13

    v_add_u32 v12, 16, v9
    v_and_b32 v13, 0xffffffe0, v12
    v_bfe_u32 v14, v12, 2, 1
    v_lshl_add_u32 v13, v14, 4, v13
    v_bfe_u32 v14, v12, 3, 2
    v_lshl_add_u32 v13, v14, 2, v13
    v_and_b32 v14, 3, v12
    v_add_u32 v13, v13, v14
    v_mul_u32_u24 v13, 288, v13
    v_lshl_add_u32 v13, v10, 4, v13
    v_add_u32 v17, 18432, v13

    v_add_u32 v12, 32, v9
    v_and_b32 v13, 0xffffffe0, v12
    v_bfe_u32 v14, v12, 2, 1
    v_lshl_add_u32 v13, v14, 4, v13
    v_bfe_u32 v14, v12, 3, 2
    v_lshl_add_u32 v13, v14, 2, v13
    v_and_b32 v14, 3, v12
    v_add_u32 v13, v13, v14
    v_mul_u32_u24 v13, 288, v13
    v_lshl_add_u32 v13, v10, 4, v13
    v_add_u32 v18, 18432, v13

    v_add_u32 v12, 48, v9
    v_and_b32 v13, 0xffffffe0, v12
    v_bfe_u32 v14, v12, 2, 1
    v_lshl_add_u32 v13, v14, 4, v13
    v_bfe_u32 v14, v12, 3, 2
    v_lshl_add_u32 v13, v14, 2, v13
    v_and_b32 v14, 3, v12
    v_add_u32 v13, v13, v14
    v_mul_u32_u24 v13, 288, v13
    v_lshl_add_u32 v13, v10, 4, v13
    v_add_u32 v19, 18432, v13

    v_lshrrev_b32 v12, 1, v2
    v_and_b32 v13, 1, v2
    v_lshlrev_b32 v14, 6, v12
    v_add_u32 v14, v14, v3
    v_mul_u32_u24 v14, 144, v14
    v_lshl_add_u32 v20, v4, 4, v14

    v_bfe_u32 v14, v0, 2, 2
    v_and_b32 v15, 3, v0
    v_lshl_add_u32 v14, v4, 2, v14
    v_mul_u32_u24 v14, 288, v14
    v_mul_u32_u24 v21, 64, v13
    v_lshl_add_u32 v21, v15, 2, v21
    v_lshl_add_u32 v21, v21, 1, v14
    v_add_u32 v21, 18432, v21

    v_mov_b32 v64, 0
    v_mov_b32 v65, 0
    v_mov_b32 v66, 0
    v_mov_b32 v67, 0
    v_mov_b32 v68, 0
    v_mov_b32 v69, 0
    v_mov_b32 v70, 0
    v_mov_b32 v71, 0
    v_mov_b32 v72, 0
    v_mov_b32 v73, 0
    v_mov_b32 v74, 0
    v_mov_b32 v75, 0
    v_mov_b32 v76, 0
    v_mov_b32 v77, 0
    v_mov_b32 v78, 0
    v_mov_b32 v79, 0
    v_mov_b32 v80, 0
    v_mov_b32 v81, 0
    v_mov_b32 v82, 0
    v_mov_b32 v83, 0
    v_mov_b32 v84, 0
    v_mov_b32 v85, 0
    v_mov_b32 v86, 0
    v_mov_b32 v87, 0
    v_mov_b32 v88, 0
    v_mov_b32 v89, 0
    v_mov_b32 v90, 0
    v_mov_b32 v91, 0
    v_mov_b32 v92, 0
    v_mov_b32 v93, 0
    v_mov_b32 v94, 0
    v_mov_b32 v95, 0
    v_mov_b32 v96, 0
    v_mov_b32 v97, 0
    v_mov_b32 v98, 0
    v_mov_b32 v99, 0
    v_mov_b32 v100, 0
    v_mov_b32 v101, 0
    v_mov_b32 v102, 0
    v_mov_b32 v103, 0
    v_mov_b32 v104, 0
    v_mov_b32 v105, 0
    v_mov_b32 v106, 0
    v_mov_b32 v107, 0
    v_mov_b32 v108, 0
    v_mov_b32 v109, 0
    v_mov_b32 v110, 0
    v_mov_b32 v111, 0
    v_mov_b32 v112, 0
    v_mov_b32 v113, 0
    v_mov_b32 v114, 0
    v_mov_b32 v115, 0
    v_mov_b32 v116, 0
    v_mov_b32 v117, 0
    v_mov_b32 v118, 0
    v_mov_b32 v119, 0
    v_mov_b32 v120, 0
    v_mov_b32 v121, 0
    v_mov_b32 v122, 0
    v_mov_b32 v123, 0
    v_mov_b32 v124, 0
    v_mov_b32 v125, 0
    v_mov_b32 v126, 0
    v_mov_b32 v127, 0
    v_add_u32 v25, 36864, v7
    v_add_u32 v26, 73728, v7
    v_add_u32 v27, 110592, v7
    v_add_u32 v29, 147456, v11
    v_add_u32 v30, 294912, v11
    v_add_u32 v31, 442368, v11
    s_mov_b32 s26, 0
    s_mov_b32 s27, 0
    s_mov_b32 s28, 0
    buffer_load_dwordx4 v[32:35], v7, s[12:15], s26 offen offset:0
    buffer_load_dwordx4 v[36:39], v25, s[12:15], s26 offen
    buffer_load_dwordx4 v[40:43], v26, s[12:15], s26 offen
    buffer_load_dwordx4 v[44:47], v27, s[12:15], s26 offen
    s_not_b64 exec, s[40:41]
    buffer_load_dwordx4 v[48:51], v11, s[16:19], s27 offen
    buffer_load_dwordx4 v[52:55], v29, s[16:19], s27 offen
    buffer_load_dwordx4 v[56:59], v30, s[16:19], s27 offen
    buffer_load_dwordx4 v[60:63], v31, s[16:19], s27 offen
    s_mov_b64 exec, s[40:41]
    buffer_load_dwordx4 v[48:51], v11, s[36:39], s27 offen
    buffer_load_dwordx4 v[52:55], v29, s[36:39], s27 offen
    buffer_load_dwordx4 v[56:59], v30, s[36:39], s27 offen
    buffer_load_dwordx4 v[60:63], v31, s[36:39], s27 offen
    s_mov_b64 exec, -1
    s_waitcnt vmcnt(0)
    ds_write_b128 v8, v[32:35] offset:0
    ds_write_b128 v8, v[36:39] offset:4608
    ds_write_b128 v8, v[40:43] offset:9216
    ds_write_b128 v8, v[44:47] offset:13824
    ds_write_b128 v16, v[48:51]
    ds_write_b128 v17, v[52:55]
    ds_write_b128 v18, v[56:59]
    ds_write_b128 v19, v[60:63]
    s_waitcnt lgkmcnt(0)
    s_barrier
ffn1_kernel_loop1:
    s_add_u32 s26, s26, 128
    s_add_u32 s27, s27, 589824
    s_add_u32 s28, s28, 1

    buffer_load_dwordx4 v[32:35], v7, s[12:15], s26 offen offset:0
    buffer_load_dwordx4 v[36:39], v25, s[12:15], s26 offen
    buffer_load_dwordx4 v[40:43], v26, s[12:15], s26 offen
    buffer_load_dwordx4 v[44:47], v27, s[12:15], s26 offen
    s_not_b64 exec, s[40:41]
    buffer_load_dwordx4 v[48:51], v11, s[16:19], s27 offen
    buffer_load_dwordx4 v[52:55], v29, s[16:19], s27 offen
    buffer_load_dwordx4 v[56:59], v30, s[16:19], s27 offen
    buffer_load_dwordx4 v[60:63], v31, s[16:19], s27 offen
    s_mov_b64 exec, s[40:41]
    buffer_load_dwordx4 v[48:51], v11, s[36:39], s27 offen
    buffer_load_dwordx4 v[52:55], v29, s[36:39], s27 offen
    buffer_load_dwordx4 v[56:59], v30, s[36:39], s27 offen
    buffer_load_dwordx4 v[60:63], v31, s[36:39], s27 offen
    s_mov_b64 exec, -1
    ds_read_b128 v[128:131], v20 offset:0
    ds_read_b128 v[132:135], v20 offset:2304
    ds_read_b128 v[136:139], v20 offset:4608
    ds_read_b128 v[140:143], v20 offset:6912
    ds_read_b64_tr_b16 v[144:145], v21 offset:0
    ds_read_b64_tr_b16 v[146:147], v21 offset:4608
    ds_read_b64_tr_b16 v[148:149], v21 offset:32
    ds_read_b64_tr_b16 v[150:151], v21 offset:4640
    ds_read_b64_tr_b16 v[152:153], v21 offset:64
    ds_read_b64_tr_b16 v[154:155], v21 offset:4672
    ds_read_b64_tr_b16 v[156:157], v21 offset:96
    ds_read_b64_tr_b16 v[158:159], v21 offset:4704
    s_waitcnt lgkmcnt(0)
    v_mfma_f32_16x16x32_bf16 v[64:67], v[144:147], v[128:131], v[64:67]
    v_mfma_f32_16x16x32_bf16 v[68:71], v[148:151], v[128:131], v[68:71]
    v_mfma_f32_16x16x32_bf16 v[72:75], v[152:155], v[128:131], v[72:75]
    v_mfma_f32_16x16x32_bf16 v[76:79], v[156:159], v[128:131], v[76:79]
    v_mfma_f32_16x16x32_bf16 v[80:83], v[144:147], v[132:135], v[80:83]
    v_mfma_f32_16x16x32_bf16 v[84:87], v[148:151], v[132:135], v[84:87]
    v_mfma_f32_16x16x32_bf16 v[88:91], v[152:155], v[132:135], v[88:91]
    v_mfma_f32_16x16x32_bf16 v[92:95], v[156:159], v[132:135], v[92:95]
    v_mfma_f32_16x16x32_bf16 v[96:99], v[144:147], v[136:139], v[96:99]
    v_mfma_f32_16x16x32_bf16 v[100:103], v[148:151], v[136:139], v[100:103]
    v_mfma_f32_16x16x32_bf16 v[104:107], v[152:155], v[136:139], v[104:107]
    v_mfma_f32_16x16x32_bf16 v[108:111], v[156:159], v[136:139], v[108:111]
    v_mfma_f32_16x16x32_bf16 v[112:115], v[144:147], v[140:143], v[112:115]
    v_mfma_f32_16x16x32_bf16 v[116:119], v[148:151], v[140:143], v[116:119]
    v_mfma_f32_16x16x32_bf16 v[120:123], v[152:155], v[140:143], v[120:123]
    v_mfma_f32_16x16x32_bf16 v[124:127], v[156:159], v[140:143], v[124:127]
    ds_read_b128 v[128:131], v20 offset:64
    ds_read_b128 v[132:135], v20 offset:2368
    ds_read_b128 v[136:139], v20 offset:4672
    ds_read_b128 v[140:143], v20 offset:6976
    ds_read_b64_tr_b16 v[144:145], v21 offset:9216
    ds_read_b64_tr_b16 v[146:147], v21 offset:13824
    ds_read_b64_tr_b16 v[148:149], v21 offset:9248
    ds_read_b64_tr_b16 v[150:151], v21 offset:13856
    ds_read_b64_tr_b16 v[152:153], v21 offset:9280
    ds_read_b64_tr_b16 v[154:155], v21 offset:13888
    ds_read_b64_tr_b16 v[156:157], v21 offset:9312
    ds_read_b64_tr_b16 v[158:159], v21 offset:13920
    s_waitcnt lgkmcnt(0)
    v_mfma_f32_16x16x32_bf16 v[64:67], v[144:147], v[128:131], v[64:67]
    v_mfma_f32_16x16x32_bf16 v[68:71], v[148:151], v[128:131], v[68:71]
    v_mfma_f32_16x16x32_bf16 v[72:75], v[152:155], v[128:131], v[72:75]
    v_mfma_f32_16x16x32_bf16 v[76:79], v[156:159], v[128:131], v[76:79]
    v_mfma_f32_16x16x32_bf16 v[80:83], v[144:147], v[132:135], v[80:83]
    v_mfma_f32_16x16x32_bf16 v[84:87], v[148:151], v[132:135], v[84:87]
    v_mfma_f32_16x16x32_bf16 v[88:91], v[152:155], v[132:135], v[88:91]
    v_mfma_f32_16x16x32_bf16 v[92:95], v[156:159], v[132:135], v[92:95]
    v_mfma_f32_16x16x32_bf16 v[96:99], v[144:147], v[136:139], v[96:99]
    v_mfma_f32_16x16x32_bf16 v[100:103], v[148:151], v[136:139], v[100:103]
    v_mfma_f32_16x16x32_bf16 v[104:107], v[152:155], v[136:139], v[104:107]
    v_mfma_f32_16x16x32_bf16 v[108:111], v[156:159], v[136:139], v[108:111]
    v_mfma_f32_16x16x32_bf16 v[112:115], v[144:147], v[140:143], v[112:115]
    v_mfma_f32_16x16x32_bf16 v[116:119], v[148:151], v[140:143], v[116:119]
    v_mfma_f32_16x16x32_bf16 v[120:123], v[152:155], v[140:143], v[120:123]
    v_mfma_f32_16x16x32_bf16 v[124:127], v[156:159], v[140:143], v[124:127]
    v_xor_b32 v8, 65536, v8
    v_xor_b32 v20, 65536, v20
    v_xor_b32 v21, 65536, v21

    v_xor_b32 v16, 65536, v16
    v_xor_b32 v17, 65536, v17
    v_xor_b32 v18, 65536, v18
    v_xor_b32 v19, 65536, v19
    s_cmp_ge_u32 s28, 9
    s_cbranch_scc1 ffn1_kernel_skip2
    s_waitcnt vmcnt(0)

    ds_write_b128 v8, v[32:35] offset:0
    ds_write_b128 v8, v[36:39] offset:4608
    ds_write_b128 v8, v[40:43] offset:9216
    ds_write_b128 v8, v[44:47] offset:13824
    ds_write_b128 v16, v[48:51]
    ds_write_b128 v17, v[52:55]
    ds_write_b128 v18, v[56:59]
    ds_write_b128 v19, v[60:63]
    s_waitcnt lgkmcnt(0)
    s_barrier
    s_branch ffn1_kernel_loop1
ffn1_kernel_skip2:
    s_waitcnt vmcnt(0)
    s_nop 7
    s_nop 7
    s_add_u32 s32, s8, 84967424
    s_addc_u32 s33, s9, 0
    s_mov_b32 s34, 18874368
    s_mov_b32 s35, 0x00020000
    v_lshrrev_b32 v12, 1, v2
    v_and_b32 v13, 1, v2
    s_lshl_b32 s25, s22, 7
    v_lshl_add_u32 v14, v12, 6, v3
    v_add_u32 v14, s25, v14
    v_mul_u32_u24 v14, 9216, v14
    v_lshlrev_b32 v15, 5, v13
    v_lshl_add_u32 v15, v4, 2, v15
    s_lshl_b32 s25, s23, 6
    v_add_u32 v15, s25, v15
    v_lshl_add_u32 v14, v15, 1, v14

    v_cvt_pk_bf16_f32 v48, v64, v65
    v_cvt_pk_bf16_f32 v49, v66, v67
    v_cvt_pk_bf16_f32 v50, v68, v69
    v_cvt_pk_bf16_f32 v51, v70, v71
    v_lshlrev_b32 v64, 16, v48
    v_and_b32 v65, 0xffff0000, v48
    v_lshlrev_b32 v66, 16, v49
    v_and_b32 v67, 0xffff0000, v49
    v_lshlrev_b32 v68, 16, v50
    v_and_b32 v69, 0xffff0000, v50
    v_lshlrev_b32 v70, 16, v51
    v_and_b32 v71, 0xffff0000, v51
    v_max_f32 v64, 0, v64
    v_max_f32 v65, 0, v65
    v_max_f32 v66, 0, v66
    v_max_f32 v67, 0, v67
    v_mul_f32 v64, v64, v68
    v_mul_f32 v65, v65, v69
    v_mul_f32 v66, v66, v70
    v_mul_f32 v67, v67, v71
    v_cvt_pk_bf16_f32 v64, v64, v65
    v_cvt_pk_bf16_f32 v65, v66, v67

    v_cvt_pk_bf16_f32 v48, v72, v73
    v_cvt_pk_bf16_f32 v49, v74, v75
    v_cvt_pk_bf16_f32 v50, v76, v77
    v_cvt_pk_bf16_f32 v51, v78, v79
    v_lshlrev_b32 v72, 16, v48
    v_and_b32 v73, 0xffff0000, v48
    v_lshlrev_b32 v74, 16, v49
    v_and_b32 v75, 0xffff0000, v49
    v_lshlrev_b32 v76, 16, v50
    v_and_b32 v77, 0xffff0000, v50
    v_lshlrev_b32 v78, 16, v51
    v_and_b32 v79, 0xffff0000, v51
    v_max_f32 v72, 0, v72
    v_max_f32 v73, 0, v73
    v_max_f32 v74, 0, v74
    v_max_f32 v75, 0, v75
    v_mul_f32 v72, v72, v76
    v_mul_f32 v73, v73, v77
    v_mul_f32 v74, v74, v78
    v_mul_f32 v75, v75, v79
    v_cvt_pk_bf16_f32 v72, v72, v73
    v_cvt_pk_bf16_f32 v73, v74, v75

    buffer_store_dwordx2 v[64:65], v14, s[32:35], 0 offen offset:0
    buffer_store_dwordx2 v[72:73], v14, s[32:35], 0 offen offset:32
    v_add_u32 v14, 147456, v14
    v_cvt_pk_bf16_f32 v48, v80, v81
    v_cvt_pk_bf16_f32 v49, v82, v83
    v_cvt_pk_bf16_f32 v50, v84, v85
    v_cvt_pk_bf16_f32 v51, v86, v87
    v_lshlrev_b32 v80, 16, v48
    v_and_b32 v81, 0xffff0000, v48
    v_lshlrev_b32 v82, 16, v49
    v_and_b32 v83, 0xffff0000, v49
    v_lshlrev_b32 v84, 16, v50
    v_and_b32 v85, 0xffff0000, v50
    v_lshlrev_b32 v86, 16, v51
    v_and_b32 v87, 0xffff0000, v51
    v_max_f32 v80, 0, v80
    v_max_f32 v81, 0, v81
    v_max_f32 v82, 0, v82
    v_max_f32 v83, 0, v83
    v_mul_f32 v80, v80, v84
    v_mul_f32 v81, v81, v85
    v_mul_f32 v82, v82, v86
    v_mul_f32 v83, v83, v87
    v_cvt_pk_bf16_f32 v80, v80, v81
    v_cvt_pk_bf16_f32 v81, v82, v83

    v_cvt_pk_bf16_f32 v48, v88, v89
    v_cvt_pk_bf16_f32 v49, v90, v91
    v_cvt_pk_bf16_f32 v50, v92, v93
    v_cvt_pk_bf16_f32 v51, v94, v95
    v_lshlrev_b32 v88, 16, v48
    v_and_b32 v89, 0xffff0000, v48
    v_lshlrev_b32 v90, 16, v49
    v_and_b32 v91, 0xffff0000, v49
    v_lshlrev_b32 v92, 16, v50
    v_and_b32 v93, 0xffff0000, v50
    v_lshlrev_b32 v94, 16, v51
    v_and_b32 v95, 0xffff0000, v51
    v_max_f32 v88, 0, v88
    v_max_f32 v89, 0, v89
    v_max_f32 v90, 0, v90
    v_max_f32 v91, 0, v91
    v_mul_f32 v88, v88, v92
    v_mul_f32 v89, v89, v93
    v_mul_f32 v90, v90, v94
    v_mul_f32 v91, v91, v95
    v_cvt_pk_bf16_f32 v88, v88, v89
    v_cvt_pk_bf16_f32 v89, v90, v91

    buffer_store_dwordx2 v[80:81], v14, s[32:35], 0 offen offset:0
    buffer_store_dwordx2 v[88:89], v14, s[32:35], 0 offen offset:32
    v_add_u32 v14, 147456, v14
    v_cvt_pk_bf16_f32 v48, v96, v97
    v_cvt_pk_bf16_f32 v49, v98, v99
    v_cvt_pk_bf16_f32 v50, v100, v101
    v_cvt_pk_bf16_f32 v51, v102, v103
    v_lshlrev_b32 v96, 16, v48
    v_and_b32 v97, 0xffff0000, v48
    v_lshlrev_b32 v98, 16, v49
    v_and_b32 v99, 0xffff0000, v49
    v_lshlrev_b32 v100, 16, v50
    v_and_b32 v101, 0xffff0000, v50
    v_lshlrev_b32 v102, 16, v51
    v_and_b32 v103, 0xffff0000, v51
    v_max_f32 v96, 0, v96
    v_max_f32 v97, 0, v97
    v_max_f32 v98, 0, v98
    v_max_f32 v99, 0, v99
    v_mul_f32 v96, v96, v100
    v_mul_f32 v97, v97, v101
    v_mul_f32 v98, v98, v102
    v_mul_f32 v99, v99, v103
    v_cvt_pk_bf16_f32 v96, v96, v97
    v_cvt_pk_bf16_f32 v97, v98, v99

    v_cvt_pk_bf16_f32 v48, v104, v105
    v_cvt_pk_bf16_f32 v49, v106, v107
    v_cvt_pk_bf16_f32 v50, v108, v109
    v_cvt_pk_bf16_f32 v51, v110, v111
    v_lshlrev_b32 v104, 16, v48
    v_and_b32 v105, 0xffff0000, v48
    v_lshlrev_b32 v106, 16, v49
    v_and_b32 v107, 0xffff0000, v49
    v_lshlrev_b32 v108, 16, v50
    v_and_b32 v109, 0xffff0000, v50
    v_lshlrev_b32 v110, 16, v51
    v_and_b32 v111, 0xffff0000, v51
    v_max_f32 v104, 0, v104
    v_max_f32 v105, 0, v105
    v_max_f32 v106, 0, v106
    v_max_f32 v107, 0, v107
    v_mul_f32 v104, v104, v108
    v_mul_f32 v105, v105, v109
    v_mul_f32 v106, v106, v110
    v_mul_f32 v107, v107, v111
    v_cvt_pk_bf16_f32 v104, v104, v105
    v_cvt_pk_bf16_f32 v105, v106, v107

    buffer_store_dwordx2 v[96:97], v14, s[32:35], 0 offen offset:0
    buffer_store_dwordx2 v[104:105], v14, s[32:35], 0 offen offset:32
    v_add_u32 v14, 147456, v14
    v_cvt_pk_bf16_f32 v48, v112, v113
    v_cvt_pk_bf16_f32 v49, v114, v115
    v_cvt_pk_bf16_f32 v50, v116, v117
    v_cvt_pk_bf16_f32 v51, v118, v119
    v_lshlrev_b32 v112, 16, v48
    v_and_b32 v113, 0xffff0000, v48
    v_lshlrev_b32 v114, 16, v49
    v_and_b32 v115, 0xffff0000, v49
    v_lshlrev_b32 v116, 16, v50
    v_and_b32 v117, 0xffff0000, v50
    v_lshlrev_b32 v118, 16, v51
    v_and_b32 v119, 0xffff0000, v51
    v_max_f32 v112, 0, v112
    v_max_f32 v113, 0, v113
    v_max_f32 v114, 0, v114
    v_max_f32 v115, 0, v115
    v_mul_f32 v112, v112, v116
    v_mul_f32 v113, v113, v117
    v_mul_f32 v114, v114, v118
    v_mul_f32 v115, v115, v119
    v_cvt_pk_bf16_f32 v112, v112, v113
    v_cvt_pk_bf16_f32 v113, v114, v115

    v_cvt_pk_bf16_f32 v48, v120, v121
    v_cvt_pk_bf16_f32 v49, v122, v123
    v_cvt_pk_bf16_f32 v50, v124, v125
    v_cvt_pk_bf16_f32 v51, v126, v127
    v_lshlrev_b32 v120, 16, v48
    v_and_b32 v121, 0xffff0000, v48
    v_lshlrev_b32 v122, 16, v49
    v_and_b32 v123, 0xffff0000, v49
    v_lshlrev_b32 v124, 16, v50
    v_and_b32 v125, 0xffff0000, v50
    v_lshlrev_b32 v126, 16, v51
    v_and_b32 v127, 0xffff0000, v51
    v_max_f32 v120, 0, v120
    v_max_f32 v121, 0, v121
    v_max_f32 v122, 0, v122
    v_max_f32 v123, 0, v123
    v_mul_f32 v120, v120, v124
    v_mul_f32 v121, v121, v125
    v_mul_f32 v122, v122, v126
    v_mul_f32 v123, v123, v127
    v_cvt_pk_bf16_f32 v120, v120, v121
    v_cvt_pk_bf16_f32 v121, v122, v123

    buffer_store_dwordx2 v[112:113], v14, s[32:35], 0 offen offset:0
    buffer_store_dwordx2 v[120:121], v14, s[32:35], 0 offen offset:32
    v_add_u32 v14, 147456, v14
ffn1_kernel_end:
    s_endpgm
.section .rodata,"a"
.p2align 6
.amdhsa_kernel ffn1_kernel
  .amdhsa_next_free_vgpr 160
  .amdhsa_next_free_sgpr 48
  .amdhsa_accum_offset 160
  .amdhsa_group_segment_fixed_size 0
  .amdhsa_kernarg_size 128
  .amdhsa_user_sgpr_count 2
  .amdhsa_user_sgpr_kernarg_segment_ptr 1
  .amdhsa_system_sgpr_workgroup_id_x 1
.end_amdhsa_kernel
.text
.p2align 8
.globl ffn2_kernel
.type ffn2_kernel,@function
ffn2_kernel:
    s_cmp_ge_u32 s2, 144
    s_cbranch_scc1 ffn2_kernel_end
    s_load_dwordx2 s[4:5], s[0:1], 120
    s_load_dwordx2 s[8:9], s[0:1], 120
    s_and_b32 s22, s2, 15
    s_lshr_b32 s23, s2, 4

    s_load_dwordx2 s[10:11], s[0:1], 80
    s_mul_i32 s24, s23, 128
    s_mov_b32 s29, 0

    s_waitcnt lgkmcnt(0)
    s_add_u32 s12, s4, 84967424
    s_addc_u32 s13, s5, 0
    s_mov_b32 s14, 18874368
    s_mov_b32 s15, 0x00020000
    s_mov_b32 s16, s10
    s_mov_b32 s17, s11
    s_mov_b32 s18, 5308416
    s_mov_b32 s19, 0x00020000
    v_and_b32 v1, 63, v0
    v_lshrrev_b32 v2, 6, v0
    v_and_b32 v3, 15, v0
    v_bfe_u32 v4, v0, 4, 2

    v_lshrrev_b32 v5, 3, v0
    v_and_b32 v6, 7, v0
    s_mul_i32 s25, s22, 1179648
    v_mul_u32_u24 v7, 9216, v5
    v_lshl_add_u32 v7, v6, 4, v7
    v_add_u32 v7, s25, v7
    v_mul_u32_u24 v8, 144, v5
    v_lshl_add_u32 v8, v6, 4, v8

    v_lshrrev_b32 v9, 3, v0
    v_and_b32 v10, 7, v0
    v_mul_u32_u24 v11, 1152, v9
    v_lshl_add_u32 v11, v10, 4, v11
    v_add_u32 v11, s24, v11

    v_add_u32 v12, 0, v9
    v_and_b32 v13, 0xffffffe0, v12
    v_bfe_u32 v14, v12, 2, 1
    v_lshl_add_u32 v13, v14, 4, v13
    v_bfe_u32 v14, v12, 3, 2
    v_lshl_add_u32 v13, v14, 2, v13
    v_and_b32 v14, 3, v12
    v_add_u32 v13, v13, v14
    v_mul_u32_u24 v13, 160, v13
    v_lshl_add_u32 v13, v10, 4, v13
    v_add_u32 v16, 18432, v13

    v_add_u32 v12, 32, v9
    v_and_b32 v13, 0xffffffe0, v12
    v_bfe_u32 v14, v12, 2, 1
    v_lshl_add_u32 v13, v14, 4, v13
    v_bfe_u32 v14, v12, 3, 2
    v_lshl_add_u32 v13, v14, 2, v13
    v_and_b32 v14, 3, v12
    v_add_u32 v13, v13, v14
    v_mul_u32_u24 v13, 160, v13
    v_lshl_add_u32 v13, v10, 4, v13
    v_add_u32 v17, 18432, v13

    v_lshrrev_b32 v12, 1, v2
    v_and_b32 v13, 1, v2
    v_lshlrev_b32 v14, 6, v12
    v_add_u32 v14, v14, v3
    v_mul_u32_u24 v14, 144, v14
    v_lshl_add_u32 v20, v4, 4, v14

    v_bfe_u32 v14, v0, 2, 2
    v_and_b32 v15, 3, v0
    v_lshl_add_u32 v14, v4, 2, v14
    v_mul_u32_u24 v14, 160, v14
    v_mul_u32_u24 v21, 32, v13
    v_lshl_add_u32 v21, v15, 2, v21
    v_lshl_add_u32 v21, v21, 1, v14
    v_add_u32 v21, 18432, v21

    v_mov_b32 v64, 0
    v_mov_b32 v65, 0
    v_mov_b32 v66, 0
    v_mov_b32 v67, 0
    v_mov_b32 v68, 0
    v_mov_b32 v69, 0
    v_mov_b32 v70, 0
    v_mov_b32 v71, 0
    v_mov_b32 v72, 0
    v_mov_b32 v73, 0
    v_mov_b32 v74, 0
    v_mov_b32 v75, 0
    v_mov_b32 v76, 0
    v_mov_b32 v77, 0
    v_mov_b32 v78, 0
    v_mov_b32 v79, 0
    v_mov_b32 v80, 0
    v_mov_b32 v81, 0
    v_mov_b32 v82, 0
    v_mov_b32 v83, 0
    v_mov_b32 v84, 0
    v_mov_b32 v85, 0
    v_mov_b32 v86, 0
    v_mov_b32 v87, 0
    v_mov_b32 v88, 0
    v_mov_b32 v89, 0
    v_mov_b32 v90, 0
    v_mov_b32 v91, 0
    v_mov_b32 v92, 0
    v_mov_b32 v93, 0
    v_mov_b32 v94, 0
    v_mov_b32 v95, 0
    v_add_u32 v25, 294912, v7
    v_add_u32 v26, 589824, v7
    v_add_u32 v27, 884736, v7
    v_add_u32 v29, 36864, v11
    s_mov_b32 s26, 0
    s_mov_b32 s27, 0
    s_mov_b32 s28, 0
    buffer_load_dwordx4 v[32:35], v7, s[12:15], s26 offen offset:0
    buffer_load_dwordx4 v[36:39], v25, s[12:15], s26 offen
    buffer_load_dwordx4 v[40:43], v26, s[12:15], s26 offen
    buffer_load_dwordx4 v[44:47], v27, s[12:15], s26 offen
    buffer_load_dwordx4 v[48:51], v11, s[16:19], s27 offen
    buffer_load_dwordx4 v[52:55], v29, s[16:19], s27 offen
    s_waitcnt vmcnt(0)
    ds_write_b128 v8, v[32:35] offset:0
    ds_write_b128 v8, v[36:39] offset:4608
    ds_write_b128 v8, v[40:43] offset:9216
    ds_write_b128 v8, v[44:47] offset:13824
    ds_write_b128 v16, v[48:51]
    ds_write_b128 v17, v[52:55]
    s_waitcnt lgkmcnt(0)
    s_barrier
ffn2_kernel_loop1:
    s_add_u32 s26, s26, 128
    s_add_u32 s27, s27, 73728
    s_add_u32 s28, s28, 1

    buffer_load_dwordx4 v[32:35], v7, s[12:15], s26 offen offset:0
    buffer_load_dwordx4 v[36:39], v25, s[12:15], s26 offen
    buffer_load_dwordx4 v[40:43], v26, s[12:15], s26 offen
    buffer_load_dwordx4 v[44:47], v27, s[12:15], s26 offen
    buffer_load_dwordx4 v[48:51], v11, s[16:19], s27 offen
    buffer_load_dwordx4 v[52:55], v29, s[16:19], s27 offen
    ds_read_b128 v[128:131], v20 offset:0
    ds_read_b128 v[132:135], v20 offset:2304
    ds_read_b128 v[136:139], v20 offset:4608
    ds_read_b128 v[140:143], v20 offset:6912
    ds_read_b64_tr_b16 v[144:145], v21 offset:0
    ds_read_b64_tr_b16 v[146:147], v21 offset:2560
    ds_read_b64_tr_b16 v[148:149], v21 offset:32
    ds_read_b64_tr_b16 v[150:151], v21 offset:2592
    s_waitcnt lgkmcnt(0)
    v_mfma_f32_16x16x32_bf16 v[64:67], v[144:147], v[128:131], v[64:67]
    v_mfma_f32_16x16x32_bf16 v[68:71], v[148:151], v[128:131], v[68:71]
    v_mfma_f32_16x16x32_bf16 v[72:75], v[144:147], v[132:135], v[72:75]
    v_mfma_f32_16x16x32_bf16 v[76:79], v[148:151], v[132:135], v[76:79]
    v_mfma_f32_16x16x32_bf16 v[80:83], v[144:147], v[136:139], v[80:83]
    v_mfma_f32_16x16x32_bf16 v[84:87], v[148:151], v[136:139], v[84:87]
    v_mfma_f32_16x16x32_bf16 v[88:91], v[144:147], v[140:143], v[88:91]
    v_mfma_f32_16x16x32_bf16 v[92:95], v[148:151], v[140:143], v[92:95]
    ds_read_b128 v[128:131], v20 offset:64
    ds_read_b128 v[132:135], v20 offset:2368
    ds_read_b128 v[136:139], v20 offset:4672
    ds_read_b128 v[140:143], v20 offset:6976
    ds_read_b64_tr_b16 v[144:145], v21 offset:5120
    ds_read_b64_tr_b16 v[146:147], v21 offset:7680
    ds_read_b64_tr_b16 v[148:149], v21 offset:5152
    ds_read_b64_tr_b16 v[150:151], v21 offset:7712
    s_waitcnt lgkmcnt(0)
    v_mfma_f32_16x16x32_bf16 v[64:67], v[144:147], v[128:131], v[64:67]
    v_mfma_f32_16x16x32_bf16 v[68:71], v[148:151], v[128:131], v[68:71]
    v_mfma_f32_16x16x32_bf16 v[72:75], v[144:147], v[132:135], v[72:75]
    v_mfma_f32_16x16x32_bf16 v[76:79], v[148:151], v[132:135], v[76:79]
    v_mfma_f32_16x16x32_bf16 v[80:83], v[144:147], v[136:139], v[80:83]
    v_mfma_f32_16x16x32_bf16 v[84:87], v[148:151], v[136:139], v[84:87]
    v_mfma_f32_16x16x32_bf16 v[88:91], v[144:147], v[140:143], v[88:91]
    v_mfma_f32_16x16x32_bf16 v[92:95], v[148:151], v[140:143], v[92:95]
    v_xor_b32 v8, 32768, v8
    v_xor_b32 v20, 32768, v20
    v_xor_b32 v21, 32768, v21

    v_xor_b32 v16, 32768, v16
    v_xor_b32 v17, 32768, v17
    s_cmp_ge_u32 s28, 72
    s_cbranch_scc1 ffn2_kernel_skip2
    s_waitcnt vmcnt(0)

    ds_write_b128 v8, v[32:35] offset:0
    ds_write_b128 v8, v[36:39] offset:4608
    ds_write_b128 v8, v[40:43] offset:9216
    ds_write_b128 v8, v[44:47] offset:13824
    ds_write_b128 v16, v[48:51]
    ds_write_b128 v17, v[52:55]
    s_waitcnt lgkmcnt(0)
    s_barrier
    s_branch ffn2_kernel_loop1
ffn2_kernel_skip2:
    s_waitcnt vmcnt(0)
    s_nop 7
    s_nop 7
    s_load_dwordx2 s[4:5], s[0:1], 120
    s_load_dwordx2 s[6:7], s[0:1], 104
    s_waitcnt lgkmcnt(0)
    s_add_u32 s32, s4, 80248832
    s_addc_u32 s33, s5, 0
    s_mov_b32 s34, 2359296
    s_mov_b32 s35, 0x00020000
    s_mov_b32 s36, s6
    s_mov_b32 s37, s7
    s_mov_b32 s38, 2359296
    s_mov_b32 s39, 0x00020000
    s_mov_b32 s40, s8
    s_mov_b32 s41, s9
    s_mov_b32 s42, 13824
    s_mov_b32 s43, 0x00020000
    v_lshrrev_b32 v12, 1, v2
    v_and_b32 v13, 1, v2
    s_lshl_b32 s25, s22, 7
    v_lshl_add_u32 v14, v12, 6, v3
    v_add_u32 v14, s25, v14
    v_mul_u32_u24 v14, 1152, v14
    v_mul_u32_u24 v15, 32, v13
    v_lshl_add_u32 v15, v4, 2, v15
    s_mul_i32 s25, s23, 64
    v_add_u32 v15, s25, v15
    v_lshl_add_u32 v14, v15, 1, v14
    v_lshlrev_b32 v15, 2, v15
    v_add_u32 v15, 11520, v15

    buffer_load_dwordx4 v[16:19], v15, s[40:43], 0 offen offset:0
    buffer_load_dwordx4 v[20:23], v15, s[40:43], 0 offen offset:64
    buffer_load_dwordx2 v[32:33], v14, s[32:35], 0 offen offset:0
    buffer_load_dwordx2 v[34:35], v14, s[32:35], 0 offen offset:32
    s_waitcnt vmcnt(0)
    v_cvt_pk_bf16_f32 v48, v64, v65
    v_cvt_pk_bf16_f32 v49, v66, v67
    v_lshlrev_b32 v64, 16, v48
    v_and_b32 v65, 0xffff0000, v48
    v_lshlrev_b32 v66, 16, v49
    v_and_b32 v67, 0xffff0000, v49
    v_mul_f32 v64, v64, v16
    v_mul_f32 v65, v65, v17
    v_mul_f32 v66, v66, v18
    v_mul_f32 v67, v67, v19
    v_cvt_pk_bf16_f32 v48, v64, v65
    v_cvt_pk_bf16_f32 v49, v66, v67
    v_lshlrev_b32 v64, 16, v48
    v_and_b32 v65, 0xffff0000, v48
    v_lshlrev_b32 v66, 16, v49
    v_and_b32 v67, 0xffff0000, v49
    v_lshlrev_b32 v50, 16, v32
    v_and_b32 v51, 0xffff0000, v32
    v_lshlrev_b32 v52, 16, v33
    v_and_b32 v53, 0xffff0000, v33
    v_add_f32 v64, v64, v50
    v_add_f32 v65, v65, v51
    v_add_f32 v66, v66, v52
    v_add_f32 v67, v67, v53
    v_cvt_pk_bf16_f32 v64, v64, v65
    v_cvt_pk_bf16_f32 v65, v66, v67

    v_cvt_pk_bf16_f32 v48, v68, v69
    v_cvt_pk_bf16_f32 v49, v70, v71
    v_lshlrev_b32 v68, 16, v48
    v_and_b32 v69, 0xffff0000, v48
    v_lshlrev_b32 v70, 16, v49
    v_and_b32 v71, 0xffff0000, v49
    v_mul_f32 v68, v68, v20
    v_mul_f32 v69, v69, v21
    v_mul_f32 v70, v70, v22
    v_mul_f32 v71, v71, v23
    v_cvt_pk_bf16_f32 v48, v68, v69
    v_cvt_pk_bf16_f32 v49, v70, v71
    v_lshlrev_b32 v68, 16, v48
    v_and_b32 v69, 0xffff0000, v48
    v_lshlrev_b32 v70, 16, v49
    v_and_b32 v71, 0xffff0000, v49
    v_lshlrev_b32 v50, 16, v34
    v_and_b32 v51, 0xffff0000, v34
    v_lshlrev_b32 v52, 16, v35
    v_and_b32 v53, 0xffff0000, v35
    v_add_f32 v68, v68, v50
    v_add_f32 v69, v69, v51
    v_add_f32 v70, v70, v52
    v_add_f32 v71, v71, v53
    v_cvt_pk_bf16_f32 v68, v68, v69
    v_cvt_pk_bf16_f32 v69, v70, v71

    buffer_store_dwordx2 v[64:65], v14, s[36:39], 0 offen offset:0
    buffer_store_dwordx2 v[68:69], v14, s[36:39], 0 offen offset:32
    v_add_u32 v14, 18432, v14
    buffer_load_dwordx2 v[32:33], v14, s[32:35], 0 offen offset:0
    buffer_load_dwordx2 v[34:35], v14, s[32:35], 0 offen offset:32
    s_waitcnt vmcnt(0)
    v_cvt_pk_bf16_f32 v48, v72, v73
    v_cvt_pk_bf16_f32 v49, v74, v75
    v_lshlrev_b32 v72, 16, v48
    v_and_b32 v73, 0xffff0000, v48
    v_lshlrev_b32 v74, 16, v49
    v_and_b32 v75, 0xffff0000, v49
    v_mul_f32 v72, v72, v16
    v_mul_f32 v73, v73, v17
    v_mul_f32 v74, v74, v18
    v_mul_f32 v75, v75, v19
    v_cvt_pk_bf16_f32 v48, v72, v73
    v_cvt_pk_bf16_f32 v49, v74, v75
    v_lshlrev_b32 v72, 16, v48
    v_and_b32 v73, 0xffff0000, v48
    v_lshlrev_b32 v74, 16, v49
    v_and_b32 v75, 0xffff0000, v49
    v_lshlrev_b32 v50, 16, v32
    v_and_b32 v51, 0xffff0000, v32
    v_lshlrev_b32 v52, 16, v33
    v_and_b32 v53, 0xffff0000, v33
    v_add_f32 v72, v72, v50
    v_add_f32 v73, v73, v51
    v_add_f32 v74, v74, v52
    v_add_f32 v75, v75, v53
    v_cvt_pk_bf16_f32 v72, v72, v73
    v_cvt_pk_bf16_f32 v73, v74, v75

    v_cvt_pk_bf16_f32 v48, v76, v77
    v_cvt_pk_bf16_f32 v49, v78, v79
    v_lshlrev_b32 v76, 16, v48
    v_and_b32 v77, 0xffff0000, v48
    v_lshlrev_b32 v78, 16, v49
    v_and_b32 v79, 0xffff0000, v49
    v_mul_f32 v76, v76, v20
    v_mul_f32 v77, v77, v21
    v_mul_f32 v78, v78, v22
    v_mul_f32 v79, v79, v23
    v_cvt_pk_bf16_f32 v48, v76, v77
    v_cvt_pk_bf16_f32 v49, v78, v79
    v_lshlrev_b32 v76, 16, v48
    v_and_b32 v77, 0xffff0000, v48
    v_lshlrev_b32 v78, 16, v49
    v_and_b32 v79, 0xffff0000, v49
    v_lshlrev_b32 v50, 16, v34
    v_and_b32 v51, 0xffff0000, v34
    v_lshlrev_b32 v52, 16, v35
    v_and_b32 v53, 0xffff0000, v35
    v_add_f32 v76, v76, v50
    v_add_f32 v77, v77, v51
    v_add_f32 v78, v78, v52
    v_add_f32 v79, v79, v53
    v_cvt_pk_bf16_f32 v76, v76, v77
    v_cvt_pk_bf16_f32 v77, v78, v79

    buffer_store_dwordx2 v[72:73], v14, s[36:39], 0 offen offset:0
    buffer_store_dwordx2 v[76:77], v14, s[36:39], 0 offen offset:32
    v_add_u32 v14, 18432, v14
    buffer_load_dwordx2 v[32:33], v14, s[32:35], 0 offen offset:0
    buffer_load_dwordx2 v[34:35], v14, s[32:35], 0 offen offset:32
    s_waitcnt vmcnt(0)
    v_cvt_pk_bf16_f32 v48, v80, v81
    v_cvt_pk_bf16_f32 v49, v82, v83
    v_lshlrev_b32 v80, 16, v48
    v_and_b32 v81, 0xffff0000, v48
    v_lshlrev_b32 v82, 16, v49
    v_and_b32 v83, 0xffff0000, v49
    v_mul_f32 v80, v80, v16
    v_mul_f32 v81, v81, v17
    v_mul_f32 v82, v82, v18
    v_mul_f32 v83, v83, v19
    v_cvt_pk_bf16_f32 v48, v80, v81
    v_cvt_pk_bf16_f32 v49, v82, v83
    v_lshlrev_b32 v80, 16, v48
    v_and_b32 v81, 0xffff0000, v48
    v_lshlrev_b32 v82, 16, v49
    v_and_b32 v83, 0xffff0000, v49
    v_lshlrev_b32 v50, 16, v32
    v_and_b32 v51, 0xffff0000, v32
    v_lshlrev_b32 v52, 16, v33
    v_and_b32 v53, 0xffff0000, v33
    v_add_f32 v80, v80, v50
    v_add_f32 v81, v81, v51
    v_add_f32 v82, v82, v52
    v_add_f32 v83, v83, v53
    v_cvt_pk_bf16_f32 v80, v80, v81
    v_cvt_pk_bf16_f32 v81, v82, v83

    v_cvt_pk_bf16_f32 v48, v84, v85
    v_cvt_pk_bf16_f32 v49, v86, v87
    v_lshlrev_b32 v84, 16, v48
    v_and_b32 v85, 0xffff0000, v48
    v_lshlrev_b32 v86, 16, v49
    v_and_b32 v87, 0xffff0000, v49
    v_mul_f32 v84, v84, v20
    v_mul_f32 v85, v85, v21
    v_mul_f32 v86, v86, v22
    v_mul_f32 v87, v87, v23
    v_cvt_pk_bf16_f32 v48, v84, v85
    v_cvt_pk_bf16_f32 v49, v86, v87
    v_lshlrev_b32 v84, 16, v48
    v_and_b32 v85, 0xffff0000, v48
    v_lshlrev_b32 v86, 16, v49
    v_and_b32 v87, 0xffff0000, v49
    v_lshlrev_b32 v50, 16, v34
    v_and_b32 v51, 0xffff0000, v34
    v_lshlrev_b32 v52, 16, v35
    v_and_b32 v53, 0xffff0000, v35
    v_add_f32 v84, v84, v50
    v_add_f32 v85, v85, v51
    v_add_f32 v86, v86, v52
    v_add_f32 v87, v87, v53
    v_cvt_pk_bf16_f32 v84, v84, v85
    v_cvt_pk_bf16_f32 v85, v86, v87

    buffer_store_dwordx2 v[80:81], v14, s[36:39], 0 offen offset:0
    buffer_store_dwordx2 v[84:85], v14, s[36:39], 0 offen offset:32
    v_add_u32 v14, 18432, v14
    buffer_load_dwordx2 v[32:33], v14, s[32:35], 0 offen offset:0
    buffer_load_dwordx2 v[34:35], v14, s[32:35], 0 offen offset:32
    s_waitcnt vmcnt(0)
    v_cvt_pk_bf16_f32 v48, v88, v89
    v_cvt_pk_bf16_f32 v49, v90, v91
    v_lshlrev_b32 v88, 16, v48
    v_and_b32 v89, 0xffff0000, v48
    v_lshlrev_b32 v90, 16, v49
    v_and_b32 v91, 0xffff0000, v49
    v_mul_f32 v88, v88, v16
    v_mul_f32 v89, v89, v17
    v_mul_f32 v90, v90, v18
    v_mul_f32 v91, v91, v19
    v_cvt_pk_bf16_f32 v48, v88, v89
    v_cvt_pk_bf16_f32 v49, v90, v91
    v_lshlrev_b32 v88, 16, v48
    v_and_b32 v89, 0xffff0000, v48
    v_lshlrev_b32 v90, 16, v49
    v_and_b32 v91, 0xffff0000, v49
    v_lshlrev_b32 v50, 16, v32
    v_and_b32 v51, 0xffff0000, v32
    v_lshlrev_b32 v52, 16, v33
    v_and_b32 v53, 0xffff0000, v33
    v_add_f32 v88, v88, v50
    v_add_f32 v89, v89, v51
    v_add_f32 v90, v90, v52
    v_add_f32 v91, v91, v53
    v_cvt_pk_bf16_f32 v88, v88, v89
    v_cvt_pk_bf16_f32 v89, v90, v91

    v_cvt_pk_bf16_f32 v48, v92, v93
    v_cvt_pk_bf16_f32 v49, v94, v95
    v_lshlrev_b32 v92, 16, v48
    v_and_b32 v93, 0xffff0000, v48
    v_lshlrev_b32 v94, 16, v49
    v_and_b32 v95, 0xffff0000, v49
    v_mul_f32 v92, v92, v20
    v_mul_f32 v93, v93, v21
    v_mul_f32 v94, v94, v22
    v_mul_f32 v95, v95, v23
    v_cvt_pk_bf16_f32 v48, v92, v93
    v_cvt_pk_bf16_f32 v49, v94, v95
    v_lshlrev_b32 v92, 16, v48
    v_and_b32 v93, 0xffff0000, v48
    v_lshlrev_b32 v94, 16, v49
    v_and_b32 v95, 0xffff0000, v49
    v_lshlrev_b32 v50, 16, v34
    v_and_b32 v51, 0xffff0000, v34
    v_lshlrev_b32 v52, 16, v35
    v_and_b32 v53, 0xffff0000, v35
    v_add_f32 v92, v92, v50
    v_add_f32 v93, v93, v51
    v_add_f32 v94, v94, v52
    v_add_f32 v95, v95, v53
    v_cvt_pk_bf16_f32 v92, v92, v93
    v_cvt_pk_bf16_f32 v93, v94, v95

    buffer_store_dwordx2 v[88:89], v14, s[36:39], 0 offen offset:0
    buffer_store_dwordx2 v[92:93], v14, s[36:39], 0 offen offset:32
    v_add_u32 v14, 18432, v14
ffn2_kernel_end:
    s_endpgm
.section .rodata,"a"
.p2align 6
.amdhsa_kernel ffn2_kernel
  .amdhsa_next_free_vgpr 160
  .amdhsa_next_free_sgpr 48
  .amdhsa_accum_offset 160
  .amdhsa_group_segment_fixed_size 0
  .amdhsa_kernarg_size 128
  .amdhsa_user_sgpr_count 2
  .amdhsa_user_sgpr_kernarg_segment_ptr 1
  .amdhsa_system_sgpr_workgroup_id_x 1
.end_amdhsa_kernel
.text
```
